```python
import torch

def _softmax(x, axis=-1):
    return torch.softmax(x, dim=axis)
def _gelu(x):
    return torch.nn.functional.gelu(x, approximate="tanh")
def _silu(x):
    return torch.nn.functional.silu(x)
def _sigmoid(x):
    return torch.sigmoid(x)
def _layernorm(x, axis=-1, eps=1e-5):
    m = x.mean(dim=axis, keepdim=True)
    v = x.var(dim=axis, keepdim=True, unbiased=False)
    return (x - m) / torch.sqrt(v + eps)
def _scatter_add(tgt, idx, src, axis=0):
    return tgt.clone().index_add_(axis, idx, src)
def _segment_sum(src, seg, n):
    out = torch.zeros((n,) + src.shape[1:], dtype=src.dtype)
    return out.index_add_(0, seg, src)
def _pad(x, pw):
    flat = tuple(v for pair in reversed(pw) for v in pair)
    return torch.nn.functional.pad(x, flat)

kernel_name = 'interleave_layers__ssm_conv_s4d__glu_gated_glu__prompt'

def setup_inputs():

    _w = (lambda a: (lambda t: t.to(torch.bfloat16) if t.is_floating_point() else t)(torch.as_tensor(a)))
    def _A_setup():
        Bsz, L, D, N = 1, 2048, 448, 256
        return {
            "u": _w((lambda *s: torch.randn(*s, dtype=torch.bfloat16) * 0.05)(Bsz, L, D)),
            "log_A_real": _w((lambda *s: torch.randn(*s, dtype=torch.bfloat16) * 3.2)(D, N) * 0.5),
            "A_imag": _w((lambda *s: torch.randn(*s, dtype=torch.bfloat16) * 0.1)(D, N) * 3.14),
            "C_real": _w((lambda *s: torch.randn(*s, dtype=torch.bfloat16) * 0.1)(D, N) / N ** 0.5),
            "C_imag": _w((lambda *s: torch.randn(*s, dtype=torch.bfloat16) * 0.1)(D, N) / N ** 0.5),
            "log_dt": _w((lambda *s: torch.randn(*s, dtype=torch.bfloat16) * 0.1)(D) * 0.5 - 4.0),
            "D_skip": _w((lambda *s: torch.randn(*s, dtype=torch.bfloat16) * 0.1)(D)),
        }
    _A_in = _A_setup()

    def _B_setup():
        B, S, D, F = 1, 2048, 448, 1792
        return {
            "x": _w((lambda *s: torch.randn(*s, dtype=torch.bfloat16) * 0.05)(B, S, D)),
            "w_gate": _w((lambda *s: torch.randn(*s, dtype=torch.bfloat16) * 0.05)(D, F)),
            "w_up": _w((lambda *s: torch.randn(*s, dtype=torch.bfloat16) * 0.05)(D, F)),
            "w_down": _w((lambda *s: torch.randn(*s, dtype=torch.bfloat16) * 0.05)(F, D)),
        }
    _B_in = _B_setup()

    return {
        "A_u": _A_in["u"],
        "A_log_A_real": _A_in["log_A_real"],
        "A_A_imag": _A_in["A_imag"],
        "A_C_real": _A_in["C_real"],
        "A_C_imag": _A_in["C_imag"],
        "A_log_dt": _A_in["log_dt"],
        "A_D_skip": _A_in["D_skip"],
        "B_x": _B_in["x"],
        "B_w_gate": _B_in["w_gate"],
        "B_w_up": _B_in["w_up"],
        "B_w_down": _B_in["w_down"],
    }

def reference(A_u, A_log_A_real, A_A_imag, A_C_real, A_C_imag, A_log_dt, A_D_skip, B_x, B_w_gate, B_w_up, B_w_down):
    def _A_ref(u, log_A_real, A_imag, C_real, C_imag, log_dt, D_skip):
        L = u.shape[1]
        dt = torch.exp(log_dt)
        A = -torch.exp(log_A_real) + 1j * A_imag
        C = (C_real + 1j * C_imag) * dt[:, None]
        pos = (lambda x, dt: x.to(dt))(torch.arange(L), log_dt.dtype)
        P = torch.exp((A * dt[:, None])[:, :, None] * pos[None, None, :])
        K = 2.0 * torch.einsum("dn,dnl->dl", C, P).real
        L2 = 2 * L
        u_t = (lambda x, *d: x.permute(*d))(u, 0, 2, 1)
        Kf = (lambda x, *a, **k: torch.fft.rfft(x.float(), *a, **k))(K, L2)
        Uf = (lambda x, *a, **k: torch.fft.rfft(x.float(), *a, **k))(u_t, L2)
        y = (lambda x, *a, **k: torch.fft.irfft(x, *a, **k).to(torch.bfloat16))(Uf * Kf[None, :, :], L2)[:, :, :L]
        y = (lambda x, *d: x.permute(*d))(y, 0, 2, 1)
        return y + u * D_skip[None, None, :]

    def _B_ref(x, w_gate, w_up, w_down):
        g = torch.einsum("bsd,df->bsf", x, w_gate)
        u = torch.einsum("bsd,df->bsf", x, w_up)
        h = _sigmoid(g) * u
        return torch.einsum("bsf,fd->bsd", h, w_down)

    x = A_u
    x = x + _A_ref(_layernorm(x, axis=-1), A_log_A_real, A_A_imag, A_C_real, A_C_imag, A_log_dt, A_D_skip)
    x = x + _B_ref(_layernorm(x, axis=-1), B_w_gate, B_w_up, B_w_down)
    x = x + _A_ref(_layernorm(x, axis=-1), A_log_A_real, A_A_imag, A_C_real, A_C_imag, A_log_dt, A_D_skip)
    x = x + _B_ref(_layernorm(x, axis=-1), B_w_gate, B_w_up, B_w_down)
    return x
```

```asm
; @launch grid=(240,1,1) block=(256,1,1) lds=163840
.amdgcn_target "amdgcn-amd-amdhsa--gfx950"
.text
.globl interleave_layers__ssm_conv_s4d__glu_gated_glu__prompt_kernel
.p2align 8
.type interleave_layers__ssm_conv_s4d__glu_gated_glu__prompt_kernel,@function
interleave_layers__ssm_conv_s4d__glu_gated_glu__prompt_kernel:
  s_cmp_ge_u32 s2, 240
  s_cbranch_scc1 L_exit
  s_load_dwordx16 s[16:31], s[0:1], 0
  s_load_dwordx8 s[32:39], s[0:1], 64
  s_load_dwordx4 s[40:43], s[0:1], 96
  v_lshrrev_b32 v3, 6, v0
  v_and_b32 v1, 63, v0
  v_readfirstlane_b32 s3, v3
  v_lshlrev_b32 v2, 4, v1
  s_and_b32 s4, s2, 7
  s_lshr_b32 s9, s2, 3
  s_mul_i32 s10, s9, 37
  s_lshr_b32 s10, s10, 8
  s_mul_i32 s11, s10, 7
  s_sub_u32 s7, s9, s11
  s_and_b32 s8, s4, 1
  s_lshr_b32 s5, s4, 1
  s_lshl_b32 s5, s5, 2
  s_add_u32 s5, s5, s10
  s_mul_i32 s6, s8, 7
  s_add_u32 s6, s6, s7
  s_mov_b32 s47, 0x3f803f80
  v_lshlrev_b32 v4, 1, v0
  s_lshl_b32 s9, s2, 10
  v_add_u32 v4, s9, v4
  s_waitcnt lgkmcnt(0)
  s_cmp_ge_u32 s2, 224
  s_cbranch_scc1 nokp_1
  global_load_ushort v64, v4, s[18:19] offset:0 nt
  global_load_ushort v65, v4, s[20:21] offset:0 nt
  global_load_ushort v66, v4, s[22:23] offset:0 nt
  global_load_ushort v67, v4, s[24:25] offset:0 nt
  global_load_ushort v68, v4, s[18:19] offset:512 nt
  global_load_ushort v69, v4, s[20:21] offset:512 nt
  global_load_ushort v70, v4, s[22:23] offset:512 nt
  global_load_ushort v71, v4, s[24:25] offset:512 nt
  v_mov_b32 v62, s2
  v_lshlrev_b32 v62, 2, v62
  global_load_dword v60, v62, s[26:27]
  global_load_dword v61, v62, s[28:29]
nokp_1:
  s_mov_b32 s44, s32
  s_mov_b32 s45, s33
  v_mov_b32 v88, v2
  s_mov_b32 s61, 0
  s_mov_b32 s62, 0
  s_cmp_ge_u32 s2, 168
  s_cbranch_scc1 nopack_2
  s_cmp_ge_u32 s2, 112
  s_cbranch_scc1 iswd_4
  s_lshr_b32 s11, s2, 4
  s_mul_i32 s10, s4, 7
  s_add_u32 s10, s10, s11
  s_and_b32 s9, s10, 62
  s_bfe_u32 s11, s2, 0x10003
  s_add_u32 s9, s9, s11
  s_and_b32 s10, s10, 1
  s_cmp_eq_u32 s10, 1
  s_cselect_b32 s44, s34, s32
  s_cselect_b32 s45, s35, s33
  s_lshl_b32 s61, s9, 6
  s_mov_b32 s60, 0
  s_mov_b32 s58, 3584
  s_mov_b32 s59, 0x3b124925
  s_mov_b32 s62, 0
  s_mov_b32 s63, 256
  s_mov_b32 s13, 9
  s_mul_i32 s14, s9, 57344
  s_lshl_b32 s9, s10, 10
  s_add_u32 s14, s14, s9
  s_branch cfg_5
iswd_4:
  s_mov_b32 s44, s36
  s_mov_b32 s45, s37
  s_sub_u32 s9, s2, 112
  s_lshr_b32 s10, s9, 3
  s_mul_i32 s11, s4, 3
  s_lshr_b32 s12, s10, 1
  s_add_u32 s11, s11, s12
  s_and_b32 s12, s10, 1
  s_cmp_eq_u32 s10, 6
  s_cbranch_scc0 iswd_4_m
  s_lshr_b32 s11, s4, 1
  s_add_u32 s11, s11, 24
  s_and_b32 s12, s4, 1
iswd_4_m:
  s_lshr_b32 s9, s11, 2
  s_lshl_b32 s9, s9, 3
  s_lshl_b32 s12, s12, 2
  s_add_u32 s9, s9, s12
  s_and_b32 s11, s11, 3
  s_add_u32 s9, s9, s11
  s_lshr_b32 s10, s9, 3
  s_lshl_b32 s61, s10, 7
  s_bfe_u32 s11, s9, 0x10002
  s_and_b32 s12, s9, 3
  s_lshl_b32 s60, s11, 6
  s_lshl_b32 s9, s12, 5
  s_add_u32 s60, s60, s9
  s_mul_i32 s62, s12, 448
  s_mul_i32 s14, s10, 229376
  s_mul_i32 s9, s12, 57344
  s_add_u32 s14, s14, s9
  s_lshl_b32 s9, s11, 10
  s_add_u32 s14, s14, s9
  s_add_u32 s14, s14, 3211264
  s_mov_b32 s58, 896
  s_mov_b32 s59, 0
  s_mov_b32 s63, 512
  s_mov_b32 s13, 8
cfg_5:
  s_mul_i32 s9, s3, 112
  s_add_u32 s9, s9, s62
  v_lshrrev_b32 v5, 2, v1
  v_add_u32 v5, s9, v5
  v_mul_lo_u32 v5, v5, s58
  v_and_b32 v6, 3, v1
  v_lshlrev_b32 v6, 4, v6
  v_add_u32 v6, s60, v6
  v_and_b32 v6, 127, v6
  v_add3_u32 v5, v5, v6, s61
  s_lshl_b32 s62, s58, 4
  s_mul_i32 s10, s3, 7168
  s_add_u32 s10, s10, 0
  s_mov_b32 s61, s10
  v_mov_b32 v88, v5
  v_lshrrev_b32 v6, 5, v1
  v_lshlrev_b32 v6, s13, v6
  v_and_b32 v7, 15, v1
  v_lshrrev_b32 v7, 2, v7
  v_lshlrev_b32 v7, 6, v7
  v_add_u32 v6, v6, v7
  v_bfe_u32 v7, v1, 4, 1
  v_lshlrev_b32 v7, 5, v7
  v_add_u32 v6, v6, v7
  v_and_b32 v7, 3, v1
  v_lshlrev_b32 v7, 3, v7
  v_add3_u32 v7, v6, v7, s61
  v_add_u32 v8, s63, v7
  s_mov_b32 s60, s14
  s_branch packld_3
nopack_2:
  s_cmp_ge_u32 s2, 232
  s_cbranch_scc1 packld_3
  s_sub_u32 s61, s2, 168
  v_lshrrev_b32 v5, 3, v1
  v_mul_u32_u24 v5, 896, v5
  v_and_b32 v6, 7, v1
  v_lshlrev_b32 v6, 4, v6
  v_add_u32 v5, v5, v6
  s_lshl_b32 s62, s3, 13
  s_mul_i32 s57, s61, 28672
  s_lshl_b32 s58, s3, 8
  s_add_u32 s57, s57, s58
  v_add_u32 v5, s57, v5
  s_mul_i32 s59, s61, 28672
  s_add_u32 s59, s59, s62
  s_add_u32 s59, s59, 6291456
  v_add_u32 v6, 0, v5
  s_add_u32 m0, s62, 0
  s_nop 0
  global_load_lds_dwordx4 v6, s[16:17] nt
  v_add_u32 v6, 7168, v6
  s_add_u32 m0, s62, 1024
  s_nop 0
  global_load_lds_dwordx4 v6, s[16:17] nt
  v_add_u32 v6, 7168, v6
  s_add_u32 m0, s62, 2048
  s_nop 0
  global_load_lds_dwordx4 v6, s[16:17] nt
  v_add_u32 v6, 7168, v6
  s_add_u32 m0, s62, 3072
  s_nop 0
  global_load_lds_dwordx4 v6, s[16:17] nt
  s_cmp_eq_u32 s3, 3
  s_cbranch_scc1 nk1_6
  v_add_u32 v6, 128, v5
  s_add_u32 m0, s62, 4096
  s_nop 0
  global_load_lds_dwordx4 v6, s[16:17] nt
  v_add_u32 v6, 7168, v6
  s_add_u32 m0, s62, 5120
  s_nop 0
  global_load_lds_dwordx4 v6, s[16:17] nt
  v_add_u32 v6, 7168, v6
  s_add_u32 m0, s62, 6144
  s_nop 0
  global_load_lds_dwordx4 v6, s[16:17] nt
  v_add_u32 v6, 7168, v6
  s_add_u32 m0, s62, 7168
  s_nop 0
  global_load_lds_dwordx4 v6, s[16:17] nt
nk1_6:
  v_lshrrev_b32 v7, 4, v1
  v_lshlrev_b32 v7, 10, v7
  v_bfe_u32 v6, v1, 2, 2
  v_lshlrev_b32 v6, 7, v6
  v_and_b32 v8, 3, v1
  v_lshlrev_b32 v8, 3, v8
  v_add3_u32 v7, v7, v6, v8
  v_add_u32 v7, s62, v7
  v_and_b32 v8, 15, v1
  v_lshlrev_b32 v8, 6, v8
  v_lshrrev_b32 v6, 4, v1
  v_lshlrev_b32 v6, 4, v6
  v_add_u32 v8, v8, v6
  s_lshl_b32 s9, s3, 10
  v_add_u32 v57, s9, v2
  s_lshl_b32 s9, s61, 5
  s_lshl_b32 s10, s3, 3
  s_add_u32 s9, s9, s10
  v_lshrrev_b32 v56, 3, v1
  v_add_u32 v56, s9, v56
packld_3:
  v_mov_b32 v12, 1
  v_and_b32 v41, 3, v1
  v_lshlrev_b32 v41, 6, v41
  v_mov_b32 v42, 0
  v_mov_b32 v43, 0
  v_lshrrev_b32 v4, 3, v0
  v_mul_u32_u24 v4, 28672, v4
  v_and_b32 v3, 7, v0
  v_lshlrev_b32 v3, 3, v3
  s_lshl_b32 s9, s2, 7
  v_add3_u32 v10, v4, v3, s9
  v_lshlrev_b32 v11, 5, v0
  v_lshlrev_b32 v13, 10, v1
  s_lshl_b32 s9, s4, 7
  v_add_u32 v13, s9, v13
  v_and_b32 v14, 7, v1
  v_lshlrev_b32 v14, 7, v14
  s_lshl_b32 s9, s4, 10
  v_add_u32 v14, s9, v14
  v_lshlrev_b32 v15, 3, v0
  v_add_u32 v15, 17120, v15
  v_lshlrev_b32 v16, 4, v0
  v_add_u32 v16, 90112, v16
  v_and_b32 v4, 15, v1
  v_lshrrev_b32 v3, 4, v1
  s_lshr_b32 s9, s3, 1
  s_and_b32 s10, s3, 1
  v_and_b32 v18, 1, v3
  v_lshlrev_b32 v18, 4, v18
  v_lshrrev_b32 v19, 1, v3
  v_lshlrev_b32 v19, 5, v19
  v_sub_u32 v20, v18, v19
  s_lshl_b32 s12, s10, 8
  s_mul_i32 s11, s9, 4608
  s_sub_u32 s11, s11, s12
  s_add_u32 s11, s11, 16928
  v_lshlrev_b32 v21, 5, v4
  v_add3_u32 v21, v21, v20, s11
  s_mul_i32 s11, s9, 8320
  s_sub_u32 s11, s11, s12
  s_add_u32 s11, s11, 318
  v_lshlrev_b32 v18, 1, v4
  v_sub_u32 v18, v20, v18
  v_add_u32 v18, s11, v18
  v_and_b32 v19, 1, v4
  v_mov_b32 v20, 4158
  v_cmp_eq_u32 vcc, 0, v19
  s_nop 1
  v_cndmask_b32 v19, 0, v20, vcc
  v_add_u32 v17, v18, v19
  v_add_u32 v18, 1024, v17
  v_add_u32 v19, 2048, v17
  v_add_u32 v20, 3072, v17
  s_lshl_b32 s11, s3, 12
  s_add_u32 s11, s11, 106496
  v_add_u32 v22, s11, v2
  s_lshl_b32 s11, s9, 13
  s_lshl_b32 s12, s10, 11
  s_add_u32 s11, s11, s12
  s_add_u32 s12, s11, 106496
  v_add_u32 v23, s12, v2
  s_add_u32 s11, s11, 90112
  v_lshlrev_b32 v24, 6, v4
  v_lshlrev_b32 v25, 4, v3
  v_add3_u32 v24, v24, v25, s11
  v_lshrrev_b32 v25, 1, v4
  v_and_b32 v5, 1, v3
  v_lshlrev_b32 v5, 3, v5
  v_add_u32 v25, v25, v5
  v_mul_u32_u24 v25, 28672, v25
  v_and_b32 v4, 1, v4
  v_lshlrev_b32 v4, 5, v4
  v_lshrrev_b32 v3, 1, v3
  v_lshlrev_b32 v3, 4, v3
  v_add3_u32 v25, v25, v4, v3
  s_mul_i32 s11, s10, 458752
  s_lshl_b32 s12, s2, 7
  s_add_u32 s11, s11, s12
  s_lshl_b32 s12, s9, 6
  s_add_u32 s11, s11, s12
  v_add_u32 v25, s11, v25
  v_bfe_u32 v3, v1, 2, 2
  v_lshlrev_b32 v3, 6, v3
  v_bfe_u32 v4, v1, 4, 1
  v_lshlrev_b32 v4, 5, v4
  v_add_u32 v3, v3, v4
  v_and_b32 v4, 3, v1
  v_lshlrev_b32 v4, 3, v4
  v_add_u32 v3, v3, v4
  v_lshrrev_b32 v4, 5, v1
  v_lshlrev_b32 v26, 9, v4
  v_add3_u32 v26, v26, v3, 0
  v_add_u32 v26, 32768, v26
  v_lshlrev_b32 v30, 8, v4
  v_add_u32 v30, v30, v3
  s_mul_i32 s11, s8, 28672
  s_lshl_b32 s12, s7, 12
  s_add_u32 s11, s11, s12
  s_lshl_b32 s12, s3, 10
  s_add_u32 s11, s11, s12
  s_add_u32 s11, s11, 32768
  v_add_u32 v30, s11, v30
  s_mul_i32 s11, s3, 7168
  v_add_u32 v27, s11, v2
  s_lshl_b32 s11, s6, 2
  s_add_u32 s11, s11, s3
  s_lshl_b32 s11, s11, 11
  v_add_u32 v28, s11, v2
  v_and_b32 v29, 31, v1
  v_lshlrev_b32 v29, 3, v29
  s_mul_i32 s11, s3, 28672
  v_add_u32 v38, s11, v2
  s_mul_i32 s11, s3, 6144
  s_add_u32 s11, s11, 32768
  v_add_u32 v32, s11, v2
  v_and_b32 v33, 7, v1
  v_lshlrev_b32 v33, 5, v33
  v_bfe_u32 v3, v1, 3, 2
  v_mul_u32_u24 v3, 384, v3
  v_lshlrev_b32 v4, 3, v4
  v_add3_u32 v33, v33, v3, v4
  s_mul_i32 s11, s3, 1536
  s_add_u32 s11, s11, 25856
  v_add_u32 v33, s11, v33
  v_bfe_u32 v34, v1, 2, 2
  v_lshlrev_b32 v34, 5, v34
  v_lshrrev_b32 v3, 4, v1
  v_mul_u32_u24 v3, 384, v3
  v_and_b32 v4, 3, v1
  v_lshlrev_b32 v4, 3, v4
  v_add3_u32 v34, v34, v3, v4
  v_add_u32 v34, s11, v34
  s_lshl_b32 s12, s8, 4
  s_add_u32 s12, s12, s5
  s_mul_i32 s11, s12, 28672
  s_lshl_b32 s13, s7, 12
  s_add_u32 s11, s11, s13
  s_lshl_b32 s13, s3, 10
  s_add_u32 s11, s11, s13
  v_and_b32 v35, 15, v1
  v_lshlrev_b32 v35, 6, v35
  v_lshrrev_b32 v3, 4, v1
  v_lshlrev_b32 v3, 4, v3
  v_add3_u32 v35, v35, v3, s11
  s_lshr_b32 s11, s12, 3
  s_lshl_b32 s11, s11, 12
  s_and_b32 s13, s12, 7
  s_lshl_b32 s13, s13, 7
  s_add_u32 s11, s11, s13
  s_and_b32 s13, s3, 1
  s_lshl_b32 s13, s13, 6
  s_add_u32 s11, s11, s13
  s_add_u32 s11, s11, 33554432
  v_bfe_u32 v4, v1, 2, 2
  v_lshlrev_b32 v4, 10, v4
  v_lshrrev_b32 v3, 4, v1
  v_lshlrev_b32 v3, 4, v3
  v_add3_u32 v36, v4, v3, s11
  v_and_b32 v3, 3, v1
  v_lshlrev_b32 v3, 2, v3
  v_add_u32 v36, v36, v3
  v_bfe_u32 v3, v1, 4, 2
  v_lshlrev_b32 v3, 2, v3
  s_mul_i32 s11, s3, 7168
  s_add_u32 s11, s11, 32768
  v_add3_u32 v31, v2, v3, s11
  v_lshrrev_b32 v3, 5, v1
  v_and_b32 v37, 31, v1
  s_lshl_b32 s11, s12, 5
  v_add_u32 v37, s11, v37
  v_mul_u32_u24 v37, 896, v37
  v_lshlrev_b32 v3, 4, v3
  s_lshl_b32 s11, s7, 7
  s_lshl_b32 s13, s3, 5
  s_add_u32 s11, s11, s13
  v_add3_u32 v37, v37, v3, s11
  s_mov_b32 s46, 0
  s_mov_b32 s48, 6291456
  s_mov_b32 s49, 8388608
  s_mov_b32 s50, 10485760
  s_mov_b32 s51, 16777216
  s_mov_b32 s52, 34603008
  s_mov_b32 s53, 33619968
  s_mov_b32 s54, 33587200
  s_mov_b32 s55, 0
  s_cmp_ge_u32 s2, 232
  s_cbranch_scc1 L_helper
  s_cmp_lt_u32 s2, 168
  s_cbranch_scc1 pkp_12
  s_waitcnt vmcnt(0)
  s_barrier
  ds_read_b128 v[160:163], v57 offset:0
  ds_read_b128 v[164:167], v57 offset:4096
  ds_read_b128 v[168:171], v57 offset:8192
  ds_read_b128 v[172:175], v57 offset:12288
  ds_read_b128 v[176:179], v57 offset:16384
  ds_read_b128 v[180:183], v57 offset:20480
  ds_read_b128 v[184:187], v57 offset:24576
  ds_read_b64_tr_b16 v[128:129], v7 offset:0
  ds_read_b64_tr_b16 v[130:131], v7 offset:512
  ds_read_b64_tr_b16 v[132:133], v7 offset:32
  ds_read_b64_tr_b16 v[134:135], v7 offset:544
  ds_read_b64_tr_b16 v[136:137], v7 offset:64
  ds_read_b64_tr_b16 v[138:139], v7 offset:576
  ds_read_b64_tr_b16 v[140:141], v7 offset:96
  ds_read_b64_tr_b16 v[142:143], v7 offset:608
  s_cmp_eq_u32 s3, 3
  s_cbranch_scc1 nk2_14
  ds_read_b64_tr_b16 v[144:145], v7 offset:4096
  ds_read_b64_tr_b16 v[146:147], v7 offset:4608
  ds_read_b64_tr_b16 v[148:149], v7 offset:4128
  ds_read_b64_tr_b16 v[150:151], v7 offset:4640
  ds_read_b64_tr_b16 v[152:153], v7 offset:4160
  ds_read_b64_tr_b16 v[154:155], v7 offset:4672
  ds_read_b64_tr_b16 v[156:157], v7 offset:4192
  ds_read_b64_tr_b16 v[158:159], v7 offset:4704
nk2_14:
  v_add_u32 v5, s59, v8
  v_add_u32 v6, 4096, v5
  s_waitcnt lgkmcnt(0)
  global_store_dwordx4 v5, v[128:131], s[42:43] offset:0 sc1
  global_store_dwordx4 v5, v[132:135], s[42:43] offset:1024 sc1
  global_store_dwordx4 v5, v[136:139], s[42:43] offset:2048 sc1
  global_store_dwordx4 v5, v[140:143], s[42:43] offset:3072 sc1
  s_cmp_eq_u32 s3, 3
  s_cbranch_scc1 nk3_15
  global_store_dwordx4 v6, v[144:147], s[42:43] offset:0 sc1
  global_store_dwordx4 v6, v[148:151], s[42:43] offset:1024 sc1
  global_store_dwordx4 v6, v[152:155], s[42:43] offset:2048 sc1
  global_store_dwordx4 v6, v[156:159], s[42:43] offset:3072 sc1
nk3_15:
  v_mov_b32 v90, 0
  v_mov_b32 v91, 0
  v_dot2_f32_bf16 v90, v160, s47, v90
  v_dot2_f32_bf16 v91, v160, v160, v91
  v_dot2_f32_bf16 v90, v161, s47, v90
  v_dot2_f32_bf16 v91, v161, v161, v91
  v_dot2_f32_bf16 v90, v162, s47, v90
  v_dot2_f32_bf16 v91, v162, v162, v91
  v_dot2_f32_bf16 v90, v163, s47, v90
  v_dot2_f32_bf16 v91, v163, v163, v91
  v_dot2_f32_bf16 v90, v164, s47, v90
  v_dot2_f32_bf16 v91, v164, v164, v91
  v_dot2_f32_bf16 v90, v165, s47, v90
  v_dot2_f32_bf16 v91, v165, v165, v91
  v_dot2_f32_bf16 v90, v166, s47, v90
  v_dot2_f32_bf16 v91, v166, v166, v91
  v_dot2_f32_bf16 v90, v167, s47, v90
  v_dot2_f32_bf16 v91, v167, v167, v91
  v_dot2_f32_bf16 v90, v168, s47, v90
  v_dot2_f32_bf16 v91, v168, v168, v91
  v_dot2_f32_bf16 v90, v169, s47, v90
  v_dot2_f32_bf16 v91, v169, v169, v91
  v_dot2_f32_bf16 v90, v170, s47, v90
  v_dot2_f32_bf16 v91, v170, v170, v91
  v_dot2_f32_bf16 v90, v171, s47, v90
  v_dot2_f32_bf16 v91, v171, v171, v91
  v_dot2_f32_bf16 v90, v172, s47, v90
  v_dot2_f32_bf16 v91, v172, v172, v91
  v_dot2_f32_bf16 v90, v173, s47, v90
  v_dot2_f32_bf16 v91, v173, v173, v91
  v_dot2_f32_bf16 v90, v174, s47, v90
  v_dot2_f32_bf16 v91, v174, v174, v91
  v_dot2_f32_bf16 v90, v175, s47, v90
  v_dot2_f32_bf16 v91, v175, v175, v91
  v_dot2_f32_bf16 v90, v176, s47, v90
  v_dot2_f32_bf16 v91, v176, v176, v91
  v_dot2_f32_bf16 v90, v177, s47, v90
  v_dot2_f32_bf16 v91, v177, v177, v91
  v_dot2_f32_bf16 v90, v178, s47, v90
  v_dot2_f32_bf16 v91, v178, v178, v91
  v_dot2_f32_bf16 v90, v179, s47, v90
  v_dot2_f32_bf16 v91, v179, v179, v91
  v_dot2_f32_bf16 v90, v180, s47, v90
  v_dot2_f32_bf16 v91, v180, v180, v91
  v_dot2_f32_bf16 v90, v181, s47, v90
  v_dot2_f32_bf16 v91, v181, v181, v91
  v_dot2_f32_bf16 v90, v182, s47, v90
  v_dot2_f32_bf16 v91, v182, v182, v91
  v_dot2_f32_bf16 v90, v183, s47, v90
  v_dot2_f32_bf16 v91, v183, v183, v91
  v_dot2_f32_bf16 v90, v184, s47, v90
  v_dot2_f32_bf16 v91, v184, v184, v91
  v_dot2_f32_bf16 v90, v185, s47, v90
  v_dot2_f32_bf16 v91, v185, v185, v91
  v_dot2_f32_bf16 v90, v186, s47, v90
  v_dot2_f32_bf16 v91, v186, v186, v91
  v_dot2_f32_bf16 v90, v187, s47, v90
  v_dot2_f32_bf16 v91, v187, v187, v91
  s_nop 1
  v_add_f32_dpp v90, v90, v90 quad_perm:[1,0,3,2] row_mask:0xf bank_mask:0xf
  v_add_f32_dpp v91, v91, v91 quad_perm:[1,0,3,2] row_mask:0xf bank_mask:0xf
  s_nop 0
  v_add_f32_dpp v90, v90, v90 quad_perm:[2,3,0,1] row_mask:0xf bank_mask:0xf
  v_add_f32_dpp v91, v91, v91 quad_perm:[2,3,0,1] row_mask:0xf bank_mask:0xf
  s_nop 0
  v_add_f32_dpp v90, v90, v90 row_half_mirror row_mask:0xf bank_mask:0xf
  v_add_f32_dpp v91, v91, v91 row_half_mirror row_mask:0xf bank_mask:0xf
  v_lshlrev_b32 v92, 3, v56
  v_add_u32 v92, 34603008, v92
  s_mov_b32 exec_lo, 0x01010101
  s_mov_b32 exec_hi, 0x01010101
  global_store_dwordx2 v92, v[90:91], s[42:43] sc1
  s_mov_b64 exec, -1
  s_nop 1
  s_lshl_b32 s9, s61, 11
  s_add_u32 s9, s9, 33554432
  v_lshlrev_b32 v5, 3, v0
  v_add_u32 v5, s9, v5
  v_mov_b32 v84, 0
  v_mov_b32 v85, 0
  global_store_dwordx2 v5, v[84:85], s[42:43] sc1
  s_cmp_lt_u32 s2, 224
  s_cbranch_scc1 kpd_7
  s_waitcnt vmcnt(0) lgkmcnt(0)
  s_barrier
  s_cmp_lg_u32 s3, 0
  s_cbranch_scc1 w0_16
  s_mov_b64 exec, 1
  s_and_b32 s9, s2, 3
  s_lshl_b32 s9, s9, 6
  v_mov_b32 v4, s9
  global_atomic_add v4, v12, s[40:41] sc1
  s_mov_b64 exec, -1
w0_16:
  s_branch L_helper
pkp_12:
  s_waitcnt vmcnt(0)
  s_add_u32 m0, s61, 0
  s_nop 0
  global_load_lds_dwordx4 v88, s[44:45] nt
  v_add_u32 v88, s62, v88
  s_add_u32 m0, s61, 1024
  s_nop 0
  global_load_lds_dwordx4 v88, s[44:45] nt
  v_add_u32 v88, s62, v88
  s_add_u32 m0, s61, 2048
  s_nop 0
  global_load_lds_dwordx4 v88, s[44:45] nt
  v_add_u32 v88, s62, v88
  s_add_u32 m0, s61, 3072
  s_nop 0
  global_load_lds_dwordx4 v88, s[44:45] nt
  v_add_u32 v88, s62, v88
  s_add_u32 m0, s61, 4096
  s_nop 0
  global_load_lds_dwordx4 v88, s[44:45] nt
  v_add_u32 v88, s62, v88
  s_add_u32 m0, s61, 5120
  s_nop 0
  global_load_lds_dwordx4 v88, s[44:45] nt
  v_add_u32 v88, s62, v88
  s_add_u32 m0, s61, 6144
  s_nop 0
  global_load_lds_dwordx4 v88, s[44:45] nt
kpd_7:
  v_lshlrev_b32 v39, 16, v61
  v_and_b32 v40, 0xffff0000, v61
  v_mov_b32 v240, -1
  v_mov_b32 v241, -1
  v_mov_b32 v242, -1
  v_mov_b32 v243, -1
  v_lshlrev_b32 v62, 16, v60
  s_lshl_b32 s9, s3, 8
  s_add_u32 s14, s9, 32768
  s_mov_b32 s12, 0
kg1_17:
  s_mov_b32 m0, s14
  v_mul_f32 v72, 0x3fb8aa3b, v62
  v_exp_f32 v72, v72
  v_lshlrev_b32 v64, 16, v64
  v_lshlrev_b32 v65, 16, v65
  v_lshlrev_b32 v66, 16, v66
  v_lshlrev_b32 v67, 16, v67
  v_mul_f32 v64, 0x3fb8aa3b, v64
  v_exp_f32 v64, v64
  v_cvt_pk_bf16_f32 v72, v72, v72
  v_lshlrev_b32 v72, 16, v72
  v_cvt_pk_bf16_f32 v64, v64, v64
  v_lshlrev_b32 v64, 16, v64
  v_mul_f32 v64, v64, v72
  v_mul_f32 v65, v65, v72
  v_mul_f32 v66, v66, v72
  v_mul_f32 v67, v67, v72
  v_mul_f32 v64, 0xbfb8aa3b, v64
  v_mul_f32 v65, 0x3e22f983, v65
  v_mov_b32 v84, v64
  v_fract_f32 v90, v65
  v_mul_f32 v85, 0x41000000, v64
  v_mul_f32 v91, 0x41000000, v65
  v_mul_f32 v86, 0x43800000, v64
  v_mul_f32 v92, 0x43800000, v65
  v_mul_f32 v87, 0x44000000, v64
  v_mul_f32 v93, 0x44000000, v65
  v_mul_f32 v88, 0x44800000, v64
  v_mul_f32 v94, 0x44800000, v65
  v_fract_f32 v91, v91
  v_fract_f32 v92, v92
  v_fract_f32 v93, v93
  v_fract_f32 v94, v94
  v_exp_f32 v84, v84
  v_exp_f32 v85, v85
  v_exp_f32 v86, v86
  v_exp_f32 v87, v87
  v_exp_f32 v88, v88
  v_cos_f32 v74, v90
  v_sin_f32 v75, v90
  v_cos_f32 v76, v91
  v_sin_f32 v77, v91
  v_cos_f32 v78, v92
  v_sin_f32 v79, v92
  v_cos_f32 v80, v93
  v_sin_f32 v81, v93
  v_cos_f32 v82, v94
  v_sin_f32 v83, v94
  v_mul_f32 v74, v74, v84
  v_mul_f32 v75, v75, v84
  v_mul_f32 v76, v76, v85
  v_mul_f32 v77, v77, v85
  v_mul_f32 v78, v78, v86
  v_mul_f32 v79, v79, v86
  v_mul_f32 v80, v80, v87
  v_mul_f32 v81, v81, v87
  v_mul_f32 v82, v82, v88
  v_mul_f32 v83, v83, v88
  v_add_f32 v128, v66, v66
  v_add_f32 v129, v67, v67
  v_pk_mul_f32 v[96:97], v[76:77], v[76:77] op_sel:[0,0] op_sel_hi:[0,1]
  v_pk_mul_f32 v[98:99], v[74:75], v[74:75] op_sel:[0,0] op_sel_hi:[0,1]
  v_pk_mul_f32 v[100:101], v[128:129], v[76:77] op_sel:[0,0] op_sel_hi:[0,1]
  v_pk_fma_f32 v[108:109], v[76:77], v[76:77], v[96:97] op_sel:[1,1,0] op_sel_hi:[1,0,1] neg_lo:[1,0,0]
  v_pk_fma_f32 v[114:115], v[74:75], v[74:75], v[98:99] op_sel:[1,1,0] op_sel_hi:[1,0,1] neg_lo:[1,0,0]
  v_pk_fma_f32 v[130:131], v[128:129], v[76:77], v[100:101] op_sel:[1,1,0] op_sel_hi:[1,0,1] neg_lo:[1,0,0]
  v_mov_b32 v107, 0x3f80
  ds_write_addtid_b32 v107 offset:33280
  v_cvt_pk_bf16_f32 v104, v74, v75
  ds_write_addtid_b32 v104 offset:34320
  v_cvt_pk_bf16_f32 v105, v128, -v129
  ds_write_addtid_b32 v105 offset:0
  v_pk_mul_f32 v[96:97], v[108:109], v[76:77] op_sel:[0,0] op_sel_hi:[0,1]
  v_pk_mul_f32 v[98:99], v[108:109], v[108:109] op_sel:[0,0] op_sel_hi:[0,1]
  v_pk_mul_f32 v[100:101], v[114:115], v[74:75] op_sel:[0,0] op_sel_hi:[0,1]
  v_pk_mul_f32 v[102:103], v[114:115], v[114:115] op_sel:[0,0] op_sel_hi:[0,1]
  v_pk_fma_f32 v[110:111], v[108:109], v[76:77], v[96:97] op_sel:[1,1,0] op_sel_hi:[1,0,1] neg_lo:[1,0,0]
  v_pk_fma_f32 v[112:113], v[108:109], v[108:109], v[98:99] op_sel:[1,1,0] op_sel_hi:[1,0,1] neg_lo:[1,0,0]
  v_pk_fma_f32 v[116:117], v[114:115], v[74:75], v[100:101] op_sel:[1,1,0] op_sel_hi:[1,0,1] neg_lo:[1,0,0]
  v_pk_fma_f32 v[118:119], v[114:115], v[114:115], v[102:103] op_sel:[1,1,0] op_sel_hi:[1,0,1] neg_lo:[1,0,0]
  v_cvt_pk_bf16_f32 v106, v114, v115
  ds_write_addtid_b32 v106 offset:35360
  v_cvt_pk_bf16_f32 v107, v130, -v131
  ds_write_addtid_b32 v107 offset:1040
  v_pk_mul_f32 v[96:97], v[128:129], v[108:109] op_sel:[0,0] op_sel_hi:[0,1]
  v_pk_mul_f32 v[98:99], v[128:129], v[110:111] op_sel:[0,0] op_sel_hi:[0,1]
  v_pk_mul_f32 v[100:101], v[80:81], v[78:79] op_sel:[0,0] op_sel_hi:[0,1]
  v_pk_mul_f32 v[102:103], v[118:119], v[74:75] op_sel:[0,0] op_sel_hi:[0,1]
  v_pk_fma_f32 v[132:133], v[128:129], v[108:109], v[96:97] op_sel:[1,1,0] op_sel_hi:[1,0,1] neg_lo:[1,0,0]
  v_pk_fma_f32 v[134:135], v[128:129], v[110:111], v[98:99] op_sel:[1,1,0] op_sel_hi:[1,0,1] neg_lo:[1,0,0]
  v_pk_fma_f32 v[126:127], v[80:81], v[78:79], v[100:101] op_sel:[1,1,0] op_sel_hi:[1,0,1] neg_lo:[1,0,0]
  v_pk_fma_f32 v[120:121], v[118:119], v[74:75], v[102:103] op_sel:[1,1,0] op_sel_hi:[1,0,1] neg_lo:[1,0,0]
  v_cvt_pk_bf16_f32 v104, v116, v117
  ds_write_addtid_b32 v104 offset:36400
  v_cvt_pk_bf16_f32 v105, v118, v119
  ds_write_addtid_b32 v105 offset:37440
  v_cvt_pk_bf16_f32 v106, v78, v79
  ds_write_addtid_b32 v106 offset:41600
  v_cvt_pk_bf16_f32 v107, v80, v81
  ds_write_addtid_b32 v107 offset:45760
  v_cvt_pk_bf16_f32 v104, v82, v83
  ds_write_addtid_b32 v104 offset:49920
  v_pk_mul_f32 v[96:97], v[118:119], v[114:115] op_sel:[0,0] op_sel_hi:[0,1]
  v_pk_mul_f32 v[98:99], v[118:119], v[116:117] op_sel:[0,0] op_sel_hi:[0,1]
  v_pk_mul_f32 v[100:101], v[78:79], v[114:115] op_sel:[0,0] op_sel_hi:[0,1]
  v_pk_mul_f32 v[102:103], v[78:79], v[118:119] op_sel:[0,0] op_sel_hi:[0,1]
  v_pk_fma_f32 v[122:123], v[118:119], v[114:115], v[96:97] op_sel:[1,1,0] op_sel_hi:[1,0,1] neg_lo:[1,0,0]
  v_pk_fma_f32 v[124:125], v[118:119], v[116:117], v[98:99] op_sel:[1,1,0] op_sel_hi:[1,0,1] neg_lo:[1,0,0]
  v_pk_fma_f32 v[136:137], v[78:79], v[114:115], v[100:101] op_sel:[1,1,0] op_sel_hi:[1,0,1] neg_lo:[1,0,0]
  v_pk_fma_f32 v[138:139], v[78:79], v[118:119], v[102:103] op_sel:[1,1,0] op_sel_hi:[1,0,1] neg_lo:[1,0,0]
  v_cvt_pk_bf16_f32 v105, v132, -v133
  ds_write_addtid_b32 v105 offset:2080
  v_cvt_pk_bf16_f32 v106, v134, -v135
  ds_write_addtid_b32 v106 offset:3120
  v_cvt_pk_bf16_f32 v107, v120, v121
  ds_write_addtid_b32 v107 offset:38480
  v_cvt_pk_bf16_f32 v104, v126, v127
  ds_write_addtid_b32 v104 offset:47840
  v_pk_mul_f32 v[96:97], v[78:79], v[122:123] op_sel:[0,0] op_sel_hi:[0,1]
  v_pk_mul_f32 v[98:99], v[80:81], v[118:119] op_sel:[0,0] op_sel_hi:[0,1]
  v_pk_mul_f32 v[100:101], v[126:127], v[118:119] op_sel:[0,0] op_sel_hi:[0,1]
  v_pk_mul_f32 v[102:103], v[82:83], v[78:79] op_sel:[0,0] op_sel_hi:[0,1]
  v_pk_fma_f32 v[144:145], v[78:79], v[122:123], v[96:97] op_sel:[1,1,0] op_sel_hi:[1,0,1] neg_lo:[1,0,0]
  v_pk_fma_f32 v[146:147], v[80:81], v[118:119], v[98:99] op_sel:[1,1,0] op_sel_hi:[1,0,1] neg_lo:[1,0,0]
  v_pk_fma_f32 v[148:149], v[126:127], v[118:119], v[100:101] op_sel:[1,1,0] op_sel_hi:[1,0,1] neg_lo:[1,0,0]
  v_pk_fma_f32 v[150:151], v[82:83], v[78:79], v[102:103] op_sel:[1,1,0] op_sel_hi:[1,0,1] neg_lo:[1,0,0]
  v_cvt_pk_bf16_f32 v105, v122, v123
  ds_write_addtid_b32 v105 offset:39520
  v_cvt_pk_bf16_f32 v106, v124, v125
  ds_write_addtid_b32 v106 offset:40560
  v_cvt_pk_bf16_f32 v107, v136, v137
  ds_write_addtid_b32 v107 offset:42640
  v_cvt_pk_bf16_f32 v104, v138, v139
  ds_write_addtid_b32 v104 offset:43680
  v_pk_mul_f32 v[96:97], v[82:83], v[80:81] op_sel:[0,0] op_sel_hi:[0,1]
  v_pk_mul_f32 v[98:99], v[82:83], v[126:127] op_sel:[0,0] op_sel_hi:[0,1]
  v_pk_mul_f32 v[100:101], v[82:83], v[82:83] op_sel:[0,0] op_sel_hi:[0,1]
  v_pk_fma_f32 v[136:137], v[82:83], v[80:81], v[96:97] op_sel:[1,1,0] op_sel_hi:[1,0,1] neg_lo:[1,0,0]
  v_pk_fma_f32 v[138:139], v[82:83], v[126:127], v[98:99] op_sel:[1,1,0] op_sel_hi:[1,0,1] neg_lo:[1,0,0]
  v_pk_fma_f32 v[140:141], v[82:83], v[82:83], v[100:101] op_sel:[1,1,0] op_sel_hi:[1,0,1] neg_lo:[1,0,0]
  v_cvt_pk_bf16_f32 v105, v144, v145
  ds_write_addtid_b32 v105 offset:44720
  v_cvt_pk_bf16_f32 v106, v146, v147
  ds_write_addtid_b32 v106 offset:46800
  v_cvt_pk_bf16_f32 v107, v148, v149
  ds_write_addtid_b32 v107 offset:48880
  v_cvt_pk_bf16_f32 v104, v150, v151
  ds_write_addtid_b32 v104 offset:50960
  v_pk_mul_f32 v[96:97], v[128:129], v[112:113] op_sel:[0,0] op_sel_hi:[0,1]
  v_pk_mul_f32 v[98:99], v[130:131], v[112:113] op_sel:[0,0] op_sel_hi:[0,1]
  v_pk_mul_f32 v[100:101], v[132:133], v[112:113] op_sel:[0,0] op_sel_hi:[0,1]
  v_pk_mul_f32 v[102:103], v[134:135], v[112:113] op_sel:[0,0] op_sel_hi:[0,1]
  v_pk_fma_f32 v[152:153], v[128:129], v[112:113], v[96:97] op_sel:[1,1,0] op_sel_hi:[1,0,1] neg_lo:[1,0,0]
  v_pk_fma_f32 v[154:155], v[130:131], v[112:113], v[98:99] op_sel:[1,1,0] op_sel_hi:[1,0,1] neg_lo:[1,0,0]
  v_pk_fma_f32 v[156:157], v[132:133], v[112:113], v[100:101] op_sel:[1,1,0] op_sel_hi:[1,0,1] neg_lo:[1,0,0]
  v_pk_fma_f32 v[158:159], v[134:135], v[112:113], v[102:103] op_sel:[1,1,0] op_sel_hi:[1,0,1] neg_lo:[1,0,0]
  v_cvt_pk_bf16_f32 v105, v136, v137
  ds_write_addtid_b32 v105 offset:52000
  v_cvt_pk_bf16_f32 v106, v138, v139
  ds_write_addtid_b32 v106 offset:53040
  v_cvt_pk_bf16_f32 v107, v140, v141
  ds_write_addtid_b32 v107 offset:54080
  v_pk_mul_f32 v[96:97], v[152:153], v[112:113] op_sel:[0,0] op_sel_hi:[0,1]
  v_pk_mul_f32 v[98:99], v[154:155], v[112:113] op_sel:[0,0] op_sel_hi:[0,1]
  v_pk_mul_f32 v[100:101], v[156:157], v[112:113] op_sel:[0,0] op_sel_hi:[0,1]
  v_pk_mul_f32 v[102:103], v[158:159], v[112:113] op_sel:[0,0] op_sel_hi:[0,1]
  v_pk_fma_f32 v[128:129], v[152:153], v[112:113], v[96:97] op_sel:[1,1,0] op_sel_hi:[1,0,1] neg_lo:[1,0,0]
  v_pk_fma_f32 v[130:131], v[154:155], v[112:113], v[98:99] op_sel:[1,1,0] op_sel_hi:[1,0,1] neg_lo:[1,0,0]
  v_pk_fma_f32 v[132:133], v[156:157], v[112:113], v[100:101] op_sel:[1,1,0] op_sel_hi:[1,0,1] neg_lo:[1,0,0]
  v_pk_fma_f32 v[134:135], v[158:159], v[112:113], v[102:103] op_sel:[1,1,0] op_sel_hi:[1,0,1] neg_lo:[1,0,0]
  v_cvt_pk_bf16_f32 v104, v152, -v153
  ds_write_addtid_b32 v104 offset:4160
  v_cvt_pk_bf16_f32 v105, v154, -v155
  ds_write_addtid_b32 v105 offset:5200
  v_cvt_pk_bf16_f32 v106, v156, -v157
  ds_write_addtid_b32 v106 offset:6240
  v_cvt_pk_bf16_f32 v107, v158, -v159
  ds_write_addtid_b32 v107 offset:7280
  v_pk_mul_f32 v[96:97], v[128:129], v[112:113] op_sel:[0,0] op_sel_hi:[0,1]
  v_pk_mul_f32 v[98:99], v[130:131], v[112:113] op_sel:[0,0] op_sel_hi:[0,1]
  v_pk_mul_f32 v[100:101], v[132:133], v[112:113] op_sel:[0,0] op_sel_hi:[0,1]
  v_pk_mul_f32 v[102:103], v[134:135], v[112:113] op_sel:[0,0] op_sel_hi:[0,1]
  v_pk_fma_f32 v[152:153], v[128:129], v[112:113], v[96:97] op_sel:[1,1,0] op_sel_hi:[1,0,1] neg_lo:[1,0,0]
  v_pk_fma_f32 v[154:155], v[130:131], v[112:113], v[98:99] op_sel:[1,1,0] op_sel_hi:[1,0,1] neg_lo:[1,0,0]
  v_pk_fma_f32 v[156:157], v[132:133], v[112:113], v[100:101] op_sel:[1,1,0] op_sel_hi:[1,0,1] neg_lo:[1,0,0]
  v_pk_fma_f32 v[158:159], v[134:135], v[112:113], v[102:103] op_sel:[1,1,0] op_sel_hi:[1,0,1] neg_lo:[1,0,0]
  v_cvt_pk_bf16_f32 v104, v128, -v129
  ds_write_addtid_b32 v104 offset:8320
  v_cvt_pk_bf16_f32 v105, v130, -v131
  ds_write_addtid_b32 v105 offset:9360
  v_cvt_pk_bf16_f32 v106, v132, -v133
  ds_write_addtid_b32 v106 offset:10400
  v_cvt_pk_bf16_f32 v107, v134, -v135
  ds_write_addtid_b32 v107 offset:11440
  v_pk_mul_f32 v[96:97], v[152:153], v[112:113] op_sel:[0,0] op_sel_hi:[0,1]
  v_pk_mul_f32 v[98:99], v[154:155], v[112:113] op_sel:[0,0] op_sel_hi:[0,1]
  v_pk_mul_f32 v[100:101], v[156:157], v[112:113] op_sel:[0,0] op_sel_hi:[0,1]
  v_pk_mul_f32 v[102:103], v[158:159], v[112:113] op_sel:[0,0] op_sel_hi:[0,1]
  v_pk_fma_f32 v[128:129], v[152:153], v[112:113], v[96:97] op_sel:[1,1,0] op_sel_hi:[1,0,1] neg_lo:[1,0,0]
  v_pk_fma_f32 v[130:131], v[154:155], v[112:113], v[98:99] op_sel:[1,1,0] op_sel_hi:[1,0,1] neg_lo:[1,0,0]
  v_pk_fma_f32 v[132:133], v[156:157], v[112:113], v[100:101] op_sel:[1,1,0] op_sel_hi:[1,0,1] neg_lo:[1,0,0]
  v_pk_fma_f32 v[134:135], v[158:159], v[112:113], v[102:103] op_sel:[1,1,0] op_sel_hi:[1,0,1] neg_lo:[1,0,0]
  v_cvt_pk_bf16_f32 v104, v152, -v153
  ds_write_addtid_b32 v104 offset:12480
  v_cvt_pk_bf16_f32 v105, v154, -v155
  ds_write_addtid_b32 v105 offset:13520
  v_cvt_pk_bf16_f32 v106, v156, -v157
  ds_write_addtid_b32 v106 offset:14560
  v_cvt_pk_bf16_f32 v107, v158, -v159
  ds_write_addtid_b32 v107 offset:15600
  v_pk_mul_f32 v[96:97], v[128:129], v[112:113] op_sel:[0,0] op_sel_hi:[0,1]
  v_pk_mul_f32 v[98:99], v[130:131], v[112:113] op_sel:[0,0] op_sel_hi:[0,1]
  v_pk_mul_f32 v[100:101], v[132:133], v[112:113] op_sel:[0,0] op_sel_hi:[0,1]
  v_pk_mul_f32 v[102:103], v[134:135], v[112:113] op_sel:[0,0] op_sel_hi:[0,1]
  v_pk_fma_f32 v[152:153], v[128:129], v[112:113], v[96:97] op_sel:[1,1,0] op_sel_hi:[1,0,1] neg_lo:[1,0,0]
  v_pk_fma_f32 v[154:155], v[130:131], v[112:113], v[98:99] op_sel:[1,1,0] op_sel_hi:[1,0,1] neg_lo:[1,0,0]
  v_pk_fma_f32 v[156:157], v[132:133], v[112:113], v[100:101] op_sel:[1,1,0] op_sel_hi:[1,0,1] neg_lo:[1,0,0]
  v_pk_fma_f32 v[158:159], v[134:135], v[112:113], v[102:103] op_sel:[1,1,0] op_sel_hi:[1,0,1] neg_lo:[1,0,0]
  v_cvt_pk_bf16_f32 v104, v128, -v129
  ds_write_addtid_b32 v104 offset:16640
  v_cvt_pk_bf16_f32 v105, v130, -v131
  ds_write_addtid_b32 v105 offset:17680
  v_cvt_pk_bf16_f32 v106, v132, -v133
  ds_write_addtid_b32 v106 offset:18720
  v_cvt_pk_bf16_f32 v107, v134, -v135
  ds_write_addtid_b32 v107 offset:19760
  v_pk_mul_f32 v[96:97], v[152:153], v[112:113] op_sel:[0,0] op_sel_hi:[0,1]
  v_pk_mul_f32 v[98:99], v[154:155], v[112:113] op_sel:[0,0] op_sel_hi:[0,1]
  v_pk_mul_f32 v[100:101], v[156:157], v[112:113] op_sel:[0,0] op_sel_hi:[0,1]
  v_pk_mul_f32 v[102:103], v[158:159], v[112:113] op_sel:[0,0] op_sel_hi:[0,1]
  v_pk_fma_f32 v[128:129], v[152:153], v[112:113], v[96:97] op_sel:[1,1,0] op_sel_hi:[1,0,1] neg_lo:[1,0,0]
  v_pk_fma_f32 v[130:131], v[154:155], v[112:113], v[98:99] op_sel:[1,1,0] op_sel_hi:[1,0,1] neg_lo:[1,0,0]
  v_pk_fma_f32 v[132:133], v[156:157], v[112:113], v[100:101] op_sel:[1,1,0] op_sel_hi:[1,0,1] neg_lo:[1,0,0]
  v_pk_fma_f32 v[134:135], v[158:159], v[112:113], v[102:103] op_sel:[1,1,0] op_sel_hi:[1,0,1] neg_lo:[1,0,0]
  v_cvt_pk_bf16_f32 v104, v152, -v153
  ds_write_addtid_b32 v104 offset:20800
  v_cvt_pk_bf16_f32 v105, v154, -v155
  ds_write_addtid_b32 v105 offset:21840
  v_cvt_pk_bf16_f32 v106, v156, -v157
  ds_write_addtid_b32 v106 offset:22880
  v_cvt_pk_bf16_f32 v107, v158, -v159
  ds_write_addtid_b32 v107 offset:23920
  v_pk_mul_f32 v[96:97], v[128:129], v[112:113] op_sel:[0,0] op_sel_hi:[0,1]
  v_pk_mul_f32 v[98:99], v[130:131], v[112:113] op_sel:[0,0] op_sel_hi:[0,1]
  v_pk_mul_f32 v[100:101], v[132:133], v[112:113] op_sel:[0,0] op_sel_hi:[0,1]
  v_pk_mul_f32 v[102:103], v[134:135], v[112:113] op_sel:[0,0] op_sel_hi:[0,1]
  v_pk_fma_f32 v[152:153], v[128:129], v[112:113], v[96:97] op_sel:[1,1,0] op_sel_hi:[1,0,1] neg_lo:[1,0,0]
  v_pk_fma_f32 v[154:155], v[130:131], v[112:113], v[98:99] op_sel:[1,1,0] op_sel_hi:[1,0,1] neg_lo:[1,0,0]
  v_pk_fma_f32 v[156:157], v[132:133], v[112:113], v[100:101] op_sel:[1,1,0] op_sel_hi:[1,0,1] neg_lo:[1,0,0]
  v_pk_fma_f32 v[158:159], v[134:135], v[112:113], v[102:103] op_sel:[1,1,0] op_sel_hi:[1,0,1] neg_lo:[1,0,0]
  v_cvt_pk_bf16_f32 v104, v128, -v129
  ds_write_addtid_b32 v104 offset:24960
  v_cvt_pk_bf16_f32 v105, v130, -v131
  ds_write_addtid_b32 v105 offset:26000
  v_cvt_pk_bf16_f32 v106, v132, -v133
  ds_write_addtid_b32 v106 offset:27040
  v_cvt_pk_bf16_f32 v107, v134, -v135
  ds_write_addtid_b32 v107 offset:28080
  v_cvt_pk_bf16_f32 v104, v152, -v153
  ds_write_addtid_b32 v104 offset:29120
  v_cvt_pk_bf16_f32 v105, v154, -v155
  ds_write_addtid_b32 v105 offset:30160
  v_cvt_pk_bf16_f32 v106, v156, -v157
  ds_write_addtid_b32 v106 offset:31200
  v_cvt_pk_bf16_f32 v107, v158, -v159
  ds_write_addtid_b32 v107 offset:32240
  v_mov_b32 v64, v68
  v_mov_b32 v65, v69
  v_mov_b32 v66, v70
  v_mov_b32 v67, v71
  v_and_b32 v62, 0xffff0000, v60
  s_add_u32 s14, s14, 55120
  s_add_u32 s12, s12, 1
  s_cmp_eq_u32 s12, 2
  s_cbranch_scc1 kg1_17_done
  s_cmp_lt_u32 s2, 168
  s_cbranch_scc1 dopk_18
  s_waitcnt vmcnt(0) lgkmcnt(0)
  s_barrier
  s_cmp_lg_u32 s3, 0
  s_cbranch_scc1 w0_19
  s_mov_b64 exec, 1
  s_and_b32 s9, s2, 3
  s_lshl_b32 s9, s9, 6
  v_mov_b32 v4, s9
  global_atomic_add v4, v12, s[40:41] sc1
  s_mov_b64 exec, -1
w0_19:
dopk_18:
  s_branch kg1_17
kg1_17_done:
  s_cmp_ge_u32 s2, 168
  s_cbranch_scc1 pkd_20
  s_waitcnt vmcnt(0)
  ds_read_b64_tr_b16 v[128:129], v7 offset:0
  ds_read_b64_tr_b16 v[130:131], v8 offset:0
  ds_read_b64_tr_b16 v[132:133], v7 offset:1024
  ds_read_b64_tr_b16 v[134:135], v8 offset:1024
  ds_read_b64_tr_b16 v[136:137], v7 offset:2048
  ds_read_b64_tr_b16 v[138:139], v8 offset:2048
  ds_read_b64_tr_b16 v[140:141], v7 offset:3072
  ds_read_b64_tr_b16 v[142:143], v8 offset:3072
  ds_read_b64_tr_b16 v[144:145], v7 offset:4096
  ds_read_b64_tr_b16 v[146:147], v8 offset:4096
  ds_read_b64_tr_b16 v[148:149], v7 offset:5120
  ds_read_b64_tr_b16 v[150:151], v8 offset:5120
  ds_read_b64_tr_b16 v[152:153], v7 offset:6144
  ds_read_b64_tr_b16 v[154:155], v8 offset:6144
  v_mov_b32 v90, 0
  v_mov_b32 v91, 0
  s_waitcnt lgkmcnt(12)
  v_dot2_f32_bf16 v90, v128, s47, v90
  v_dot2_f32_bf16 v91, v129, s47, v91
  v_dot2_f32_bf16 v90, v130, s47, v90
  v_dot2_f32_bf16 v91, v131, s47, v91
  s_waitcnt lgkmcnt(10)
  v_dot2_f32_bf16 v90, v132, s47, v90
  v_dot2_f32_bf16 v91, v133, s47, v91
  v_dot2_f32_bf16 v90, v134, s47, v90
  v_dot2_f32_bf16 v91, v135, s47, v91
  s_waitcnt lgkmcnt(8)
  v_dot2_f32_bf16 v90, v136, s47, v90
  v_dot2_f32_bf16 v91, v137, s47, v91
  v_dot2_f32_bf16 v90, v138, s47, v90
  v_dot2_f32_bf16 v91, v139, s47, v91
  s_waitcnt lgkmcnt(6)
  v_dot2_f32_bf16 v90, v140, s47, v90
  v_dot2_f32_bf16 v91, v141, s47, v91
  v_dot2_f32_bf16 v90, v142, s47, v90
  v_dot2_f32_bf16 v91, v143, s47, v91
  s_waitcnt lgkmcnt(4)
  v_dot2_f32_bf16 v90, v144, s47, v90
  v_dot2_f32_bf16 v91, v145, s47, v91
  v_dot2_f32_bf16 v90, v146, s47, v90
  v_dot2_f32_bf16 v91, v147, s47, v91
  s_waitcnt lgkmcnt(2)
  v_dot2_f32_bf16 v90, v148, s47, v90
  v_dot2_f32_bf16 v91, v149, s47, v91
  v_dot2_f32_bf16 v90, v150, s47, v90
  v_dot2_f32_bf16 v91, v151, s47, v91
  s_waitcnt lgkmcnt(0)
  v_dot2_f32_bf16 v90, v152, s47, v90
  v_dot2_f32_bf16 v91, v153, s47, v91
  v_dot2_f32_bf16 v90, v154, s47, v90
  v_dot2_f32_bf16 v91, v155, s47, v91
  s_nop 2
  v_add_f32 v90, v90, v91
  s_nop 1
  v_mov_b32 v91, v90
  s_nop 1
  v_permlane32_swap_b32 v90, v91
  s_nop 1
  v_add_f32 v90, v90, v91
  v_and_b32 v92, 31, v1
  v_lshlrev_b32 v92, 2, v92
  s_lshl_b32 s9, s3, 7
  v_add_u32 v93, s9, v92
  ds_write_b32 v93, v90 offset:28672
  s_waitcnt lgkmcnt(0)
  s_barrier
  ds_read_b32 v94, v92 offset:28672
  ds_read_b32 v95, v92 offset:28800
  ds_read_b32 v96, v92 offset:28928
  ds_read_b32 v97, v92 offset:29056
  s_mul_i32 s9, s3, 14336
  s_add_u32 s9, s9, s60
  v_add_u32 v5, s9, v2
  s_waitcnt lgkmcnt(0)
  v_add_f32 v94, v94, v95
  v_add_f32 v96, v96, v97
  v_add_f32 v94, v94, v96
  v_mul_f32 v90, s59, v94
  v_lshlrev_b32 v96, 16, v128
  v_and_b32 v97, 0xffff0000, v128
  v_lshlrev_b32 v98, 16, v129
  v_and_b32 v99, 0xffff0000, v129
  v_lshlrev_b32 v100, 16, v130
  v_and_b32 v101, 0xffff0000, v130
  v_lshlrev_b32 v102, 16, v131
  v_and_b32 v103, 0xffff0000, v131
  v_sub_f32 v96, v96, v90
  v_sub_f32 v97, v97, v90
  v_sub_f32 v98, v98, v90
  v_sub_f32 v99, v99, v90
  v_sub_f32 v100, v100, v90
  v_sub_f32 v101, v101, v90
  v_sub_f32 v102, v102, v90
  v_sub_f32 v103, v103, v90
  v_cvt_pk_bf16_f32 v128, v96, v97
  v_cvt_pk_bf16_f32 v129, v98, v99
  v_cvt_pk_bf16_f32 v130, v100, v101
  v_cvt_pk_bf16_f32 v131, v102, v103
  global_store_dwordx4 v5, v[128:131], s[42:43] offset:0 sc1
  v_lshlrev_b32 v96, 16, v132
  v_and_b32 v97, 0xffff0000, v132
  v_lshlrev_b32 v98, 16, v133
  v_and_b32 v99, 0xffff0000, v133
  v_lshlrev_b32 v100, 16, v134
  v_and_b32 v101, 0xffff0000, v134
  v_lshlrev_b32 v102, 16, v135
  v_and_b32 v103, 0xffff0000, v135
  v_sub_f32 v96, v96, v90
  v_sub_f32 v97, v97, v90
  v_sub_f32 v98, v98, v90
  v_sub_f32 v99, v99, v90
  v_sub_f32 v100, v100, v90
  v_sub_f32 v101, v101, v90
  v_sub_f32 v102, v102, v90
  v_sub_f32 v103, v103, v90
  v_cvt_pk_bf16_f32 v132, v96, v97
  v_cvt_pk_bf16_f32 v133, v98, v99
  v_cvt_pk_bf16_f32 v134, v100, v101
  v_cvt_pk_bf16_f32 v135, v102, v103
  global_store_dwordx4 v5, v[132:135], s[42:43] offset:2048 sc1
  v_add_u32 v5, 4096, v5
  v_lshlrev_b32 v96, 16, v136
  v_and_b32 v97, 0xffff0000, v136
  v_lshlrev_b32 v98, 16, v137
  v_and_b32 v99, 0xffff0000, v137
  v_lshlrev_b32 v100, 16, v138
  v_and_b32 v101, 0xffff0000, v138
  v_lshlrev_b32 v102, 16, v139
  v_and_b32 v103, 0xffff0000, v139
  v_sub_f32 v96, v96, v90
  v_sub_f32 v97, v97, v90
  v_sub_f32 v98, v98, v90
  v_sub_f32 v99, v99, v90
  v_sub_f32 v100, v100, v90
  v_sub_f32 v101, v101, v90
  v_sub_f32 v102, v102, v90
  v_sub_f32 v103, v103, v90
  v_cvt_pk_bf16_f32 v136, v96, v97
  v_cvt_pk_bf16_f32 v137, v98, v99
  v_cvt_pk_bf16_f32 v138, v100, v101
  v_cvt_pk_bf16_f32 v139, v102, v103
  global_store_dwordx4 v5, v[136:139], s[42:43] offset:0 sc1
  v_lshlrev_b32 v96, 16, v140
  v_and_b32 v97, 0xffff0000, v140
  v_lshlrev_b32 v98, 16, v141
  v_and_b32 v99, 0xffff0000, v141
  v_lshlrev_b32 v100, 16, v142
  v_and_b32 v101, 0xffff0000, v142
  v_lshlrev_b32 v102, 16, v143
  v_and_b32 v103, 0xffff0000, v143
  v_sub_f32 v96, v96, v90
  v_sub_f32 v97, v97, v90
  v_sub_f32 v98, v98, v90
  v_sub_f32 v99, v99, v90
  v_sub_f32 v100, v100, v90
  v_sub_f32 v101, v101, v90
  v_sub_f32 v102, v102, v90
  v_sub_f32 v103, v103, v90
  v_cvt_pk_bf16_f32 v140, v96, v97
  v_cvt_pk_bf16_f32 v141, v98, v99
  v_cvt_pk_bf16_f32 v142, v100, v101
  v_cvt_pk_bf16_f32 v143, v102, v103
  global_store_dwordx4 v5, v[140:143], s[42:43] offset:2048 sc1
  v_add_u32 v5, 4096, v5
  v_lshlrev_b32 v96, 16, v144
  v_and_b32 v97, 0xffff0000, v144
  v_lshlrev_b32 v98, 16, v145
  v_and_b32 v99, 0xffff0000, v145
  v_lshlrev_b32 v100, 16, v146
  v_and_b32 v101, 0xffff0000, v146
  v_lshlrev_b32 v102, 16, v147
  v_and_b32 v103, 0xffff0000, v147
  v_sub_f32 v96, v96, v90
  v_sub_f32 v97, v97, v90
  v_sub_f32 v98, v98, v90
  v_sub_f32 v99, v99, v90
  v_sub_f32 v100, v100, v90
  v_sub_f32 v101, v101, v90
  v_sub_f32 v102, v102, v90
  v_sub_f32 v103, v103, v90
  v_cvt_pk_bf16_f32 v144, v96, v97
  v_cvt_pk_bf16_f32 v145, v98, v99
  v_cvt_pk_bf16_f32 v146, v100, v101
  v_cvt_pk_bf16_f32 v147, v102, v103
  global_store_dwordx4 v5, v[144:147], s[42:43] offset:0 sc1
  v_lshlrev_b32 v96, 16, v148
  v_and_b32 v97, 0xffff0000, v148
  v_lshlrev_b32 v98, 16, v149
  v_and_b32 v99, 0xffff0000, v149
  v_lshlrev_b32 v100, 16, v150
  v_and_b32 v101, 0xffff0000, v150
  v_lshlrev_b32 v102, 16, v151
  v_and_b32 v103, 0xffff0000, v151
  v_sub_f32 v96, v96, v90
  v_sub_f32 v97, v97, v90
  v_sub_f32 v98, v98, v90
  v_sub_f32 v99, v99, v90
  v_sub_f32 v100, v100, v90
  v_sub_f32 v101, v101, v90
  v_sub_f32 v102, v102, v90
  v_sub_f32 v103, v103, v90
  v_cvt_pk_bf16_f32 v148, v96, v97
  v_cvt_pk_bf16_f32 v149, v98, v99
  v_cvt_pk_bf16_f32 v150, v100, v101
  v_cvt_pk_bf16_f32 v151, v102, v103
  global_store_dwordx4 v5, v[148:151], s[42:43] offset:2048 sc1
  v_add_u32 v5, 4096, v5
  v_lshlrev_b32 v96, 16, v152
  v_and_b32 v97, 0xffff0000, v152
  v_lshlrev_b32 v98, 16, v153
  v_and_b32 v99, 0xffff0000, v153
  v_lshlrev_b32 v100, 16, v154
  v_and_b32 v101, 0xffff0000, v154
  v_lshlrev_b32 v102, 16, v155
  v_and_b32 v103, 0xffff0000, v155
  v_sub_f32 v96, v96, v90
  v_sub_f32 v97, v97, v90
  v_sub_f32 v98, v98, v90
  v_sub_f32 v99, v99, v90
  v_sub_f32 v100, v100, v90
  v_sub_f32 v101, v101, v90
  v_sub_f32 v102, v102, v90
  v_sub_f32 v103, v103, v90
  v_cvt_pk_bf16_f32 v152, v96, v97
  v_cvt_pk_bf16_f32 v153, v98, v99
  v_cvt_pk_bf16_f32 v154, v100, v101
  v_cvt_pk_bf16_f32 v155, v102, v103
  global_store_dwordx4 v5, v[152:155], s[42:43] offset:0 sc1
pkd_20:
  s_waitcnt lgkmcnt(0)
  s_barrier
  s_lshr_b32 s9, s3, 1
  s_mul_i32 s9, s9, 55120
  s_and_b32 s10, s3, 1
  s_lshl_b32 s11, s10, 9
  s_add_u32 s9, s9, s11
  s_add_u32 s9, s9, 32768
  v_and_b32 v4, 31, v1
  v_mul_u32_u24 v4, 1040, v4
  v_lshrrev_b32 v5, 5, v1
  v_lshlrev_b32 v5, 4, v5
  v_add3_u32 v4, v4, v5, s9
  ds_read_b128 v[96:99], v4 offset:0
  ds_read_b128 v[100:103], v4 offset:33280
  ds_read_b128 v[104:107], v4 offset:32
  ds_read_b128 v[108:111], v4 offset:33312
  ds_read_b128 v[112:115], v4 offset:64
  ds_read_b128 v[116:119], v4 offset:33344
  ds_read_b128 v[120:123], v4 offset:96
  ds_read_b128 v[124:127], v4 offset:33376
  ds_read_b128 v[128:131], v4 offset:128
  ds_read_b128 v[132:135], v4 offset:33408
  ds_read_b128 v[136:139], v4 offset:160
  ds_read_b128 v[140:143], v4 offset:33440
  ds_read_b128 v[144:147], v4 offset:192
  ds_read_b128 v[148:151], v4 offset:33472
  ds_read_b128 v[152:155], v4 offset:224
  ds_read_b128 v[156:159], v4 offset:33504
  ds_read_b128 v[160:163], v4 offset:256
  ds_read_b128 v[164:167], v4 offset:33536
  ds_read_b128 v[168:171], v4 offset:288
  ds_read_b128 v[172:175], v4 offset:33568
  ds_read_b128 v[176:179], v4 offset:320
  ds_read_b128 v[180:183], v4 offset:33600
  ds_read_b128 v[184:187], v4 offset:352
  ds_read_b128 v[188:191], v4 offset:33632
  ds_read_b128 v[192:195], v4 offset:384
  ds_read_b128 v[196:199], v4 offset:33664
  ds_read_b128 v[200:203], v4 offset:416
  ds_read_b128 v[204:207], v4 offset:33696
  ds_read_b128 v[208:211], v4 offset:448
  ds_read_b128 v[212:215], v4 offset:33728
  ds_read_b128 v[216:219], v4 offset:480
  ds_read_b128 v[220:223], v4 offset:33760
  v_and_b32 v82, 31, v1
  v_mov_b32 v80, v82
  v_lshlrev_b32 v83, 1, v82
  v_add_u32 v83, 240, v83
  v_cmp_le_u32 vcc, 8, v82
  s_nop 1
  v_cndmask_b32 v80, v80, v83, vcc
  v_and_b32 v83, 1, v82
  v_lshlrev_b32 v83, 2, v83
  v_bfe_u32 v84, v82, 1, 1
  v_lshlrev_b32 v84, 8, v84
  v_add3_u32 v83, v83, v84, 0
  v_add_u32 v83, 512, v83
  v_cmp_le_u32 vcc, 12, v82
  s_nop 1
  v_cndmask_b32 v80, v80, v83, vcc
  v_lshlrev_b32 v83, 8, v82
  v_subrev_u32 v83, 3072, v83
  v_cmp_le_u32 vcc, 16, v82
  s_nop 1
  v_cndmask_b32 v80, v80, v83, vcc
  v_cvt_f32_u32 v80, v80
  v_mov_b32 v81, 0x41000000
  v_mov_b32 v83, 0x41800000
  v_cmp_le_u32 vcc, 20, v82
  s_nop 1
  v_cndmask_b32 v81, v81, v83, vcc
  v_lshrrev_b32 v83, 5, v1
  v_lshlrev_b32 v83, 2, v83
  s_lshl_b32 s11, s10, 4
  v_add_u32 v83, s11, v83
  v_cvt_f32_u32 v83, v83
  v_fma_f32 v84, v81, v83, v80
  v_add_f32 v85, v84, v81
  v_add_f32 v86, v85, v81
  v_add_f32 v87, v86, v81
  s_mov_b32 s11, 0x41000000
  v_fma_f32 v88, v81, s11, v84
  v_fma_f32 v89, v81, s11, v85
  v_fma_f32 v90, v81, s11, v86
  v_fma_f32 v91, v81, s11, v87
  s_mov_b32 s11, 0x45010000
  v_med3_f32 v84, v84, 0.5, s11
  v_med3_f32 v85, v85, 0.5, s11
  v_med3_f32 v86, v86, 0.5, s11
  v_med3_f32 v87, v87, 0.5, s11
  v_med3_f32 v88, v88, 0.5, s11
  v_med3_f32 v89, v89, 0.5, s11
  v_med3_f32 v90, v90, 0.5, s11
  v_med3_f32 v91, v91, 0.5, s11
  v_cvt_pk_bf16_f32 v84, v84, v85
  v_cvt_pk_bf16_f32 v86, v86, v87
  v_cvt_pk_bf16_f32 v88, v88, v89
  v_cvt_pk_bf16_f32 v90, v90, v91
  v_lshrrev_b32 v85, 15, v84
  v_lshlrev_b16 v84, 1, v84
  v_lshrrev_b32 v87, 15, v86
  v_lshlrev_b16 v86, 1, v86
  v_lshrrev_b32 v89, 15, v88
  v_lshlrev_b16 v88, 1, v88
  v_lshrrev_b32 v91, 15, v90
  v_lshlrev_b16 v90, 1, v90
  s_lshr_b32 s9, s3, 1
  s_lshl_b32 s9, s9, 12
  s_add_u32 s9, s9, 1024
  v_add_u32 v84, s9, v84
  v_add_u32 v85, s9, v85
  v_add_u32 v86, s9, v86
  v_add_u32 v87, s9, v87
  v_add_u32 v88, s9, v88
  v_add_u32 v89, s9, v89
  v_add_u32 v90, s9, v90
  v_add_u32 v91, s9, v91
  s_waitcnt lgkmcnt(15)
  v_mfma_f32_32x32x16_bf16 v[64:79], v[96:99], v[100:103], 0
  v_mfma_f32_32x32x16_bf16 v[64:79], v[104:107], v[108:111], v[64:79]
  v_mfma_f32_32x32x16_bf16 v[64:79], v[112:115], v[116:119], v[64:79]
  v_mfma_f32_32x32x16_bf16 v[64:79], v[120:123], v[124:127], v[64:79]
  v_mfma_f32_32x32x16_bf16 v[64:79], v[128:131], v[132:135], v[64:79]
  v_mfma_f32_32x32x16_bf16 v[64:79], v[136:139], v[140:143], v[64:79]
  v_mfma_f32_32x32x16_bf16 v[64:79], v[144:147], v[148:151], v[64:79]
  v_mfma_f32_32x32x16_bf16 v[64:79], v[152:155], v[156:159], v[64:79]
  s_waitcnt lgkmcnt(14)
  v_mfma_f32_32x32x16_bf16 v[64:79], v[160:163], v[164:167], v[64:79]
  s_waitcnt lgkmcnt(12)
  v_mfma_f32_32x32x16_bf16 v[64:79], v[168:171], v[172:175], v[64:79]
  s_waitcnt lgkmcnt(10)
  v_mfma_f32_32x32x16_bf16 v[64:79], v[176:179], v[180:183], v[64:79]
  s_waitcnt lgkmcnt(8)
  v_mfma_f32_32x32x16_bf16 v[64:79], v[184:187], v[188:191], v[64:79]
  s_waitcnt lgkmcnt(6)
  v_mfma_f32_32x32x16_bf16 v[64:79], v[192:195], v[196:199], v[64:79]
  s_waitcnt lgkmcnt(4)
  v_mfma_f32_32x32x16_bf16 v[64:79], v[200:203], v[204:207], v[64:79]
  s_waitcnt lgkmcnt(2)
  v_mfma_f32_32x32x16_bf16 v[64:79], v[208:211], v[212:215], v[64:79]
  s_waitcnt lgkmcnt(0)
  v_mfma_f32_32x32x16_bf16 v[64:79], v[216:219], v[220:223], v[64:79]
  s_xor_b32 s11, s3, 1
  s_lshl_b32 s11, s11, 11
  v_add_u32 v4, s11, v2
  s_lshl_b32 s11, s3, 11
  v_add_u32 v5, s11, v2
  s_cmp_eq_u32 s10, 0
  s_nop 4
  s_cbranch_scc0 snd1_21
  s_nop 4
  ds_write_b128 v4, v[72:75] offset:16640
  ds_write_b128 v4, v[76:79] offset:17664
  s_branch snd2_22
snd1_21:
  ds_write_b128 v4, v[64:67] offset:16640
  ds_write_b128 v4, v[68:71] offset:17664
  v_mov_b32 v64, v72
  v_mov_b32 v65, v73
  v_mov_b32 v66, v74
  v_mov_b32 v67, v75
  v_mov_b32 v68, v76
  v_mov_b32 v69, v77
  v_mov_b32 v70, v78
  v_mov_b32 v71, v79
snd2_22:
  s_waitcnt lgkmcnt(0)
  s_barrier
  ds_read_b128 v[72:75], v5 offset:16640
  ds_read_b128 v[76:79], v5 offset:17664
  s_cmp_lg_u32 s3, 0
  s_cbranch_scc1 w0_23
  global_load_dword v42, v41, s[40:41] sc1
w0_23:
  s_add_u32 s14, s5, 0
  s_mul_i32 s14, s14, 114688
  s_add_u32 s14, s14, 16777216
  v_add_u32 v6, s14, v28
  global_store_dwordx4 v6, v[240:243], s[42:43] offset:0 sc1
  global_store_dwordx4 v6, v[240:243], s[42:43] offset:1024 sc1
  s_add_u32 s14, s5, 16
  s_mul_i32 s14, s14, 114688
  s_add_u32 s14, s14, 16777216
  v_add_u32 v6, s14, v28
  global_store_dwordx4 v6, v[240:243], s[42:43] offset:0 sc1
  global_store_dwordx4 v6, v[240:243], s[42:43] offset:1024 sc1
  s_add_u32 s14, s5, 32
  s_mul_i32 s14, s14, 114688
  s_add_u32 s14, s14, 16777216
  v_add_u32 v6, s14, v28
  global_store_dwordx4 v6, v[240:243], s[42:43] offset:0 sc1
  global_store_dwordx4 v6, v[240:243], s[42:43] offset:1024 sc1
  s_add_u32 s14, s5, 48
  s_mul_i32 s14, s14, 114688
  s_add_u32 s14, s14, 16777216
  v_add_u32 v6, s14, v28
  global_store_dwordx4 v6, v[240:243], s[42:43] offset:0 sc1
  global_store_dwordx4 v6, v[240:243], s[42:43] offset:1024 sc1
  v_mov_b32 v92, s9
  v_mov_b32 v93, 0
  s_waitcnt lgkmcnt(0)
  v_add_f32 v64, v64, v72
  v_add_f32 v65, v65, v73
  v_add_f32 v66, v66, v74
  v_add_f32 v67, v67, v75
  v_add_f32 v68, v68, v76
  v_add_f32 v69, v69, v77
  v_add_f32 v70, v70, v78
  v_add_f32 v71, v71, v79
  v_cvt_pk_bf16_f32 v64, v64, v65
  v_cvt_pk_bf16_f32 v65, v66, v67
  v_cvt_pk_bf16_f32 v66, v68, v69
  v_cvt_pk_bf16_f32 v67, v70, v71
  ds_write_b16 v84, v64
  ds_write_b16_d16_hi v85, v64
  ds_write_b16 v86, v65
  ds_write_b16_d16_hi v87, v65
  ds_write_b16 v88, v66
  ds_write_b16_d16_hi v89, v66
  ds_write_b16 v90, v67
  ds_write_b16_d16_hi v91, v67
  ds_write_b16 v92, v93 offset:32000
  v_lshrrev_b32 v4, 7, v0
  v_and_b32 v5, 127, v0
  v_lshlrev_b32 v6, 12, v4
  v_add_u32 v6, 1024, v6
  v_mul_u32_u24 v7, 8320, v4
  v_lshlrev_b32 v8, 4, v5
  v_add_u32 v7, v7, v8
  v_lshlrev_b32 v8, 3, v5
  v_sub_u32 v8, 2047, v8
  v_cvt_f32_u32 v8, v8
  v_mov_b32 v96, v8
  v_add_f32 v97, -1.0, v96
  v_add_f32 v98, -1.0, v97
  v_add_f32 v99, -1.0, v98
  v_add_f32 v100, -1.0, v99
  v_add_f32 v101, -1.0, v100
  v_add_f32 v102, -1.0, v101
  v_add_f32 v103, -1.0, v102
  v_add_f32 v104, -1.0, v103
  v_add_f32 v105, -1.0, v104
  v_cvt_pk_bf16_f32 v96, v96, v97
  v_cvt_pk_bf16_f32 v98, v98, v99
  v_cvt_pk_bf16_f32 v100, v100, v101
  v_cvt_pk_bf16_f32 v102, v102, v103
  v_cvt_pk_bf16_f32 v104, v104, v105
  v_lshrrev_b32 v97, 15, v96
  v_lshlrev_b16 v96, 1, v96
  v_lshrrev_b32 v99, 15, v98
  v_lshlrev_b16 v98, 1, v98
  v_lshrrev_b32 v101, 15, v100
  v_lshlrev_b16 v100, 1, v100
  v_lshrrev_b32 v103, 15, v102
  v_lshlrev_b16 v102, 1, v102
  v_lshrrev_b32 v105, 15, v104
  v_lshlrev_b16 v104, 1, v104
  v_add_u32 v96, v6, v96
  v_add_u32 v97, v6, v97
  v_add_u32 v98, v6, v98
  v_add_u32 v99, v6, v99
  v_add_u32 v100, v6, v100
  v_add_u32 v101, v6, v101
  v_add_u32 v102, v6, v102
  v_add_u32 v103, v6, v103
  v_add_u32 v104, v6, v104
  v_subrev_f32 v8, 0x44800000, v8
  v_mov_b32 v112, v8
  v_add_f32 v113, -1.0, v112
  v_add_f32 v114, -1.0, v113
  v_add_f32 v115, -1.0, v114
  v_add_f32 v116, -1.0, v115
  v_add_f32 v117, -1.0, v116
  v_add_f32 v118, -1.0, v117
  v_add_f32 v119, -1.0, v118
  v_add_f32 v120, -1.0, v119
  v_add_f32 v121, -1.0, v120
  v_mov_b32 v77, 0x3e800000
  v_fma_f32 v76, v119, v77, 0.5
  v_max_f32 v119, v119, v76
  v_fma_f32 v76, v120, v77, 0.5
  v_max_f32 v120, v120, v76
  v_fma_f32 v76, v121, v77, 0.5
  v_max_f32 v121, v121, v76
  v_max_f32 v121, 0.5, v121
  v_cvt_pk_bf16_f32 v112, v112, v113
  v_cvt_pk_bf16_f32 v114, v114, v115
  v_cvt_pk_bf16_f32 v116, v116, v117
  v_cvt_pk_bf16_f32 v118, v118, v119
  v_cvt_pk_bf16_f32 v120, v120, v121
  v_lshrrev_b32 v113, 15, v112
  v_lshlrev_b16 v112, 1, v112
  v_lshrrev_b32 v115, 15, v114
  v_lshlrev_b16 v114, 1, v114
  v_lshrrev_b32 v117, 15, v116
  v_lshlrev_b16 v116, 1, v116
  v_lshrrev_b32 v119, 15, v118
  v_lshlrev_b16 v118, 1, v118
  v_lshrrev_b32 v121, 15, v120
  v_lshlrev_b16 v120, 1, v120
  v_add_u32 v112, v6, v112
  v_add_u32 v113, v6, v113
  v_add_u32 v114, v6, v114
  v_add_u32 v115, v6, v115
  v_add_u32 v116, v6, v116
  v_add_u32 v117, v6, v117
  v_add_u32 v118, v6, v118
  v_add_u32 v119, v6, v119
  v_add_u32 v120, v6, v120
  s_waitcnt vmcnt(8)
  s_waitcnt lgkmcnt(0)
  s_cmp_lg_u32 s3, 0
  s_cbranch_scc1 w0_26
  v_cmp_gt_u32 vcc, 16, v42
  s_nop 0
  s_cbranch_vccnz sps1a_24
bks1a_25:
w0_26:
  s_barrier
  s_cmp_lg_u32 s3, 0
  s_cbranch_scc1 sg_27
  s_add_u32 s14, s53, 0
  v_add_u32 v9, s14, v13
  s_mov_b64 exec, 0xff
  global_atomic_add v9, v12, s[42:43] sc1
  s_mov_b64 exec, -1
sg_27:
  v_and_b32 v4, 3, v1
  v_cmp_eq_u32 vcc, 2, v4
  v_mov_b32 v4, 128
  s_nop 0
  v_cndmask_b32 v4, 0, v4, vcc
  v_and_b32 v5, 0x3c, v1
  s_and_b32 s9, s3, 1
  s_lshl_b32 s9, s9, 6
  s_add_u32 s9, s9, 147456
  v_add3_u32 v13, v4, v5, s9
  v_add_u32 v4, 6291456, v10
  v_add_u32 v5, 34603008, v11
  global_load_dwordx2 v[44:45], v4, s[42:43] sc1
  global_load_dwordx2 v[46:47], v4, s[42:43] offset:64 sc1
  global_load_dwordx4 v[48:51], v5, s[42:43] sc1
  global_load_dwordx4 v[52:55], v5, s[42:43] offset:16 sc1
  v_add_u32 v8, 7208960, v10
  v_add_u32 v9, 34611200, v11
  global_load_dwordx2 v[56:57], v8, s[42:43] sc1
  global_load_dwordx2 v[58:59], v8, s[42:43] offset:64 sc1
  global_load_dwordx4 v[84:87], v9, s[42:43] sc1
  global_load_dwordx4 v[88:91], v9, s[42:43] offset:16 sc1
  ds_read_u16 v128, v96
  ds_read_u16 v129, v97
  ds_read_u16 v130, v98
  ds_read_u16 v131, v99
  ds_read_u16 v132, v100
  ds_read_u16 v133, v101
  ds_read_u16 v134, v102
  ds_read_u16 v135, v103
  ds_read_u16 v136, v104
  ds_read_u16 v138, v112
  ds_read_u16 v139, v113
  ds_read_u16 v140, v114
  ds_read_u16 v141, v115
  ds_read_u16 v142, v116
  ds_read_u16 v143, v117
  ds_read_u16 v144, v118
  ds_read_u16 v145, v119
  ds_read_u16 v146, v120
  s_waitcnt lgkmcnt(0)
  v_lshl_or_b32 v96, v129, 16, v128
  v_lshl_or_b32 v100, v130, 16, v129
  v_lshl_or_b32 v97, v131, 16, v130
  v_lshl_or_b32 v101, v132, 16, v131
  v_lshl_or_b32 v98, v133, 16, v132
  v_lshl_or_b32 v102, v134, 16, v133
  v_lshl_or_b32 v99, v135, 16, v134
  v_lshl_or_b32 v103, v136, 16, v135
  ds_write_b128 v7, v[96:99] offset:0
  ds_write_b128 v7, v[100:103] offset:4160
  v_lshl_or_b32 v104, v139, 16, v138
  v_lshl_or_b32 v108, v140, 16, v139
  v_lshl_or_b32 v105, v141, 16, v140
  v_lshl_or_b32 v109, v142, 16, v141
  v_lshl_or_b32 v106, v143, 16, v142
  v_lshl_or_b32 v110, v144, 16, v143
  v_lshl_or_b32 v107, v145, 16, v144
  v_lshl_or_b32 v111, v146, 16, v145
  ds_write_b128 v7, v[104:107] offset:2048
  ds_write_b128 v7, v[108:111] offset:6208
  v_and_b32 v4, 1, v0
  v_lshlrev_b32 v4, 4, v4
  v_bfe_u32 v5, v0, 1, 1
  v_mul_u32_u24 v5, 4160, v5
  v_bfe_u32 v6, v0, 2, 1
  v_mul_u32_u24 v6, 8320, v6
  v_add3_u32 v4, v4, v5, v6
  v_mov_b32 v64, 0
  v_mov_b32 v65, 0
  v_mov_b32 v66, 0
  v_mov_b32 v67, 0
  ds_write_b128 v4, v[64:67] offset:4096
  v_and_b32 v8, 31, v0
  v_min_u32 v8, 29, v8
  v_lshlrev_b32 v8, 4, v8
  v_bfe_u32 v9, v0, 5, 1
  v_mul_u32_u24 v9, 4608, v9
  v_add_u32 v8, v8, v9
  ds_write_b128 v8, v[64:67] offset:16640
  s_waitcnt lgkmcnt(0)
  s_barrier
  s_lshl_b32 s9, s6, 2
  s_add_u32 s9, s9, s3
  s_mul_i32 s58, s9, 57344
  s_mul_i32 s59, s7, 229376
  s_mul_i32 s9, s3, 57344
  s_add_u32 s59, s59, s9
  s_add_u32 s59, s59, 3211264
  s_mul_i32 s62, s3, 7168
  s_add_u32 s14, s3, 1
  s_and_b32 s14, s14, 3
  s_mul_i32 s14, s14, 6144
  s_add_u32 s16, s14, 32768
  s_add_u32 s14, s3, 2
  s_and_b32 s14, s14, 3
  s_mul_i32 s14, s14, 6144
  s_add_u32 s17, s14, 34816
  s_add_u32 s14, s3, 3
  s_and_b32 s14, s14, 3
  s_mul_i32 s14, s14, 6144
  s_add_u32 s18, s14, 36864
  ds_read2_b32 v[192:193], v20 offset0:176 offset1:177
  ds_read2_b32 v[194:195], v20 offset0:178 offset1:179
  ds_read2_b32 v[208:209], v20 offset0:48 offset1:49
  ds_read2_b32 v[210:211], v20 offset0:50 offset1:51
  ds_read2_b32 v[224:225], v19 offset0:176 offset1:177
  ds_read2_b32 v[226:227], v19 offset0:178 offset1:179
  ds_read2_b32 v[240:241], v19 offset0:48 offset1:49
  ds_read2_b32 v[242:243], v19 offset0:50 offset1:51
  ds_read2_b32 v[196:197], v20 offset0:160 offset1:161
  ds_read2_b32 v[198:199], v20 offset0:162 offset1:163
  ds_read2_b32 v[212:213], v20 offset0:32 offset1:33
  ds_read2_b32 v[214:215], v20 offset0:34 offset1:35
  ds_read2_b32 v[228:229], v19 offset0:160 offset1:161
  ds_read2_b32 v[230:231], v19 offset0:162 offset1:163
  ds_read2_b32 v[244:245], v19 offset0:32 offset1:33
  ds_read2_b32 v[246:247], v19 offset0:34 offset1:35
  ds_read2_b32 v[200:201], v20 offset0:144 offset1:145
  ds_read2_b32 v[202:203], v20 offset0:146 offset1:147
  ds_read2_b32 v[216:217], v20 offset0:16 offset1:17
  ds_read2_b32 v[218:219], v20 offset0:18 offset1:19
  ds_read2_b32 v[232:233], v19 offset0:144 offset1:145
  ds_read2_b32 v[234:235], v19 offset0:146 offset1:147
  ds_read2_b32 v[248:249], v19 offset0:16 offset1:17
  ds_read2_b32 v[250:251], v19 offset0:18 offset1:19
  ds_read2_b32 v[204:205], v20 offset0:128 offset1:129
  ds_read2_b32 v[206:207], v20 offset0:130 offset1:131
  ds_read2_b32 v[220:221], v20 offset0:0 offset1:1
  ds_read2_b32 v[222:223], v20 offset0:2 offset1:3
  ds_read2_b32 v[236:237], v19 offset0:128 offset1:129
  ds_read2_b32 v[238:239], v19 offset0:130 offset1:131
  ds_read2_b32 v[252:253], v19 offset0:0 offset1:1
  ds_read2_b32 v[254:255], v19 offset0:2 offset1:3
  s_cmp_lg_u32 s3, 0
  s_cbranch_scc1 w0_28
  s_add_u32 s14, s53, 0
  v_add_u32 v43, s14, v14
  global_load_dword v42, v43, s[42:43] sc1
w0_28:
  s_mov_b32 s56, 0x3b124925
  s_mov_b32 s57, 0xbfb8aa3b
  v_mov_b32 v41, 0x3727c5ac
  s_waitcnt vmcnt(4)
  v_mul_f32 v48, s56, v48
  v_fma_f32 v49, v49, s56, v41
  v_fma_f32 v49, -v48, v48, v49
  v_rsq_f32 v49, v49
  v_mul_f32 v50, s56, v50
  v_fma_f32 v51, v51, s56, v41
  v_fma_f32 v51, -v50, v50, v51
  v_rsq_f32 v51, v51
  v_mul_f32 v52, s56, v52
  v_fma_f32 v53, v53, s56, v41
  v_fma_f32 v53, -v52, v52, v53
  v_rsq_f32 v53, v53
  v_mul_f32 v54, s56, v54
  v_fma_f32 v55, v55, s56, v41
  v_fma_f32 v55, -v54, v54, v55
  v_rsq_f32 v55, v55
  v_lshlrev_b32 v64, 16, v44
  v_and_b32 v65, 0xffff0000, v44
  v_lshlrev_b32 v66, 16, v45
  v_and_b32 v67, 0xffff0000, v45
  v_lshlrev_b32 v68, 16, v46
  v_and_b32 v69, 0xffff0000, v46
  v_lshlrev_b32 v70, 16, v47
  v_and_b32 v71, 0xffff0000, v47
  v_mul_f32 v48, v48, v49
  v_mul_f32 v50, v50, v51
  v_mul_f32 v52, v52, v53
  v_mul_f32 v54, v54, v55
  v_fma_f32 v72, v64, v49, -v48
  v_fma_f32 v73, v65, v51, -v50
  v_fma_f32 v74, v66, v53, -v52
  v_fma_f32 v75, v67, v55, -v54
  v_fma_f32 v76, v68, v49, -v48
  v_fma_f32 v77, v69, v51, -v50
  v_fma_f32 v78, v70, v53, -v52
  v_fma_f32 v79, v71, v55, -v54
  v_cvt_pk_bf16_f32 v80, v72, v73
  v_cvt_pk_bf16_f32 v81, v74, v75
  v_cvt_pk_bf16_f32 v82, v76, v77
  v_cvt_pk_bf16_f32 v83, v78, v79
  ds_write_b64 v15, v[80:81] offset:0
  ds_write_b64 v15, v[82:83] offset:4608
  v_lshlrev_b32 v72, 16, v80
  v_and_b32 v73, 0xffff0000, v80
  v_lshlrev_b32 v74, 16, v81
  v_and_b32 v75, 0xffff0000, v81
  v_lshlrev_b32 v76, 16, v82
  v_and_b32 v77, 0xffff0000, v82
  v_lshlrev_b32 v78, 16, v83
  v_and_b32 v79, 0xffff0000, v83
  v_fmac_f32 v64, v72, v39
  v_fmac_f32 v65, v73, v39
  v_fmac_f32 v66, v74, v39
  v_fmac_f32 v67, v75, v39
  ds_write_b128 v16, v[64:67] offset:0
  v_fmac_f32 v68, v76, v40
  v_fmac_f32 v69, v77, v40
  v_fmac_f32 v70, v78, v40
  v_fmac_f32 v71, v79, v40
  ds_write_b128 v16, v[68:71] offset:8192
  s_cmp_lg_u32 s3, 0
  s_cbranch_scc1 w0_31
  s_waitcnt vmcnt(0)
  v_cmp_gt_u32 vcc, 30, v42
  s_nop 0
  s_cbranch_vccnz sps1b_29
bks1b_30:
w0_31:
  s_waitcnt lgkmcnt(0)
  s_barrier
  s_add_u32 s14, s58, 4096
  v_add_u32 v8, s14, v2
  global_load_dwordx4 a[0:3], v8, s[42:43] offset:-4096 sc1
  global_load_dwordx4 a[4:7], v8, s[42:43] offset:-3072 sc1
  global_load_dwordx4 a[8:11], v8, s[42:43] offset:-2048 sc1
  global_load_dwordx4 a[12:15], v8, s[42:43] offset:-1024 sc1
  global_load_dwordx4 a[16:19], v8, s[42:43] offset:0 sc1
  global_load_dwordx4 a[20:23], v8, s[42:43] offset:1024 sc1
  ds_read_b128 v[128:131], v21 offset:192
  ds_read_b128 v[144:147], v21 offset:704
  ds_read_b128 v[160:163], v21 offset:1216
  ds_read_b128 v[176:179], v21 offset:1728
  ds_read_b128 v[132:135], v21 offset:128
  ds_read_b128 v[148:151], v21 offset:640
  ds_read_b128 v[164:167], v21 offset:1152
  ds_read_b128 v[180:183], v21 offset:1664
  ds_read_b128 v[136:139], v21 offset:64
  ds_read_b128 v[152:155], v21 offset:576
  ds_read_b128 v[168:171], v21 offset:1088
  ds_read_b128 v[184:187], v21 offset:1600
  ds_read_b128 v[140:143], v21 offset:0
  ds_read_b128 v[156:159], v21 offset:512
  ds_read_b128 v[172:175], v21 offset:1024
  ds_read_b128 v[188:191], v21 offset:1536
  s_waitcnt lgkmcnt(15)
  v_mfma_f32_16x16x32_bf16 v[96:99], v[192:195], v[128:131], 0
  v_mfma_f32_16x16x32_bf16 v[100:103], v[208:211], v[128:131], 0
  v_mfma_f32_16x16x32_bf16 v[104:107], v[224:227], v[128:131], 0
  global_load_dwordx4 a[24:27], v8, s[42:43] offset:2048 sc1
  v_mfma_f32_16x16x32_bf16 v[108:111], v[240:243], v[128:131], 0
  s_waitcnt lgkmcnt(14)
  v_mfma_f32_16x16x32_bf16 v[100:103], v[192:195], v[144:147], v[100:103]
  s_waitcnt vmcnt(7)
  v_mul_f32 v84, s56, v84
  v_fma_f32 v85, v85, s56, v41
  v_mfma_f32_16x16x32_bf16 v[104:107], v[208:211], v[144:147], v[104:107]
  global_load_dwordx4 a[28:31], v8, s[42:43] offset:3072 sc1
  v_fma_f32 v85, -v84, v84, v85
  v_rsq_f32 v85, v85
  v_mfma_f32_16x16x32_bf16 v[108:111], v[224:227], v[144:147], v[108:111]
  ds_read2_b32 a[224:225], v18 offset0:176 offset1:177
  ds_read2_b32 a[226:227], v18 offset0:178 offset1:179
  v_mul_f32 v86, s56, v86
  v_fma_f32 v87, v87, s56, v41
  s_waitcnt lgkmcnt(15)
  v_mfma_f32_16x16x32_bf16 v[104:107], v[192:195], v[160:163], v[104:107]
  v_fma_f32 v87, -v86, v86, v87
  v_mfma_f32_16x16x32_bf16 v[108:111], v[208:211], v[160:163], v[108:111]
  v_rsq_f32 v87, v87
  v_mul_f32 v88, s56, v88
  s_waitcnt lgkmcnt(14)
  v_mfma_f32_16x16x32_bf16 v[108:111], v[192:195], v[176:179], v[108:111]
  v_add_u32 v8, 8192, v8
  global_load_dwordx4 a[32:35], v8, s[42:43] offset:-4096 sc1
  v_fma_f32 v89, v89, s56, v41
  v_fma_f32 v89, -v88, v88, v89
  s_waitcnt lgkmcnt(13)
  v_mfma_f32_16x16x32_bf16 v[96:99], v[196:199], v[132:135], v[96:99]
  ds_read2_b32 a[228:229], v18 offset0:160 offset1:161
  ds_read2_b32 a[230:231], v18 offset0:162 offset1:163
  v_rsq_f32 v89, v89
  v_mfma_f32_16x16x32_bf16 v[100:103], v[212:215], v[132:135], v[100:103]
  v_mul_f32 v90, s56, v90
  global_load_dwordx4 a[36:39], v8, s[42:43] offset:-3072 sc1
  v_fma_f32 v91, v91, s56, v41
  v_mfma_f32_16x16x32_bf16 v[104:107], v[228:231], v[132:135], v[104:107]
  ds_read2_b32 a[232:233], v18 offset0:144 offset1:145
  ds_read2_b32 a[234:235], v18 offset0:146 offset1:147
  v_fma_f32 v91, -v90, v90, v91
  v_rsq_f32 v91, v91
  v_mfma_f32_16x16x32_bf16 v[108:111], v[244:247], v[132:135], v[108:111]
  v_lshlrev_b32 v64, 16, v56
  v_and_b32 v65, 0xffff0000, v56
  s_waitcnt lgkmcnt(15)
  v_mfma_f32_16x16x32_bf16 v[100:103], v[196:199], v[148:151], v[100:103]
  global_load_dwordx4 a[40:43], v8, s[42:43] offset:-2048 sc1
  v_lshlrev_b32 v66, 16, v57
  v_mfma_f32_16x16x32_bf16 v[104:107], v[212:215], v[148:151], v[104:107]
  ds_read2_b32 a[236:237], v18 offset0:128 offset1:129
  ds_read2_b32 a[238:239], v18 offset0:130 offset1:131
  v_and_b32 v67, 0xffff0000, v57
  v_lshlrev_b32 v68, 16, v58
  v_mfma_f32_16x16x32_bf16 v[108:111], v[228:231], v[148:151], v[108:111]
  v_and_b32 v69, 0xffff0000, v58
  v_lshlrev_b32 v70, 16, v59
  v_mfma_f32_16x16x32_bf16 v[104:107], v[196:199], v[164:167], v[104:107]
  v_and_b32 v71, 0xffff0000, v59
  global_load_dwordx4 a[44:47], v8, s[42:43] offset:-1024 sc1
  v_mfma_f32_16x16x32_bf16 v[108:111], v[212:215], v[164:167], v[108:111]
  ds_read2_b32 a[240:241], v18 offset0:48 offset1:49
  ds_read2_b32 a[242:243], v18 offset0:50 offset1:51
  v_mul_f32 v84, v84, v85
  v_mul_f32 v86, v86, v87
  s_waitcnt lgkmcnt(15)
  v_mfma_f32_16x16x32_bf16 v[108:111], v[196:199], v[180:183], v[108:111]
  v_mul_f32 v88, v88, v89
  v_mul_f32 v90, v90, v91
  v_mfma_f32_16x16x32_bf16 v[96:99], v[200:203], v[136:139], v[96:99]
  v_fma_f32 v72, v64, v85, -v84
  global_load_dwordx4 a[48:51], v8, s[42:43] offset:0 sc1
  v_fma_f32 v73, v65, v87, -v86
  v_mfma_f32_16x16x32_bf16 v[100:103], v[216:219], v[136:139], v[100:103]
  ds_read2_b32 a[244:245], v18 offset0:32 offset1:33
  ds_read2_b32 a[246:247], v18 offset0:34 offset1:35
  v_fma_f32 v74, v66, v89, -v88
  v_mfma_f32_16x16x32_bf16 v[104:107], v[232:235], v[136:139], v[104:107]
  v_fma_f32 v75, v67, v91, -v90
  v_fma_f32 v76, v68, v85, -v84
  v_mfma_f32_16x16x32_bf16 v[108:111], v[248:251], v[136:139], v[108:111]
  v_fma_f32 v77, v69, v87, -v86
  global_load_dwordx4 a[52:55], v8, s[42:43] offset:1024 sc1
  v_fma_f32 v78, v70, v89, -v88
  v_mfma_f32_16x16x32_bf16 v[100:103], v[200:203], v[152:155], v[100:103]
  ds_read2_b32 a[248:249], v18 offset0:16 offset1:17
  ds_read2_b32 a[250:251], v18 offset0:18 offset1:19
  v_fma_f32 v79, v71, v91, -v90
  v_mfma_f32_16x16x32_bf16 v[104:107], v[216:219], v[152:155], v[104:107]
  v_cvt_pk_bf16_f32 v80, v72, v73
  v_cvt_pk_bf16_f32 v81, v74, v75
  v_mfma_f32_16x16x32_bf16 v[108:111], v[232:235], v[152:155], v[108:111]
  v_cvt_pk_bf16_f32 v82, v76, v77
  global_load_dwordx4 a[56:59], v8, s[42:43] offset:2048 sc1
  v_cvt_pk_bf16_f32 v83, v78, v79
  v_mfma_f32_16x16x32_bf16 v[104:107], v[200:203], v[168:171], v[104:107]
  ds_read2_b32 a[252:253], v18 offset0:0 offset1:1
  ds_read2_b32 a[254:255], v18 offset0:2 offset1:3
  ds_write_b64 v15, v[80:81] offset:2048
  ds_write_b64 v15, v[82:83] offset:6656
  v_mfma_f32_16x16x32_bf16 v[108:111], v[216:219], v[168:171], v[108:111]
  v_lshlrev_b32 v72, 16, v80
  s_waitcnt lgkmcnt(15)
  v_mfma_f32_16x16x32_bf16 v[108:111], v[200:203], v[184:187], v[108:111]
  v_and_b32 v73, 0xffff0000, v80
  v_lshlrev_b32 v74, 16, v81
  v_mfma_f32_16x16x32_bf16 v[96:99], v[204:207], v[140:143], v[96:99]
  global_load_dwordx4 a[60:63], v8, s[42:43] offset:3072 sc1
  v_and_b32 v75, 0xffff0000, v81
  v_lshlrev_b32 v76, 16, v82
  v_mfma_f32_16x16x32_bf16 v[100:103], v[220:223], v[140:143], v[100:103]
  v_and_b32 v77, 0xffff0000, v82
  v_mfma_f32_16x16x32_bf16 v[104:107], v[236:239], v[140:143], v[104:107]
  v_lshlrev_b32 v78, 16, v83
  v_and_b32 v79, 0xffff0000, v83
  v_mfma_f32_16x16x32_bf16 v[108:111], v[252:255], v[140:143], v[108:111]
  v_add_u32 v8, 8192, v8
  global_load_dwordx4 a[64:67], v8, s[42:43] offset:-4096 sc1
  v_fmac_f32 v64, v72, v39
  v_fmac_f32 v65, v73, v39
  v_mfma_f32_16x16x32_bf16 v[100:103], v[204:207], v[156:159], v[100:103]
  v_fmac_f32 v66, v74, v39
  v_fmac_f32 v67, v75, v39
  v_mfma_f32_16x16x32_bf16 v[104:107], v[220:223], v[156:159], v[104:107]
  ds_write_b128 v16, v[64:67] offset:4096
  global_load_dwordx4 a[68:71], v8, s[42:43] offset:-3072 sc1
  v_mfma_f32_16x16x32_bf16 v[108:111], v[236:239], v[156:159], v[108:111]
  v_fmac_f32 v68, v76, v40
  v_fmac_f32 v69, v77, v40
  v_mfma_f32_16x16x32_bf16 v[104:107], v[204:207], v[172:175], v[104:107]
  v_fmac_f32 v70, v78, v40
  v_fmac_f32 v71, v79, v40
  v_mfma_f32_16x16x32_bf16 v[108:111], v[220:223], v[172:175], v[108:111]
  ds_write_b128 v16, v[68:71] offset:12288
  v_mfma_f32_16x16x32_bf16 v[108:111], v[204:207], v[188:191], v[108:111]
  v_mfma_f32_16x16x32_bf16 v[112:115], v[240:243], v[144:147], 0
  ds_write_b128 v22, v[96:99] offset:0
  ds_write_b128 v22, v[100:103] offset:1024
  v_mfma_f32_16x16x32_bf16 v[112:115], v[224:227], v[160:163], v[112:115]
  ds_write_b128 v22, v[104:107] offset:2048
  v_mfma_f32_16x16x32_bf16 v[116:119], v[240:243], v[160:163], 0
  s_nop 1
  ds_write_b128 v22, v[108:111] offset:3072
  v_mfma_f32_16x16x32_bf16 v[112:115], v[208:211], v[176:179], v[112:115]
  s_waitcnt lgkmcnt(0)
  s_barrier
  v_mfma_f32_16x16x32_bf16 v[116:119], v[224:227], v[176:179], v[116:119]
  ds_read_b128 v[64:67], v23 offset:0
  ds_read_b128 v[68:71], v23 offset:4096
  v_mfma_f32_16x16x32_bf16 v[120:123], v[240:243], v[176:179], 0
  ds_read_b128 v[72:75], v24 offset:0
  ds_read_b128 v[76:79], v23 offset:1024
  v_mfma_f32_16x16x32_bf16 v[112:115], v[244:247], v[148:151], v[112:115]
  ds_read_b128 v[80:83], v23 offset:5120
  ds_read_b128 v[84:87], v24 offset:1024
  v_mfma_f32_16x16x32_bf16 v[112:115], v[228:231], v[164:167], v[112:115]
  v_mfma_f32_16x16x32_bf16 v[116:119], v[244:247], v[164:167], v[116:119]
  s_add_u32 s14, s49, 0
  v_add_u32 v4, s14, v25
  global_load_dwordx4 a[72:75], v8, s[42:43] offset:-2048 sc1
  s_waitcnt lgkmcnt(0)
  v_mfma_f32_16x16x32_bf16 v[112:115], v[212:215], v[180:183], v[112:115]
  v_add_f32 v64, v64, v68
  v_add_f32 v65, v65, v69
  v_mfma_f32_16x16x32_bf16 v[116:119], v[228:231], v[180:183], v[116:119]
  v_add_f32 v66, v66, v70
  v_add_f32 v67, v67, v71
  v_mfma_f32_16x16x32_bf16 v[120:123], v[244:247], v[180:183], v[120:123]
  global_load_dwordx4 a[76:79], v8, s[42:43] offset:-1024 sc1
  v_add_f32 v64, v64, v72
  v_mfma_f32_16x16x32_bf16 v[112:115], v[248:251], v[152:155], v[112:115]
  v_add_f32 v65, v65, v73
  v_add_f32 v66, v66, v74
  v_mfma_f32_16x16x32_bf16 v[112:115], v[232:235], v[168:171], v[112:115]
  v_add_f32 v67, v67, v75
  v_cvt_pk_bf16_f32 v88, v64, v65
  v_mfma_f32_16x16x32_bf16 v[116:119], v[248:251], v[168:171], v[116:119]
  v_cvt_pk_bf16_f32 v89, v66, v67
  global_load_dwordx4 a[80:83], v8, s[42:43] offset:0 sc1
  v_mfma_f32_16x16x32_bf16 v[112:115], v[216:219], v[184:187], v[112:115]
  v_add_f32 v76, v76, v80
  v_add_f32 v77, v77, v81
  v_mfma_f32_16x16x32_bf16 v[116:119], v[232:235], v[184:187], v[116:119]
  v_add_f32 v78, v78, v82
  v_add_f32 v79, v79, v83
  v_mfma_f32_16x16x32_bf16 v[120:123], v[248:251], v[184:187], v[120:123]
  v_add_f32 v76, v76, v84
  global_load_dwordx4 a[84:87], v8, s[42:43] offset:1024 sc1
  v_add_f32 v77, v77, v85
  v_mfma_f32_16x16x32_bf16 v[112:115], v[252:255], v[156:159], v[112:115]
  v_add_f32 v78, v78, v86
  v_mfma_f32_16x16x32_bf16 v[112:115], v[236:239], v[172:175], v[112:115]
  v_add_f32 v79, v79, v87
  v_cvt_pk_bf16_f32 v90, v76, v77
  v_mfma_f32_16x16x32_bf16 v[116:119], v[252:255], v[172:175], v[116:119]
  v_cvt_pk_bf16_f32 v91, v78, v79
  v_permlane16_swap_b32 v88, v90
  v_mfma_f32_16x16x32_bf16 v[112:115], v[220:223], v[188:191], v[112:115]
  v_permlane16_swap_b32 v89, v91
  v_mfma_f32_16x16x32_bf16 v[116:119], v[236:239], v[188:191], v[116:119]
  global_store_dwordx4 v4, v[88:91], s[42:43] sc1
  v_mfma_f32_16x16x32_bf16 v[120:123], v[252:255], v[188:191], v[120:123]
  v_mfma_f32_16x16x32_bf16 v[112:115], a[224:227], v[128:131], v[112:115]
  global_load_dwordx4 a[88:91], v8, s[42:43] offset:2048 sc1
  v_mfma_f32_16x16x32_bf16 v[116:119], a[224:227], v[144:147], v[116:119]
  v_mfma_f32_16x16x32_bf16 v[120:123], a[224:227], v[160:163], v[120:123]
  v_mfma_f32_16x16x32_bf16 v[124:127], a[224:227], v[176:179], 0
  ds_read_b128 v[176:179], v21 offset:3776
  v_mfma_f32_16x16x32_bf16 v[112:115], a[228:231], v[132:135], v[112:115]
  ds_read2_b32 a[224:225], v17 offset0:176 offset1:177
  ds_read2_b32 a[226:227], v17 offset0:178 offset1:179
  global_load_dwordx4 a[92:95], v8, s[42:43] offset:3072 sc1
  v_mfma_f32_16x16x32_bf16 v[116:119], a[228:231], v[148:151], v[116:119]
  v_mfma_f32_16x16x32_bf16 v[120:123], a[228:231], v[164:167], v[120:123]
  v_mfma_f32_16x16x32_bf16 v[124:127], a[228:231], v[180:183], v[124:127]
  ds_read_b128 v[180:183], v21 offset:3712
  v_mfma_f32_16x16x32_bf16 v[112:115], a[232:235], v[136:139], v[112:115]
  ds_read2_b32 a[228:229], v17 offset0:160 offset1:161
  ds_read2_b32 a[230:231], v17 offset0:162 offset1:163
  v_add_u32 v8, 8192, v8
  global_load_dwordx4 a[96:99], v8, s[42:43] offset:-4096 sc1
  v_mfma_f32_16x16x32_bf16 v[116:119], a[232:235], v[152:155], v[116:119]
  v_mfma_f32_16x16x32_bf16 v[120:123], a[232:235], v[168:171], v[120:123]
  v_mfma_f32_16x16x32_bf16 v[124:127], a[232:235], v[184:187], v[124:127]
  ds_read_b128 v[184:187], v21 offset:3648
  v_mfma_f32_16x16x32_bf16 v[112:115], a[236:239], v[140:143], v[112:115]
  ds_read2_b32 a[232:233], v17 offset0:144 offset1:145
  ds_read2_b32 a[234:235], v17 offset0:146 offset1:147
  global_load_dwordx4 a[100:103], v8, s[42:43] offset:-3072 sc1
  v_mfma_f32_16x16x32_bf16 v[116:119], a[236:239], v[156:159], v[116:119]
  v_mfma_f32_16x16x32_bf16 v[120:123], a[236:239], v[172:175], v[120:123]
  v_mfma_f32_16x16x32_bf16 v[124:127], a[236:239], v[188:191], v[124:127]
  ds_read_b128 v[188:191], v21 offset:3584
  v_mfma_f32_16x16x32_bf16 v[116:119], a[240:243], v[128:131], v[116:119]
  ds_read2_b32 a[236:237], v17 offset0:128 offset1:129
  ds_read2_b32 a[238:239], v17 offset0:130 offset1:131
  global_load_dwordx4 a[104:107], v8, s[42:43] offset:-2048 sc1
  v_mfma_f32_16x16x32_bf16 v[120:123], a[240:243], v[144:147], v[120:123]
  v_mfma_f32_16x16x32_bf16 v[124:127], a[240:243], v[160:163], v[124:127]
  ds_read_b128 v[160:163], v21 offset:3264
  v_mfma_f32_16x16x32_bf16 v[116:119], a[244:247], v[132:135], v[116:119]
  ds_read2_b32 a[240:241], v17 offset0:48 offset1:49
  ds_read2_b32 a[242:243], v17 offset0:50 offset1:51
  v_mfma_f32_16x16x32_bf16 v[120:123], a[244:247], v[148:151], v[120:123]
  global_load_dwordx4 a[108:111], v8, s[42:43] offset:-1024 sc1
  v_mfma_f32_16x16x32_bf16 v[124:127], a[244:247], v[164:167], v[124:127]
  ds_read_b128 v[164:167], v21 offset:3200
  v_mfma_f32_16x16x32_bf16 v[116:119], a[248:251], v[136:139], v[116:119]
  ds_read2_b32 a[244:245], v17 offset0:32 offset1:33
  ds_read2_b32 a[246:247], v17 offset0:34 offset1:35
  v_mfma_f32_16x16x32_bf16 v[120:123], a[248:251], v[152:155], v[120:123]
  v_mfma_f32_16x16x32_bf16 v[124:127], a[248:251], v[168:171], v[124:127]
  global_load_dwordx4 a[112:115], v8, s[42:43] offset:0 sc1
  ds_read_b128 v[168:171], v21 offset:3136
  v_mfma_f32_16x16x32_bf16 v[116:119], a[252:255], v[140:143], v[116:119]
  ds_read2_b32 a[248:249], v17 offset0:16 offset1:17
  ds_read2_b32 a[250:251], v17 offset0:18 offset1:19
  v_mfma_f32_16x16x32_bf16 v[120:123], a[252:255], v[156:159], v[120:123]
  v_mfma_f32_16x16x32_bf16 v[124:127], a[252:255], v[172:175], v[124:127]
  ds_read_b128 v[172:175], v21 offset:3072
  s_waitcnt lgkmcnt(15)
  v_mfma_f32_16x16x32_bf16 v[120:123], a[224:227], v[128:131], v[120:123]
  ds_read2_b32 a[252:253], v17 offset0:0 offset1:1
  ds_read2_b32 a[254:255], v17 offset0:2 offset1:3
  global_load_dwordx4 a[116:119], v8, s[42:43] offset:1024 sc1
  v_mfma_f32_16x16x32_bf16 v[124:127], a[224:227], v[144:147], v[124:127]
  ds_read_b128 v[144:147], v21 offset:2752
  v_mfma_f32_16x16x32_bf16 v[120:123], a[228:231], v[132:135], v[120:123]
  v_mfma_f32_16x16x32_bf16 v[124:127], a[228:231], v[148:151], v[124:127]
  ds_read_b128 v[148:151], v21 offset:2688
  s_waitcnt lgkmcnt(15)
  v_mfma_f32_16x16x32_bf16 v[120:123], a[232:235], v[136:139], v[120:123]
  global_load_dwordx4 a[120:123], v8, s[42:43] offset:2048 sc1
  v_mfma_f32_16x16x32_bf16 v[124:127], a[232:235], v[152:155], v[124:127]
  ds_read_b128 v[152:155], v21 offset:2624
  s_waitcnt lgkmcnt(15)
  v_mfma_f32_16x16x32_bf16 v[120:123], a[236:239], v[140:143], v[120:123]
  v_mfma_f32_16x16x32_bf16 v[124:127], a[236:239], v[156:159], v[124:127]
  ds_read_b128 v[156:159], v21 offset:2560
  s_waitcnt lgkmcnt(13)
  v_mfma_f32_16x16x32_bf16 v[124:127], a[240:243], v[128:131], v[124:127]
  global_load_dwordx4 a[124:127], v8, s[42:43] offset:3072 sc1
  ds_read_b128 v[128:131], v21 offset:2240
  s_waitcnt lgkmcnt(11)
  v_mfma_f32_16x16x32_bf16 v[124:127], a[244:247], v[132:135], v[124:127]
  ds_read_b128 v[132:135], v21 offset:2176
  s_waitcnt lgkmcnt(9)
  v_mfma_f32_16x16x32_bf16 v[124:127], a[248:251], v[136:139], v[124:127]
  ds_read_b128 v[136:139], v21 offset:2112
  s_waitcnt lgkmcnt(7)
  v_mfma_f32_16x16x32_bf16 v[124:127], a[252:255], v[140:143], v[124:127]
  ds_read_b128 v[140:143], v21 offset:2048
  v_mfma_f32_16x16x32_bf16 v[124:127], v[192:195], v[176:179], v[124:127]
  v_mfma_f32_16x16x32_bf16 v[124:127], v[196:199], v[180:183], v[124:127]
  v_add_u32 v8, 8192, v8
  global_load_dwordx4 a[128:131], v8, s[42:43] offset:-4096 sc1
  v_mfma_f32_16x16x32_bf16 v[124:127], v[200:203], v[184:187], v[124:127]
  v_mfma_f32_16x16x32_bf16 v[124:127], v[204:207], v[188:191], v[124:127]
  v_mfma_f32_16x16x32_bf16 v[120:123], v[192:195], v[160:163], v[120:123]
  global_load_dwordx4 a[132:135], v8, s[42:43] offset:-3072 sc1
  v_mfma_f32_16x16x32_bf16 v[124:127], v[208:211], v[160:163], v[124:127]
  v_mfma_f32_16x16x32_bf16 v[120:123], v[196:199], v[164:167], v[120:123]
  v_mfma_f32_16x16x32_bf16 v[124:127], v[212:215], v[164:167], v[124:127]
  v_mfma_f32_16x16x32_bf16 v[120:123], v[200:203], v[168:171], v[120:123]
  global_load_dwordx4 a[136:139], v8, s[42:43] offset:-2048 sc1
  v_mfma_f32_16x16x32_bf16 v[124:127], v[216:219], v[168:171], v[124:127]
  v_mfma_f32_16x16x32_bf16 v[120:123], v[204:207], v[172:175], v[120:123]
  v_mfma_f32_16x16x32_bf16 v[124:127], v[220:223], v[172:175], v[124:127]
  s_waitcnt lgkmcnt(7)
  v_mfma_f32_16x16x32_bf16 v[116:119], v[192:195], v[144:147], v[116:119]
  global_load_dwordx4 a[140:143], v8, s[42:43] offset:-1024 sc1
  v_mfma_f32_16x16x32_bf16 v[120:123], v[208:211], v[144:147], v[120:123]
  v_mfma_f32_16x16x32_bf16 v[124:127], v[224:227], v[144:147], v[124:127]
  s_waitcnt lgkmcnt(6)
  v_mfma_f32_16x16x32_bf16 v[116:119], v[196:199], v[148:151], v[116:119]
  global_load_dwordx4 a[144:147], v8, s[42:43] offset:0 sc1
  v_mfma_f32_16x16x32_bf16 v[120:123], v[212:215], v[148:151], v[120:123]
  v_mfma_f32_16x16x32_bf16 v[124:127], v[228:231], v[148:151], v[124:127]
  s_waitcnt lgkmcnt(5)
  v_mfma_f32_16x16x32_bf16 v[116:119], v[200:203], v[152:155], v[116:119]
  v_mfma_f32_16x16x32_bf16 v[120:123], v[216:219], v[152:155], v[120:123]
  global_load_dwordx4 a[148:151], v8, s[42:43] offset:1024 sc1
  v_mfma_f32_16x16x32_bf16 v[124:127], v[232:235], v[152:155], v[124:127]
  s_waitcnt lgkmcnt(4)
  v_mfma_f32_16x16x32_bf16 v[116:119], v[204:207], v[156:159], v[116:119]
  v_mfma_f32_16x16x32_bf16 v[120:123], v[220:223], v[156:159], v[120:123]
  v_mfma_f32_16x16x32_bf16 v[124:127], v[236:239], v[156:159], v[124:127]
  global_load_dwordx4 a[152:155], v8, s[42:43] offset:2048 sc1
  s_waitcnt lgkmcnt(3)
  v_mfma_f32_16x16x32_bf16 v[112:115], v[192:195], v[128:131], v[112:115]
  v_mfma_f32_16x16x32_bf16 v[116:119], v[208:211], v[128:131], v[116:119]
  v_mfma_f32_16x16x32_bf16 v[120:123], v[224:227], v[128:131], v[120:123]
  global_load_dwordx4 a[156:159], v8, s[42:43] offset:3072 sc1
  v_mfma_f32_16x16x32_bf16 v[124:127], v[240:243], v[128:131], v[124:127]
  s_waitcnt lgkmcnt(2)
  v_mfma_f32_16x16x32_bf16 v[112:115], v[196:199], v[132:135], v[112:115]
  v_mfma_f32_16x16x32_bf16 v[116:119], v[212:215], v[132:135], v[116:119]
  v_mfma_f32_16x16x32_bf16 v[120:123], v[228:231], v[132:135], v[120:123]
  v_add_u32 v8, 8192, v8
  global_load_dwordx4 a[160:163], v8, s[42:43] offset:-4096 sc1
  v_mfma_f32_16x16x32_bf16 v[124:127], v[244:247], v[132:135], v[124:127]
  s_waitcnt lgkmcnt(1)
  v_mfma_f32_16x16x32_bf16 v[112:115], v[200:203], v[136:139], v[112:115]
  v_mfma_f32_16x16x32_bf16 v[116:119], v[216:219], v[136:139], v[116:119]
  v_mfma_f32_16x16x32_bf16 v[120:123], v[232:235], v[136:139], v[120:123]
  global_load_dwordx4 a[164:167], v8, s[42:43] offset:-3072 sc1
  v_mfma_f32_16x16x32_bf16 v[124:127], v[248:251], v[136:139], v[124:127]
  s_waitcnt lgkmcnt(0)
  v_mfma_f32_16x16x32_bf16 v[112:115], v[204:207], v[140:143], v[112:115]
  v_mfma_f32_16x16x32_bf16 v[116:119], v[220:223], v[140:143], v[116:119]
  v_mfma_f32_16x16x32_bf16 v[120:123], v[236:239], v[140:143], v[120:123]
  v_mfma_f32_16x16x32_bf16 v[124:127], v[252:255], v[140:143], v[124:127]
  s_nop 4
  ds_write_b128 v22, v[112:115] offset:16384
  ds_write_b128 v22, v[116:119] offset:17408
  ds_write_b128 v22, v[120:123] offset:18432
  ds_write_b128 v22, v[124:127] offset:19456
  s_add_u32 s14, s5, 0
  s_mul_i32 s14, s14, 28672
  s_add_u32 s14, s14, s49
  v_add_u32 v6, s14, v27
  s_add_u32 m0, s62, 32768
  s_nop 0
  global_load_lds_dwordx4 v6, s[42:43] offset:0 sc1
  global_load_lds_dwordx4 v6, s[42:43] offset:1024 sc1
  global_load_lds_dwordx4 v6, s[42:43] offset:2048 sc1
  global_load_lds_dwordx4 v6, s[42:43] offset:3072 sc1
  v_add_u32 v6, 4096, v6
  s_add_u32 m0, s62, 36864
  s_nop 0
  global_load_lds_dwordx4 v6, s[42:43] offset:0 sc1
  global_load_lds_dwordx4 v6, s[42:43] offset:1024 sc1
  global_load_lds_dwordx4 v6, s[42:43] offset:2048 sc1
  s_waitcnt lgkmcnt(0)
  s_barrier
  ds_read_b128 v[64:67], v23 offset:16384
  ds_read_b128 v[68:71], v23 offset:20480
  ds_read_b128 v[72:75], v24 offset:4096
  ds_read_b128 v[76:79], v23 offset:17408
  ds_read_b128 v[80:83], v23 offset:21504
  ds_read_b128 v[84:87], v24 offset:5120
  s_add_u32 s14, s49, 917504
  v_add_u32 v4, s14, v25
  s_waitcnt lgkmcnt(0)
  v_add_f32 v64, v64, v68
  v_add_f32 v65, v65, v69
  v_add_f32 v66, v66, v70
  v_add_f32 v67, v67, v71
  v_add_f32 v64, v64, v72
  v_add_f32 v65, v65, v73
  v_add_f32 v66, v66, v74
  v_add_f32 v67, v67, v75
  v_cvt_pk_bf16_f32 v88, v64, v65
  v_cvt_pk_bf16_f32 v89, v66, v67
  v_add_f32 v76, v76, v80
  v_add_f32 v77, v77, v81
  v_add_f32 v78, v78, v82
  v_add_f32 v79, v79, v83
  v_add_f32 v76, v76, v84
  v_add_f32 v77, v77, v85
  v_add_f32 v78, v78, v86
  v_add_f32 v79, v79, v87
  v_cvt_pk_bf16_f32 v90, v76, v77
  v_cvt_pk_bf16_f32 v91, v78, v79
  s_nop 0
  v_permlane16_swap_b32 v88, v90
  v_permlane16_swap_b32 v89, v91
  global_store_dwordx4 v4, v[88:91], s[42:43] sc1
  global_load_dwordx4 a[168:171], v8, s[42:43] offset:-2048 sc1
  global_load_dwordx4 a[172:175], v8, s[42:43] offset:-1024 sc1
  global_load_dwordx4 a[176:179], v8, s[42:43] offset:0 sc1
  global_load_dwordx4 a[180:183], v8, s[42:43] offset:1024 sc1
  global_load_dwordx4 a[184:187], v8, s[42:43] offset:2048 sc1
  global_load_dwordx4 a[188:191], v8, s[42:43] offset:3072 sc1
  v_add_u32 v44, 57344, v26
  s_lshl_b32 s9, s8, 4
  s_add_u32 s9, s9, s5
  s_mul_i32 s60, s9, 114688
  s_add_u32 s60, s60, s51
  s_add_u32 s61, s60, 3670016
  s_lshl_b32 s9, s3, 12
  v_add_u32 v11, s9, v2
  v_mov_b32 v56, -1
  v_mov_b32 v57, -1
  v_mov_b32 v58, -1
  v_mov_b32 v59, -1
  s_waitcnt vmcnt(7)
  ds_read2st64_b32 v[60:61], v31 offset0:0 offset1:4
  ds_read2st64_b32 v[62:63], v31 offset0:8 offset1:12
  ds_read2st64_b32 v[52:53], v31 offset0:16 offset1:20
  ds_read2st64_b32 v[4:5], v31 offset0:24 offset1:24
  s_waitcnt lgkmcnt(0)
  v_max3_u32 v54, v60, v61, v62
  v_max3_u32 v54, v54, v63, v52
  v_max3_u32 v54, v54, v53, v4
  v_cmp_eq_u32 vcc, -1, v54
  s_nop 0
  s_cbranch_vccnz sptile0_32
bktile0_33:
  s_barrier
  ds_read_b64_tr_b16 v[128:129], v26 offset:0
  ds_read_b64_tr_b16 v[130:131], v26 offset:256
  ds_read_b64_tr_b16 v[132:133], v26 offset:1024
  ds_read_b64_tr_b16 v[134:135], v26 offset:1280
  ds_read_b64_tr_b16 v[136:137], v26 offset:2048
  ds_read_b64_tr_b16 v[138:139], v26 offset:2304
  ds_read_b64_tr_b16 v[140:141], v26 offset:3072
  ds_read_b64_tr_b16 v[142:143], v26 offset:3328
  s_waitcnt lgkmcnt(6)
  v_mfma_f32_32x32x16_bf16 v[64:79], a[0:3], v[128:131], 0
  v_mfma_f32_32x32x16_bf16 v[80:95], a[4:7], v[128:131], 0
  ds_read_b64_tr_b16 v[144:145], v26 offset:4096
  ds_read_b64_tr_b16 v[146:147], v26 offset:4352
  s_add_u32 s14, s5, 16
  s_mul_i32 s14, s14, 28672
  s_add_u32 s14, s14, s49
  v_add_u32 v7, s14, v27
  s_add_u32 m0, s62, 61440
  s_nop 0
  global_load_lds_dwordx4 v7, s[42:43] offset:0 sc1
  s_waitcnt lgkmcnt(6)
  v_mfma_f32_32x32x16_bf16 v[64:79], a[8:11], v[132:135], v[64:79]
  v_mfma_f32_32x32x16_bf16 v[80:95], a[12:15], v[132:135], v[80:95]
  ds_read_b64_tr_b16 v[148:149], v26 offset:5120
  ds_read_b64_tr_b16 v[150:151], v26 offset:5376
  global_load_lds_dwordx4 v7, s[42:43] offset:1024 sc1
  s_waitcnt lgkmcnt(6)
  v_mfma_f32_32x32x16_bf16 v[64:79], a[16:19], v[136:139], v[64:79]
  v_mfma_f32_32x32x16_bf16 v[80:95], a[20:23], v[136:139], v[80:95]
  ds_read_b64_tr_b16 v[128:129], v26 offset:6144
  ds_read_b64_tr_b16 v[130:131], v26 offset:6400
  global_load_lds_dwordx4 v7, s[42:43] offset:2048 sc1
  s_waitcnt lgkmcnt(6)
  v_mfma_f32_32x32x16_bf16 v[64:79], a[24:27], v[140:143], v[64:79]
  v_mfma_f32_32x32x16_bf16 v[80:95], a[28:31], v[140:143], v[80:95]
  ds_read_b64_tr_b16 v[132:133], v26 offset:7168
  ds_read_b64_tr_b16 v[134:135], v26 offset:7424
  global_load_lds_dwordx4 v7, s[42:43] offset:3072 sc1
  s_waitcnt lgkmcnt(6)
  v_mfma_f32_32x32x16_bf16 v[64:79], a[32:35], v[144:147], v[64:79]
  v_mfma_f32_32x32x16_bf16 v[80:95], a[36:39], v[144:147], v[80:95]
  ds_read_b64_tr_b16 v[136:137], v26 offset:8192
  ds_read_b64_tr_b16 v[138:139], v26 offset:8448
  v_add_u32 v7, 4096, v7
  s_add_u32 m0, s62, 65536
  s_nop 0
  global_load_lds_dwordx4 v7, s[42:43] offset:0 sc1
  s_waitcnt lgkmcnt(6)
  v_mfma_f32_32x32x16_bf16 v[64:79], a[40:43], v[148:151], v[64:79]
  v_mfma_f32_32x32x16_bf16 v[80:95], a[44:47], v[148:151], v[80:95]
  ds_read_b64_tr_b16 v[140:141], v26 offset:9216
  ds_read_b64_tr_b16 v[142:143], v26 offset:9472
  global_load_lds_dwordx4 v7, s[42:43] offset:1024 sc1
  s_waitcnt lgkmcnt(6)
  v_mfma_f32_32x32x16_bf16 v[64:79], a[48:51], v[128:131], v[64:79]
  v_mfma_f32_32x32x16_bf16 v[80:95], a[52:55], v[128:131], v[80:95]
  ds_read_b64_tr_b16 v[144:145], v26 offset:10240
  ds_read_b64_tr_b16 v[146:147], v26 offset:10496
  global_load_lds_dwordx4 v7, s[42:43] offset:2048 sc1
  s_waitcnt lgkmcnt(6)
  v_mfma_f32_32x32x16_bf16 v[64:79], a[56:59], v[132:135], v[64:79]
  v_mfma_f32_32x32x16_bf16 v[80:95], a[60:63], v[132:135], v[80:95]
  ds_read_b64_tr_b16 v[148:149], v26 offset:11264
  ds_read_b64_tr_b16 v[150:151], v26 offset:11520
  v_add_u32 v8, 8192, v8
  global_load_dwordx4 a[192:195], v8, s[42:43] offset:-4096 sc1
  s_waitcnt lgkmcnt(6)
  v_mfma_f32_32x32x16_bf16 v[64:79], a[64:67], v[136:139], v[64:79]
  v_mfma_f32_32x32x16_bf16 v[80:95], a[68:71], v[136:139], v[80:95]
  ds_read_b64_tr_b16 v[128:129], v26 offset:12288
  ds_read_b64_tr_b16 v[130:131], v26 offset:12544
  global_load_dwordx4 a[196:199], v8, s[42:43] offset:-3072 sc1
  s_waitcnt lgkmcnt(6)
  v_mfma_f32_32x32x16_bf16 v[64:79], a[72:75], v[140:143], v[64:79]
  v_mfma_f32_32x32x16_bf16 v[80:95], a[76:79], v[140:143], v[80:95]
  ds_read_b64_tr_b16 v[132:133], v26 offset:13312
  ds_read_b64_tr_b16 v[134:135], v26 offset:13568
  global_load_dwordx4 a[200:203], v8, s[42:43] offset:-2048 sc1
  s_waitcnt lgkmcnt(6)
  v_mfma_f32_32x32x16_bf16 v[64:79], a[80:83], v[144:147], v[64:79]
  v_mfma_f32_32x32x16_bf16 v[80:95], a[84:87], v[144:147], v[80:95]
  ds_read_b64_tr_b16 v[136:137], v26 offset:14336
  ds_read_b64_tr_b16 v[138:139], v26 offset:14592
  global_load_dwordx4 a[204:207], v8, s[42:43] offset:-1024 sc1
  s_waitcnt lgkmcnt(6)
  v_mfma_f32_32x32x16_bf16 v[64:79], a[88:91], v[148:151], v[64:79]
  v_mfma_f32_32x32x16_bf16 v[80:95], a[92:95], v[148:151], v[80:95]
  ds_read_b64_tr_b16 v[140:141], v26 offset:15360
  ds_read_b64_tr_b16 v[142:143], v26 offset:15616
  global_load_dwordx4 a[208:211], v8, s[42:43] offset:0 sc1
  s_waitcnt lgkmcnt(6)
  v_mfma_f32_32x32x16_bf16 v[64:79], a[96:99], v[128:131], v[64:79]
  v_mfma_f32_32x32x16_bf16 v[80:95], a[100:103], v[128:131], v[80:95]
  ds_read_b64_tr_b16 v[144:145], v26 offset:16384
  ds_read_b64_tr_b16 v[146:147], v26 offset:16640
  global_load_dwordx4 a[212:215], v8, s[42:43] offset:1024 sc1
  s_waitcnt lgkmcnt(6)
  v_mfma_f32_32x32x16_bf16 v[64:79], a[104:107], v[132:135], v[64:79]
  v_mfma_f32_32x32x16_bf16 v[80:95], a[108:111], v[132:135], v[80:95]
  ds_read_b64_tr_b16 v[148:149], v26 offset:17408
  ds_read_b64_tr_b16 v[150:151], v26 offset:17664
  global_load_dwordx4 a[216:219], v8, s[42:43] offset:2048 sc1
  s_waitcnt lgkmcnt(6)
  v_mfma_f32_32x32x16_bf16 v[64:79], a[112:115], v[136:139], v[64:79]
  v_mfma_f32_32x32x16_bf16 v[80:95], a[116:119], v[136:139], v[80:95]
  ds_read_b64_tr_b16 v[128:129], v26 offset:18432
  ds_read_b64_tr_b16 v[130:131], v26 offset:18688
  global_load_dwordx4 a[220:223], v8, s[42:43] offset:3072 sc1
  s_waitcnt lgkmcnt(6)
  v_mfma_f32_32x32x16_bf16 v[64:79], a[120:123], v[140:143], v[64:79]
  v_mfma_f32_32x32x16_bf16 v[80:95], a[124:127], v[140:143], v[80:95]
  ds_read_b64_tr_b16 v[132:133], v26 offset:19456
  ds_read_b64_tr_b16 v[134:135], v26 offset:19712
  s_add_u32 s14, s59, 4096
  v_add_u32 v55, s14, v2
  global_load_dwordx4 a[224:227], v55, s[42:43] offset:-4096 sc1
  s_waitcnt lgkmcnt(6)
  v_mfma_f32_32x32x16_bf16 v[64:79], a[128:131], v[144:147], v[64:79]
  v_mfma_f32_32x32x16_bf16 v[80:95], a[132:135], v[144:147], v[80:95]
  ds_read_b64_tr_b16 v[136:137], v26 offset:20480
  ds_read_b64_tr_b16 v[138:139], v26 offset:20736
  global_load_dwordx4 a[228:231], v55, s[42:43] offset:-3072 sc1
  s_waitcnt lgkmcnt(6)
  v_mfma_f32_32x32x16_bf16 v[64:79], a[136:139], v[148:151], v[64:79]
  v_mfma_f32_32x32x16_bf16 v[80:95], a[140:143], v[148:151], v[80:95]
  ds_read_b64_tr_b16 v[140:141], v26 offset:21504
  ds_read_b64_tr_b16 v[142:143], v26 offset:21760
  global_load_dwordx4 a[232:235], v55, s[42:43] offset:-2048 sc1
  s_waitcnt lgkmcnt(6)
  v_mfma_f32_32x32x16_bf16 v[64:79], a[144:147], v[128:131], v[64:79]
  v_mfma_f32_32x32x16_bf16 v[80:95], a[148:151], v[128:131], v[80:95]
  ds_read_b64_tr_b16 v[144:145], v26 offset:22528
  ds_read_b64_tr_b16 v[146:147], v26 offset:22784
  global_load_dwordx4 a[236:239], v55, s[42:43] offset:-1024 sc1
  s_waitcnt lgkmcnt(6)
  v_mfma_f32_32x32x16_bf16 v[64:79], a[152:155], v[132:135], v[64:79]
  v_mfma_f32_32x32x16_bf16 v[80:95], a[156:159], v[132:135], v[80:95]
  ds_read_b64_tr_b16 v[148:149], v26 offset:23552
  ds_read_b64_tr_b16 v[150:151], v26 offset:23808
  global_load_dwordx4 a[240:243], v55, s[42:43] offset:0 sc1
  s_waitcnt lgkmcnt(6)
  v_mfma_f32_32x32x16_bf16 v[64:79], a[160:163], v[136:139], v[64:79]
  v_mfma_f32_32x32x16_bf16 v[80:95], a[164:167], v[136:139], v[80:95]
  ds_read_b64_tr_b16 v[128:129], v26 offset:24576
  ds_read_b64_tr_b16 v[130:131], v26 offset:24832
  global_load_dwordx4 a[244:247], v55, s[42:43] offset:1024 sc1
  s_waitcnt lgkmcnt(6)
  s_waitcnt vmcnt(26)
  v_mfma_f32_32x32x16_bf16 v[64:79], a[168:171], v[140:143], v[64:79]
  s_waitcnt vmcnt(14)
  ds_read2st64_b32 v[60:61], v31 offset0:112 offset1:116
  ds_read2st64_b32 v[62:63], v31 offset0:120 offset1:124
  ds_read2st64_b32 v[52:53], v31 offset0:128 offset1:132
  ds_read2st64_b32 v[4:5], v31 offset0:136 offset1:136
  v_mfma_f32_32x32x16_bf16 v[80:95], a[172:175], v[140:143], v[80:95]
  ds_read_b64_tr_b16 v[132:133], v26 offset:25600
  ds_read_b64_tr_b16 v[134:135], v26 offset:25856
  global_load_dwordx4 a[248:251], v55, s[42:43] offset:2048 sc1
  s_waitcnt lgkmcnt(10)
  v_mfma_f32_32x32x16_bf16 v[64:79], a[176:179], v[144:147], v[64:79]
  v_mfma_f32_32x32x16_bf16 v[80:95], a[180:183], v[144:147], v[80:95]
  ds_read_b64_tr_b16 v[136:137], v26 offset:26624
  ds_read_b64_tr_b16 v[138:139], v26 offset:26880
  global_load_dwordx4 a[252:255], v55, s[42:43] offset:3072 sc1
  s_waitcnt lgkmcnt(10)
  v_mfma_f32_32x32x16_bf16 v[64:79], a[184:187], v[148:151], v[64:79]
  s_waitcnt lgkmcnt(4)
  v_max3_u32 v54, v60, v61, v62
  v_max3_u32 v54, v54, v63, v52
  v_max3_u32 v54, v54, v53, v4
  v_cmp_eq_u32 vcc, -1, v54
  s_nop 0
  s_cbranch_vccnz sptile1_36
bktile1_37:
  v_mfma_f32_32x32x16_bf16 v[80:95], a[188:191], v[148:151], v[80:95]
  ds_read_b64_tr_b16 v[140:141], v26 offset:27648
  ds_read_b64_tr_b16 v[142:143], v26 offset:27904
  v_add_u32 v55, 8192, v55
  global_load_dwordx4 v[152:155], v55, s[42:43] offset:-4096 sc1
  s_barrier
  s_waitcnt vmcnt(16)
  v_mfma_f32_32x32x16_bf16 v[64:79], a[192:195], v[128:131], v[64:79]
  s_waitcnt vmcnt(15)
  v_mfma_f32_32x32x16_bf16 v[80:95], a[196:199], v[128:131], v[80:95]
  ds_read_b64_tr_b16 v[144:145], v26 offset:28672
  ds_read_b64_tr_b16 v[146:147], v26 offset:28928
  global_load_dwordx4 v[156:159], v55, s[42:43] offset:-3072 sc1
  s_waitcnt lgkmcnt(6)
  s_waitcnt vmcnt(15)
  v_mfma_f32_32x32x16_bf16 v[64:79], a[200:203], v[132:135], v[64:79]
  s_waitcnt vmcnt(14)
  v_mfma_f32_32x32x16_bf16 v[80:95], a[204:207], v[132:135], v[80:95]
  ds_read_b64_tr_b16 v[148:149], v26 offset:29696
  ds_read_b64_tr_b16 v[150:151], v26 offset:29952
  global_load_dwordx4 v[160:163], v55, s[42:43] offset:-2048 sc1
  s_waitcnt lgkmcnt(6)
  s_waitcnt vmcnt(14)
  v_mfma_f32_32x32x16_bf16 v[64:79], a[208:211], v[136:139], v[64:79]
  s_waitcnt vmcnt(13)
  v_mfma_f32_32x32x16_bf16 v[80:95], a[212:215], v[136:139], v[80:95]
  ds_read_b64_tr_b16 v[128:129], v26 offset:30720
  ds_read_b64_tr_b16 v[130:131], v26 offset:30976
  s_add_u32 s14, s5, 32
  s_mul_i32 s14, s14, 28672
  s_add_u32 s14, s14, s49
  v_add_u32 v7, s14, v27
  s_add_u32 m0, s62, 90112
  s_nop 0
  global_load_lds_dwordx4 v7, s[42:43] offset:0 sc1
  s_waitcnt lgkmcnt(6)
  s_waitcnt vmcnt(13)
  v_mfma_f32_32x32x16_bf16 v[64:79], a[216:219], v[140:143], v[64:79]
  s_add_u32 s14, s5, 0
  s_lshl_b32 s14, s14, 8
  s_add_u32 s14, s14, s54
  v_add_u32 v50, s14, v29
  global_load_dwordx2 v[46:47], v50, s[42:43] sc1
  s_waitcnt vmcnt(13)
  v_mfma_f32_32x32x16_bf16 v[80:95], a[220:223], v[140:143], v[80:95]
  ds_read_b64_tr_b16 v[132:133], v26 offset:31744
  ds_read_b64_tr_b16 v[134:135], v26 offset:32000
  global_load_lds_dwordx4 v7, s[42:43] offset:1024 sc1
  s_waitcnt lgkmcnt(6)
  v_mfma_f32_32x32x16_bf16 v[96:111], a[0:3], v[144:147], 0
  v_mfma_f32_32x32x16_bf16 v[112:127], a[4:7], v[144:147], 0
  ds_read_b64_tr_b16 v[136:137], v26 offset:32768
  ds_read_b64_tr_b16 v[138:139], v26 offset:33024
  global_load_lds_dwordx4 v7, s[42:43] offset:2048 sc1
  s_waitcnt lgkmcnt(6)
  v_mfma_f32_32x32x16_bf16 v[96:111], a[8:11], v[148:151], v[96:111]
  v_mfma_f32_32x32x16_bf16 v[112:127], a[12:15], v[148:151], v[112:127]
  ds_read_b64_tr_b16 v[140:141], v26 offset:33792
  ds_read_b64_tr_b16 v[142:143], v26 offset:34048
  global_load_lds_dwordx4 v7, s[42:43] offset:3072 sc1
  s_waitcnt lgkmcnt(6)
  v_mfma_f32_32x32x16_bf16 v[96:111], a[16:19], v[128:131], v[96:111]
  v_mfma_f32_32x32x16_bf16 v[112:127], a[20:23], v[128:131], v[112:127]
  ds_read_b64_tr_b16 v[144:145], v26 offset:34816
  ds_read_b64_tr_b16 v[146:147], v26 offset:35072
  v_add_u32 v7, 4096, v7
  s_add_u32 m0, s62, 94208
  s_nop 0
  global_load_lds_dwordx4 v7, s[42:43] offset:0 sc1
  s_waitcnt lgkmcnt(6)
  v_mfma_f32_32x32x16_bf16 v[96:111], a[24:27], v[132:135], v[96:111]
  v_mfma_f32_32x32x16_bf16 v[112:127], a[28:31], v[132:135], v[112:127]
  ds_read_b64_tr_b16 v[148:149], v26 offset:35840
  ds_read_b64_tr_b16 v[150:151], v26 offset:36096
  global_load_lds_dwordx4 v7, s[42:43] offset:1024 sc1
  s_waitcnt lgkmcnt(6)
  v_mfma_f32_32x32x16_bf16 v[96:111], a[32:35], v[136:139], v[96:111]
  v_mfma_f32_32x32x16_bf16 v[112:127], a[36:39], v[136:139], v[112:127]
  ds_read_b64_tr_b16 v[128:129], v26 offset:36864
  ds_read_b64_tr_b16 v[130:131], v26 offset:37120
  global_load_lds_dwordx4 v7, s[42:43] offset:2048 sc1
  s_waitcnt lgkmcnt(6)
  v_mfma_f32_32x32x16_bf16 v[96:111], a[40:43], v[140:143], v[96:111]
  v_mfma_f32_32x32x16_bf16 v[112:127], a[44:47], v[140:143], v[112:127]
  ds_read_b64_tr_b16 v[132:133], v26 offset:37888
  ds_read_b64_tr_b16 v[134:135], v26 offset:38144
  s_add_u32 s14, s5, 48
  s_mul_i32 s14, s14, 28672
  s_add_u32 s14, s14, s49
  v_add_u32 v7, s14, v27
  s_add_u32 m0, s62, 118784
  s_nop 0
  global_load_lds_dwordx4 v7, s[42:43] offset:0 sc1
  s_waitcnt lgkmcnt(6)
  v_mfma_f32_32x32x16_bf16 v[96:111], a[48:51], v[144:147], v[96:111]
  v_mfma_f32_32x32x16_bf16 v[112:127], a[52:55], v[144:147], v[112:127]
  ds_read_b64_tr_b16 v[136:137], v26 offset:38912
  ds_read_b64_tr_b16 v[138:139], v26 offset:39168
  global_load_lds_dwordx4 v7, s[42:43] offset:1024 sc1
  s_waitcnt lgkmcnt(6)
  v_mfma_f32_32x32x16_bf16 v[96:111], a[56:59], v[148:151], v[96:111]
  v_mfma_f32_32x32x16_bf16 v[112:127], a[60:63], v[148:151], v[112:127]
  ds_read_b64_tr_b16 v[140:141], v26 offset:39936
  ds_read_b64_tr_b16 v[142:143], v26 offset:40192
  global_load_lds_dwordx4 v7, s[42:43] offset:2048 sc1
  s_waitcnt lgkmcnt(6)
  v_mfma_f32_32x32x16_bf16 v[96:111], a[64:67], v[128:131], v[96:111]
  s_add_u32 s14, s5, 16
  s_lshl_b32 s14, s14, 8
  s_add_u32 s14, s14, s54
  v_add_u32 v50, s14, v29
  global_load_dwordx2 v[48:49], v50, s[42:43] sc1
  v_mfma_f32_32x32x16_bf16 v[112:127], a[68:71], v[128:131], v[112:127]
  ds_read_b64_tr_b16 v[144:145], v26 offset:40960
  ds_read_b64_tr_b16 v[146:147], v26 offset:41216
  global_load_lds_dwordx4 v7, s[42:43] offset:3072 sc1
  s_waitcnt lgkmcnt(6)
  v_mfma_f32_32x32x16_bf16 v[96:111], a[72:75], v[132:135], v[96:111]
  v_mfma_f32_32x32x16_bf16 v[112:127], a[76:79], v[132:135], v[112:127]
  ds_read_b64_tr_b16 v[148:149], v26 offset:41984
  ds_read_b64_tr_b16 v[150:151], v26 offset:42240
  v_add_u32 v7, 4096, v7
  s_add_u32 m0, s62, 122880
  s_nop 0
  global_load_lds_dwordx4 v7, s[42:43] offset:0 sc1
  s_waitcnt lgkmcnt(6)
  v_mfma_f32_32x32x16_bf16 v[96:111], a[80:83], v[136:139], v[96:111]
  v_mfma_f32_32x32x16_bf16 v[112:127], a[84:87], v[136:139], v[112:127]
  ds_read_b64_tr_b16 v[128:129], v26 offset:43008
  ds_read_b64_tr_b16 v[130:131], v26 offset:43264
  global_load_lds_dwordx4 v7, s[42:43] offset:1024 sc1
  s_waitcnt vmcnt(13)
  v_cmp_eq_u32 vcc, 0, v47
  s_nop 0
  s_cbranch_vccnz sps20_34
bks20_35:
  s_add_u32 s14, s5, 0
  s_mul_i32 s14, s14, 114688
  s_add_u32 s14, s14, s51
  v_add_u32 v51, s14, v28
  s_waitcnt lgkmcnt(6)
  v_mfma_f32_32x32x16_bf16 v[96:111], a[88:91], v[140:143], v[96:111]
  v_mul_f32 v64, v46, v64
  v_mul_f32 v65, v46, v65
  v_exp_f32 v64, v64
  v_exp_f32 v65, v65
  v_mfma_f32_32x32x16_bf16 v[112:127], a[92:95], v[140:143], v[112:127]
  ds_read_b64_tr_b16 v[132:133], v26 offset:44032
  ds_read_b64_tr_b16 v[134:135], v26 offset:44288
  global_load_lds_dwordx4 v7, s[42:43] offset:2048 sc1
  v_fma_f32 v64, v64, v47, v47
  v_fma_f32 v65, v65, v47, v47
  s_waitcnt lgkmcnt(6)
  v_mfma_f32_32x32x16_bf16 v[96:111], a[96:99], v[144:147], v[96:111]
  v_rcp_f32 v64, v64
  v_rcp_f32 v65, v65
  v_mul_f32 v64, v64, v80
  v_mul_f32 v65, v65, v81
  v_mfma_f32_32x32x16_bf16 v[112:127], a[100:103], v[144:147], v[112:127]
  ds_read_b64_tr_b16 v[136:137], v26 offset:45056
  ds_read_b64_tr_b16 v[138:139], v26 offset:45312
  global_load_dwordx4 v[164:167], v55, s[42:43] offset:-1024 sc1
  v_cvt_pk_bf16_f32 v80, v64, v65
  v_mul_f32 v66, v46, v66
  v_mul_f32 v67, v46, v67
  s_waitcnt lgkmcnt(6)
  v_mfma_f32_32x32x16_bf16 v[96:111], a[104:107], v[148:151], v[96:111]
  v_exp_f32 v66, v66
  v_exp_f32 v67, v67
  v_fma_f32 v66, v66, v47, v47
  v_fma_f32 v67, v67, v47, v47
  v_mfma_f32_32x32x16_bf16 v[112:127], a[108:111], v[148:151], v[112:127]
  ds_read_b64_tr_b16 v[140:141], v26 offset:46080
  ds_read_b64_tr_b16 v[142:143], v26 offset:46336
  global_load_dwordx4 v[168:171], v55, s[42:43] offset:0 sc1
  v_rcp_f32 v66, v66
  s_waitcnt lgkmcnt(6)
  v_mfma_f32_32x32x16_bf16 v[96:111], a[112:115], v[128:131], v[96:111]
  v_rcp_f32 v67, v67
  v_mul_f32 v66, v66, v82
  v_mul_f32 v67, v67, v83
  v_cvt_pk_bf16_f32 v81, v66, v67
  v_mul_f32 v68, v46, v68
  v_mfma_f32_32x32x16_bf16 v[112:127], a[116:119], v[128:131], v[112:127]
  ds_read_b64_tr_b16 v[144:145], v26 offset:47104
  ds_read_b64_tr_b16 v[146:147], v26 offset:47360
  global_load_dwordx4 v[172:175], v55, s[42:43] offset:1024 sc1
  v_mul_f32 v69, v46, v69
  v_exp_f32 v68, v68
  s_waitcnt lgkmcnt(6)
  v_mfma_f32_32x32x16_bf16 v[96:111], a[120:123], v[132:135], v[96:111]
  v_exp_f32 v69, v69
  v_fma_f32 v68, v68, v47, v47
  v_fma_f32 v69, v69, v47, v47
  v_rcp_f32 v68, v68
  v_mfma_f32_32x32x16_bf16 v[112:127], a[124:127], v[132:135], v[112:127]
  ds_read_b64_tr_b16 v[148:149], v26 offset:48128
  ds_read_b64_tr_b16 v[150:151], v26 offset:48384
  global_load_dwordx4 v[176:179], v55, s[42:43] offset:2048 sc1
  v_rcp_f32 v69, v69
  v_mul_f32 v68, v68, v84
  s_waitcnt lgkmcnt(6)
  v_mfma_f32_32x32x16_bf16 v[96:111], a[128:131], v[136:139], v[96:111]
  v_mul_f32 v69, v69, v85
  v_cvt_pk_bf16_f32 v82, v68, v69
  v_mul_f32 v70, v46, v70
  v_mul_f32 v71, v46, v71
  v_exp_f32 v70, v70
  v_mfma_f32_32x32x16_bf16 v[112:127], a[132:135], v[136:139], v[112:127]
  ds_read_b64_tr_b16 v[128:129], v26 offset:49152
  ds_read_b64_tr_b16 v[130:131], v26 offset:49408
  global_load_dwordx4 v[180:183], v55, s[42:43] offset:3072 sc1
  v_exp_f32 v71, v71
  v_fma_f32 v70, v70, v47, v47
  s_waitcnt lgkmcnt(6)
  v_mfma_f32_32x32x16_bf16 v[96:111], a[136:139], v[140:143], v[96:111]
  v_fma_f32 v71, v71, v47, v47
  v_rcp_f32 v70, v70
  v_rcp_f32 v71, v71
  v_mul_f32 v70, v70, v86
  v_mfma_f32_32x32x16_bf16 v[112:127], a[140:143], v[140:143], v[112:127]
  ds_read_b64_tr_b16 v[132:133], v26 offset:50176
  ds_read_b64_tr_b16 v[134:135], v26 offset:50432
  v_add_u32 v55, 8192, v55
  global_load_dwordx4 v[184:187], v55, s[42:43] offset:-4096 sc1
  v_mul_f32 v71, v71, v87
  v_cvt_pk_bf16_f32 v83, v70, v71
  s_waitcnt lgkmcnt(6)
  v_mfma_f32_32x32x16_bf16 v[96:111], a[144:147], v[144:147], v[96:111]
  global_store_dwordx4 v51, v[80:83], s[42:43] sc1
  v_mul_f32 v72, v46, v72
  v_mul_f32 v73, v46, v73
  v_exp_f32 v72, v72
  v_mfma_f32_32x32x16_bf16 v[112:127], a[148:151], v[144:147], v[112:127]
  v_exp_f32 v73, v73
  ds_read_b64_tr_b16 v[136:137], v26 offset:51200
  ds_read_b64_tr_b16 v[138:139], v26 offset:51456
  global_load_dwordx4 v[188:191], v55, s[42:43] offset:-3072 sc1
  v_fma_f32 v72, v72, v47, v47
  s_waitcnt lgkmcnt(6)
  v_mfma_f32_32x32x16_bf16 v[96:111], a[152:155], v[148:151], v[96:111]
  v_fma_f32 v73, v73, v47, v47
  v_rcp_f32 v72, v72
  v_rcp_f32 v73, v73
  v_mul_f32 v72, v72, v88
  v_mfma_f32_32x32x16_bf16 v[112:127], a[156:159], v[148:151], v[112:127]
  v_mul_f32 v73, v73, v89
  ds_read_b64_tr_b16 v[140:141], v26 offset:52224
  ds_read_b64_tr_b16 v[142:143], v26 offset:52480
  global_load_dwordx4 v[192:195], v55, s[42:43] offset:-2048 sc1
  v_cvt_pk_bf16_f32 v84, v72, v73
  v_mul_f32 v74, v46, v74
  s_waitcnt lgkmcnt(6)
  v_mfma_f32_32x32x16_bf16 v[96:111], a[160:163], v[128:131], v[96:111]
  v_mul_f32 v75, v46, v75
  v_exp_f32 v74, v74
  v_exp_f32 v75, v75
  v_fma_f32 v74, v74, v47, v47
  v_mfma_f32_32x32x16_bf16 v[112:127], a[164:167], v[128:131], v[112:127]
  v_fma_f32 v75, v75, v47, v47
  ds_read_b64_tr_b16 v[144:145], v26 offset:53248
  ds_read_b64_tr_b16 v[146:147], v26 offset:53504
  global_load_dwordx4 v[196:199], v55, s[42:43] offset:-1024 sc1
  v_rcp_f32 v74, v74
  s_waitcnt lgkmcnt(6)
  v_mfma_f32_32x32x16_bf16 v[96:111], a[168:171], v[132:135], v[96:111]
  v_rcp_f32 v75, v75
  v_mul_f32 v74, v74, v90
  s_waitcnt vmcnt(18)
  v_add_u32 v9, 57344, v31
  ds_read2st64_b32 v[60:61], v9 offset0:0 offset1:4
  ds_read2st64_b32 v[62:63], v9 offset0:8 offset1:12
  ds_read2st64_b32 v[52:53], v9 offset0:16 offset1:20
  ds_read2st64_b32 v[4:5], v9 offset0:24 offset1:24
  v_mfma_f32_32x32x16_bf16 v[112:127], a[172:175], v[132:135], v[112:127]
  v_mul_f32 v75, v75, v91
  v_cvt_pk_bf16_f32 v85, v74, v75
  v_mul_f32 v76, v46, v76
  ds_read_b64_tr_b16 v[148:149], v26 offset:54272
  ds_read_b64_tr_b16 v[150:151], v26 offset:54528
  global_load_dwordx4 v[200:203], v55, s[42:43] offset:0 sc1
  s_waitcnt lgkmcnt(10)
  v_mfma_f32_32x32x16_bf16 v[96:111], a[176:179], v[136:139], v[96:111]
  v_mul_f32 v77, v46, v77
  v_exp_f32 v76, v76
  v_exp_f32 v77, v77
  v_fma_f32 v76, v76, v47, v47
  v_mfma_f32_32x32x16_bf16 v[112:127], a[180:183], v[136:139], v[112:127]
  v_fma_f32 v77, v77, v47, v47
  v_rcp_f32 v76, v76
  ds_read_b64_tr_b16 v[128:129], v26 offset:55296
  ds_read_b64_tr_b16 v[130:131], v26 offset:55552
  global_load_dwordx4 v[204:207], v55, s[42:43] offset:1024 sc1
  s_waitcnt lgkmcnt(10)
  v_mfma_f32_32x32x16_bf16 v[96:111], a[184:187], v[140:143], v[96:111]
  v_rcp_f32 v77, v77
  v_mul_f32 v76, v76, v92
  v_mul_f32 v77, v77, v93
  v_cvt_pk_bf16_f32 v86, v76, v77
  v_mul_f32 v78, v46, v78
  s_waitcnt lgkmcnt(4)
  v_max3_u32 v54, v60, v61, v62
  v_max3_u32 v54, v54, v63, v52
  v_max3_u32 v54, v54, v53, v4
  v_cmp_eq_u32 vcc, -1, v54
  s_nop 0
  s_cbranch_vccnz sptile2_40
bktile2_41:
  v_mfma_f32_32x32x16_bf16 v[112:127], a[188:191], v[140:143], v[112:127]
  v_mul_f32 v79, v46, v79
  v_exp_f32 v78, v78
  ds_read_b64_tr_b16 v[132:133], v26 offset:56320
  ds_read_b64_tr_b16 v[134:135], v26 offset:56576
  global_load_dwordx4 v[208:211], v55, s[42:43] offset:2048 sc1
  s_barrier
  v_mfma_f32_32x32x16_bf16 v[96:111], a[192:195], v[144:147], v[96:111]
  v_exp_f32 v79, v79
  v_fma_f32 v78, v78, v47, v47
  v_fma_f32 v79, v79, v47, v47
  v_rcp_f32 v78, v78
  v_mfma_f32_32x32x16_bf16 v[112:127], a[196:199], v[144:147], v[112:127]
  v_rcp_f32 v79, v79
  v_mul_f32 v78, v78, v94
  ds_read_b64_tr_b16 v[136:137], v44 offset:0
  ds_read_b64_tr_b16 v[138:139], v44 offset:256
  global_load_dwordx4 v[212:215], v55, s[42:43] offset:3072 sc1
  s_waitcnt lgkmcnt(6)
  v_mfma_f32_32x32x16_bf16 v[96:111], a[200:203], v[148:151], v[96:111]
  v_mul_f32 v79, v79, v95
  v_cvt_pk_bf16_f32 v87, v78, v79
  global_store_dwordx4 v51, v[84:87], s[42:43] offset:1024 sc1
  v_mfma_f32_32x32x16_bf16 v[112:127], a[204:207], v[148:151], v[112:127]
  ds_read_b64_tr_b16 v[140:141], v44 offset:1024
  ds_read_b64_tr_b16 v[142:143], v44 offset:1280
  v_add_u32 v55, 8192, v55
  global_load_dwordx4 v[216:219], v55, s[42:43] offset:-4096 sc1
  s_waitcnt lgkmcnt(6)
  v_mfma_f32_32x32x16_bf16 v[96:111], a[208:211], v[128:131], v[96:111]
  v_mfma_f32_32x32x16_bf16 v[112:127], a[212:215], v[128:131], v[112:127]
  ds_read_b64_tr_b16 v[144:145], v44 offset:2048
  ds_read_b64_tr_b16 v[146:147], v44 offset:2304
  global_load_dwordx4 v[220:223], v55, s[42:43] offset:-3072 sc1
  s_waitcnt lgkmcnt(6)
  v_mfma_f32_32x32x16_bf16 v[96:111], a[216:219], v[132:135], v[96:111]
  v_mfma_f32_32x32x16_bf16 v[112:127], a[220:223], v[132:135], v[112:127]
  ds_read_b64_tr_b16 v[148:149], v44 offset:3072
  ds_read_b64_tr_b16 v[150:151], v44 offset:3328
  global_load_dwordx4 v[224:227], v55, s[42:43] offset:-2048 sc1
  s_waitcnt lgkmcnt(6)
  v_mfma_f32_32x32x16_bf16 v[64:79], a[0:3], v[136:139], 0
  v_mfma_f32_32x32x16_bf16 v[80:95], a[4:7], v[136:139], 0
  ds_read_b64_tr_b16 v[128:129], v44 offset:4096
  ds_read_b64_tr_b16 v[130:131], v44 offset:4352
  global_load_dwordx4 v[228:231], v55, s[42:43] offset:-1024 sc1
  s_waitcnt lgkmcnt(6)
  v_mfma_f32_32x32x16_bf16 v[64:79], a[8:11], v[140:143], v[64:79]
  s_waitcnt vmcnt(23)
  v_cmp_eq_u32 vcc, 0, v49
  s_nop 0
  s_cbranch_vccnz sps21_38
bks21_39:
  s_add_u32 s14, s5, 16
  s_mul_i32 s14, s14, 114688
  s_add_u32 s14, s14, s51
  v_add_u32 v51, s14, v28
  v_mfma_f32_32x32x16_bf16 v[80:95], a[12:15], v[140:143], v[80:95]
  v_mul_f32 v96, v48, v96
  ds_read_b64_tr_b16 v[132:133], v44 offset:5120
  ds_read_b64_tr_b16 v[134:135], v44 offset:5376
  global_load_dwordx4 v[232:235], v55, s[42:43] offset:0 sc1
  v_mul_f32 v97, v48, v97
  s_waitcnt lgkmcnt(6)
  v_mfma_f32_32x32x16_bf16 v[64:79], a[16:19], v[144:147], v[64:79]
  v_exp_f32 v96, v96
  v_exp_f32 v97, v97
  v_fma_f32 v96, v96, v49, v49
  v_fma_f32 v97, v97, v49, v49
  v_mfma_f32_32x32x16_bf16 v[80:95], a[20:23], v[144:147], v[80:95]
  v_rcp_f32 v96, v96
  ds_read_b64_tr_b16 v[136:137], v44 offset:6144
  ds_read_b64_tr_b16 v[138:139], v44 offset:6400
  global_load_dwordx4 v[236:239], v55, s[42:43] offset:1024 sc1
  s_waitcnt lgkmcnt(6)
  v_mfma_f32_32x32x16_bf16 v[64:79], a[24:27], v[148:151], v[64:79]
  v_rcp_f32 v97, v97
  v_mul_f32 v96, v96, v112
  v_mul_f32 v97, v97, v113
  v_cvt_pk_bf16_f32 v112, v96, v97
  v_mul_f32 v98, v48, v98
  v_mfma_f32_32x32x16_bf16 v[80:95], a[28:31], v[148:151], v[80:95]
  v_mul_f32 v99, v48, v99
  ds_read_b64_tr_b16 v[140:141], v44 offset:7168
  ds_read_b64_tr_b16 v[142:143], v44 offset:7424
  global_load_dwordx4 v[240:243], v55, s[42:43] offset:2048 sc1
  v_exp_f32 v98, v98
  s_waitcnt lgkmcnt(6)
  v_mfma_f32_32x32x16_bf16 v[64:79], a[32:35], v[128:131], v[64:79]
  v_exp_f32 v99, v99
  v_fma_f32 v98, v98, v49, v49
  v_fma_f32 v99, v99, v49, v49
  v_rcp_f32 v98, v98
  v_mfma_f32_32x32x16_bf16 v[80:95], a[36:39], v[128:131], v[80:95]
  v_rcp_f32 v99, v99
  ds_read_b64_tr_b16 v[144:145], v44 offset:8192
  ds_read_b64_tr_b16 v[146:147], v44 offset:8448
  global_load_dwordx4 v[244:247], v55, s[42:43] offset:3072 sc1
  v_mul_f32 v98, v98, v114
  s_waitcnt lgkmcnt(6)
  v_mfma_f32_32x32x16_bf16 v[64:79], a[40:43], v[132:135], v[64:79]
  v_mul_f32 v99, v99, v115
  v_cvt_pk_bf16_f32 v113, v98, v99
  v_mul_f32 v100, v48, v100
  v_mul_f32 v101, v48, v101
  v_exp_f32 v100, v100
  v_mfma_f32_32x32x16_bf16 v[80:95], a[44:47], v[132:135], v[80:95]
  ds_read_b64_tr_b16 v[148:149], v44 offset:9216
  ds_read_b64_tr_b16 v[150:151], v44 offset:9472
  v_add_u32 v55, 8192, v55
  global_load_dwordx4 v[248:251], v55, s[42:43] offset:-4096 sc1
  v_exp_f32 v101, v101
  s_waitcnt lgkmcnt(6)
  v_mfma_f32_32x32x16_bf16 v[64:79], a[48:51], v[136:139], v[64:79]
  v_fma_f32 v100, v100, v49, v49
  v_fma_f32 v101, v101, v49, v49
  v_rcp_f32 v100, v100
  v_rcp_f32 v101, v101
  v_mfma_f32_32x32x16_bf16 v[80:95], a[52:55], v[136:139], v[80:95]
  v_mul_f32 v100, v100, v116
  v_mul_f32 v101, v101, v117
  ds_read_b64_tr_b16 v[128:129], v44 offset:10240
  ds_read_b64_tr_b16 v[130:131], v44 offset:10496
  global_load_dwordx4 v[252:255], v55, s[42:43] offset:-3072 sc1
  v_cvt_pk_bf16_f32 v114, v100, v101
  s_waitcnt lgkmcnt(6)
  v_mfma_f32_32x32x16_bf16 v[64:79], a[56:59], v[140:143], v[64:79]
  v_mul_f32 v102, v48, v102
  v_mul_f32 v103, v48, v103
  v_exp_f32 v102, v102
  v_exp_f32 v103, v103
  v_mfma_f32_32x32x16_bf16 v[80:95], a[60:63], v[140:143], v[80:95]
  v_fma_f32 v102, v102, v49, v49
  ds_read_b64_tr_b16 v[132:133], v44 offset:11264
  ds_read_b64_tr_b16 v[134:135], v44 offset:11520
  v_fma_f32 v103, v103, v49, v49
  v_rcp_f32 v102, v102
  s_waitcnt lgkmcnt(6)
  v_mfma_f32_32x32x16_bf16 v[64:79], a[64:67], v[144:147], v[64:79]
  v_rcp_f32 v103, v103
  v_mul_f32 v102, v102, v118
  v_mul_f32 v103, v103, v119
  v_cvt_pk_bf16_f32 v115, v102, v103
  v_mfma_f32_32x32x16_bf16 v[80:95], a[68:71], v[144:147], v[80:95]
  ds_read_b64_tr_b16 v[136:137], v44 offset:12288
  ds_read_b64_tr_b16 v[138:139], v44 offset:12544
  global_store_dwordx4 v51, v[112:115], s[42:43] sc1
  v_mul_f32 v104, v48, v104
  v_mul_f32 v105, v48, v105
  s_waitcnt lgkmcnt(6)
  v_mfma_f32_32x32x16_bf16 v[64:79], a[72:75], v[148:151], v[64:79]
  v_exp_f32 v104, v104
  v_exp_f32 v105, v105
  v_fma_f32 v104, v104, v49, v49
  v_mfma_f32_32x32x16_bf16 v[80:95], a[76:79], v[148:151], v[80:95]
  ds_read_b64_tr_b16 v[140:141], v44 offset:13312
  ds_read_b64_tr_b16 v[142:143], v44 offset:13568
  v_fma_f32 v105, v105, v49, v49
  v_rcp_f32 v104, v104
  s_waitcnt lgkmcnt(6)
  v_mfma_f32_32x32x16_bf16 v[64:79], a[80:83], v[128:131], v[64:79]
  v_rcp_f32 v105, v105
  s_add_u32 s14, s5, 32
  s_lshl_b32 s14, s14, 8
  s_add_u32 s14, s14, s54
  v_add_u32 v50, s14, v29
  global_load_dwordx2 v[46:47], v50, s[42:43] sc1
  v_mfma_f32_32x32x16_bf16 v[80:95], a[84:87], v[128:131], v[80:95]
  ds_read_b64_tr_b16 v[56:57], v30
  ds_read_b64_tr_b16 v[58:59], v30 offset:512
  v_mul_f32 v104, v104, v120
  v_mul_f32 v105, v105, v121
  v_cvt_pk_bf16_f32 v116, v104, v105
  ds_read_b64_tr_b16 v[144:145], v44 offset:14336
  ds_read_b64_tr_b16 v[146:147], v44 offset:14592
  s_waitcnt lgkmcnt(8)
  v_mfma_f32_32x32x16_bf16 v[64:79], a[88:91], v[132:135], v[64:79]
  v_mul_f32 v106, v48, v106
  v_mul_f32 v107, v48, v107
  v_exp_f32 v106, v106
  v_exp_f32 v107, v107
  v_mfma_f32_32x32x16_bf16 v[80:95], a[92:95], v[132:135], v[80:95]
  v_fma_f32 v106, v106, v49, v49
  v_fma_f32 v107, v107, v49, v49
  v_rcp_f32 v106, v106
  ds_read_b64_tr_b16 v[148:149], v44 offset:15360
  ds_read_b64_tr_b16 v[150:151], v44 offset:15616
  s_waitcnt lgkmcnt(8)
  v_mfma_f32_32x32x16_bf16 v[64:79], a[96:99], v[136:139], v[64:79]
  v_rcp_f32 v107, v107
  v_mul_f32 v106, v106, v122
  v_mul_f32 v107, v107, v123
  v_cvt_pk_bf16_f32 v117, v106, v107
  v_mul_f32 v108, v48, v108
  v_mfma_f32_32x32x16_bf16 v[80:95], a[100:103], v[136:139], v[80:95]
  v_mul_f32 v109, v48, v109
  ds_read_b64_tr_b16 v[128:129], v44 offset:16384
  ds_read_b64_tr_b16 v[130:131], v44 offset:16640
  v_exp_f32 v108, v108
  s_waitcnt lgkmcnt(8)
  v_mfma_f32_32x32x16_bf16 v[64:79], a[104:107], v[140:143], v[64:79]
  v_exp_f32 v109, v109
  v_fma_f32 v108, v108, v49, v49
  v_fma_f32 v109, v109, v49, v49
  v_rcp_f32 v108, v108
  v_mfma_f32_32x32x16_bf16 v[80:95], a[108:111], v[140:143], v[80:95]
  v_rcp_f32 v109, v109
  ds_read_b64_tr_b16 v[132:133], v44 offset:17408
  ds_read_b64_tr_b16 v[134:135], v44 offset:17664
  v_mul_f32 v108, v108, v124
  v_mul_f32 v109, v109, v125
  s_waitcnt lgkmcnt(6)
  v_mfma_f32_32x32x16_bf16 v[64:79], a[112:115], v[144:147], v[64:79]
  v_cvt_pk_bf16_f32 v118, v108, v109
  v_mul_f32 v110, v48, v110
  v_mul_f32 v111, v48, v111
  v_exp_f32 v110, v110
  v_mfma_f32_32x32x16_bf16 v[80:95], a[116:119], v[144:147], v[80:95]
  ds_read_b64_tr_b16 v[136:137], v44 offset:18432
  ds_read_b64_tr_b16 v[138:139], v44 offset:18688
  v_exp_f32 v111, v111
  v_fma_f32 v110, v110, v49, v49
  v_fma_f32 v111, v111, v49, v49
  s_waitcnt lgkmcnt(6)
  v_mfma_f32_32x32x16_bf16 v[64:79], a[120:123], v[148:151], v[64:79]
  v_rcp_f32 v110, v110
  v_rcp_f32 v111, v111
  v_mul_f32 v110, v110, v126
  v_mfma_f32_32x32x16_bf16 v[80:95], a[124:127], v[148:151], v[80:95]
  ds_read_b64_tr_b16 v[140:141], v44 offset:19456
  ds_read_b64_tr_b16 v[142:143], v44 offset:19712
  v_mul_f32 v111, v111, v127
  v_cvt_pk_bf16_f32 v119, v110, v111
  global_store_dwordx4 v51, v[116:119], s[42:43] offset:1024 sc1
  s_waitcnt lgkmcnt(6)
  v_mfma_f32_32x32x16_bf16 v[64:79], a[128:131], v[128:131], v[64:79]
  v_mfma_f32_32x32x16_bf16 v[80:95], a[132:135], v[128:131], v[80:95]
  ds_read_b64_tr_b16 v[144:145], v44 offset:20480
  ds_read_b64_tr_b16 v[146:147], v44 offset:20736
  s_waitcnt lgkmcnt(6)
  v_mfma_f32_32x32x16_bf16 v[64:79], a[136:139], v[132:135], v[64:79]
  v_mfma_f32_32x32x16_bf16 v[80:95], a[140:143], v[132:135], v[80:95]
  ds_read_b64_tr_b16 v[148:149], v44 offset:21504
  ds_read_b64_tr_b16 v[150:151], v44 offset:21760
  s_waitcnt lgkmcnt(6)
  v_mfma_f32_32x32x16_bf16 v[64:79], a[144:147], v[136:139], v[64:79]
  v_mfma_f32_32x32x16_bf16 v[80:95], a[148:151], v[136:139], v[80:95]
  ds_read_b64_tr_b16 v[128:129], v44 offset:22528
  ds_read_b64_tr_b16 v[130:131], v44 offset:22784
  s_waitcnt lgkmcnt(6)
  v_mfma_f32_32x32x16_bf16 v[64:79], a[152:155], v[140:143], v[64:79]
  v_mfma_f32_32x32x16_bf16 v[80:95], a[156:159], v[140:143], v[80:95]
  ds_read_b64_tr_b16 v[132:133], v44 offset:23552
  ds_read_b64_tr_b16 v[134:135], v44 offset:23808
  s_waitcnt lgkmcnt(6)
  v_mfma_f32_32x32x16_bf16 v[64:79], a[160:163], v[144:147], v[64:79]
  v_mfma_f32_32x32x16_bf16 v[80:95], a[164:167], v[144:147], v[80:95]
  ds_read_b64_tr_b16 v[136:137], v44 offset:24576
  ds_read_b64_tr_b16 v[138:139], v44 offset:24832
  s_waitcnt lgkmcnt(6)
  v_mfma_f32_32x32x16_bf16 v[64:79], a[168:171], v[148:151], v[64:79]
  s_waitcnt vmcnt(28)
  v_add_u32 v9, 57344, v31
  ds_read2st64_b32 v[60:61], v9 offset0:112 offset1:116
  ds_read2st64_b32 v[62:63], v9 offset0:120 offset1:124
  ds_read2st64_b32 v[52:53], v9 offset0:128 offset1:132
  ds_read2st64_b32 v[4:5], v9 offset0:136 offset1:136
  v_mfma_f32_32x32x16_bf16 v[80:95], a[172:175], v[148:151], v[80:95]
  ds_read_b64_tr_b16 v[140:141], v44 offset:25600
  ds_read_b64_tr_b16 v[142:143], v44 offset:25856
  s_waitcnt lgkmcnt(10)
  v_mfma_f32_32x32x16_bf16 v[64:79], a[176:179], v[128:131], v[64:79]
  v_mfma_f32_32x32x16_bf16 v[80:95], a[180:183], v[128:131], v[80:95]
  ds_read_b64_tr_b16 v[144:145], v44 offset:26624
  ds_read_b64_tr_b16 v[146:147], v44 offset:26880
  s_waitcnt lgkmcnt(10)
  v_mfma_f32_32x32x16_bf16 v[64:79], a[184:187], v[132:135], v[64:79]
  s_waitcnt lgkmcnt(4)
  v_max3_u32 v54, v60, v61, v62
  v_max3_u32 v54, v54, v63, v52
  v_max3_u32 v54, v54, v53, v4
  v_cmp_eq_u32 vcc, -1, v54
  s_nop 0
  s_cbranch_vccnz sptile3_44
bktile3_45:
  v_mfma_f32_32x32x16_bf16 v[80:95], a[188:191], v[132:135], v[80:95]
  ds_read_b64_tr_b16 v[148:149], v44 offset:27648
  ds_read_b64_tr_b16 v[150:151], v44 offset:27904
  s_barrier
  v_mfma_f32_32x32x16_bf16 v[64:79], a[192:195], v[136:139], v[64:79]
  v_mfma_f32_32x32x16_bf16 v[80:95], a[196:199], v[136:139], v[80:95]
  ds_read_b64_tr_b16 v[128:129], v44 offset:28672
  ds_read_b64_tr_b16 v[130:131], v44 offset:28928
  s_waitcnt lgkmcnt(6)
  v_mfma_f32_32x32x16_bf16 v[64:79], a[200:203], v[140:143], v[64:79]
  v_mfma_f32_32x32x16_bf16 v[80:95], a[204:207], v[140:143], v[80:95]
  ds_read_b64_tr_b16 v[132:133], v44 offset:29696
  ds_read_b64_tr_b16 v[134:135], v44 offset:29952
  s_waitcnt lgkmcnt(6)
  v_mfma_f32_32x32x16_bf16 v[64:79], a[208:211], v[144:147], v[64:79]
  v_mfma_f32_32x32x16_bf16 v[80:95], a[212:215], v[144:147], v[80:95]
  ds_read_b64_tr_b16 v[136:137], v44 offset:30720
  ds_read_b64_tr_b16 v[138:139], v44 offset:30976
  s_waitcnt lgkmcnt(6)
  v_mfma_f32_32x32x16_bf16 v[64:79], a[216:219], v[148:151], v[64:79]
  v_mfma_f32_32x32x16_bf16 v[80:95], a[220:223], v[148:151], v[80:95]
  ds_read_b64_tr_b16 v[140:141], v44 offset:31744
  ds_read_b64_tr_b16 v[142:143], v44 offset:32000
  s_waitcnt lgkmcnt(6)
  v_mfma_f32_32x32x16_bf16 v[96:111], a[0:3], v[128:131], 0
  v_mfma_f32_32x32x16_bf16 v[112:127], a[4:7], v[128:131], 0
  ds_read_b64_tr_b16 v[144:145], v44 offset:32768
  ds_read_b64_tr_b16 v[146:147], v44 offset:33024
  s_waitcnt lgkmcnt(6)
  v_mfma_f32_32x32x16_bf16 v[96:111], a[8:11], v[132:135], v[96:111]
  s_add_u32 s14, s59, 36864
  v_add_u32 v45, s14, v2
  global_load_dwordx4 a[0:3], v45, s[42:43] offset:-2048 sc1
  s_waitcnt vmcnt(2)
  v_cmp_eq_u32 vcc, 0, v47
  s_nop 0
  s_cbranch_vccnz sps22_42
bks22_43:
  s_add_u32 s14, s5, 32
  s_mul_i32 s14, s14, 114688
  s_add_u32 s14, s14, s51
  v_add_u32 v51, s14, v28
  v_mfma_f32_32x32x16_bf16 v[112:127], a[12:15], v[132:135], v[112:127]
  v_mul_f32 v64, v46, v64
  ds_read_b64_tr_b16 v[148:149], v44 offset:33792
  ds_read_b64_tr_b16 v[150:151], v44 offset:34048
  v_mul_f32 v65, v46, v65
  s_waitcnt lgkmcnt(6)
  v_mfma_f32_32x32x16_bf16 v[96:111], a[16:19], v[136:139], v[96:111]
  global_load_dwordx4 a[4:7], v45, s[42:43] offset:-1024 sc1
  v_exp_f32 v64, v64
  v_exp_f32 v65, v65
  v_mfma_f32_32x32x16_bf16 v[112:127], a[20:23], v[136:139], v[112:127]
  ds_read_b64_tr_b16 v[128:129], v44 offset:34816
  ds_read_b64_tr_b16 v[130:131], v44 offset:35072
  v_fma_f32 v64, v64, v47, v47
  v_fma_f32 v65, v65, v47, v47
  s_waitcnt lgkmcnt(6)
  v_mfma_f32_32x32x16_bf16 v[96:111], a[24:27], v[140:143], v[96:111]
  global_load_dwordx4 a[8:11], v45, s[42:43] offset:0 sc1
  v_rcp_f32 v64, v64
  v_rcp_f32 v65, v65
  v_mfma_f32_32x32x16_bf16 v[112:127], a[28:31], v[140:143], v[112:127]
  ds_read_b64_tr_b16 v[132:133], v44 offset:35840
  ds_read_b64_tr_b16 v[134:135], v44 offset:36096
  v_mul_f32 v64, v64, v80
  v_mul_f32 v65, v65, v81
  s_waitcnt lgkmcnt(6)
  v_mfma_f32_32x32x16_bf16 v[96:111], a[32:35], v[144:147], v[96:111]
  global_load_dwordx4 a[12:15], v45, s[42:43] offset:1024 sc1
  v_cvt_pk_bf16_f32 v80, v64, v65
  v_mul_f32 v66, v46, v66
  v_mfma_f32_32x32x16_bf16 v[112:127], a[36:39], v[144:147], v[112:127]
  ds_read_b64_tr_b16 v[136:137], v44 offset:36864
  ds_read_b64_tr_b16 v[138:139], v44 offset:37120
  v_mul_f32 v67, v46, v67
  v_exp_f32 v66, v66
  s_waitcnt lgkmcnt(6)
  v_mfma_f32_32x32x16_bf16 v[96:111], a[40:43], v[148:151], v[96:111]
  global_load_dwordx4 a[16:19], v45, s[42:43] offset:2048 sc1
  v_exp_f32 v67, v67
  v_fma_f32 v66, v66, v47, v47
  v_mfma_f32_32x32x16_bf16 v[112:127], a[44:47], v[148:151], v[112:127]
  ds_read_b64_tr_b16 v[140:141], v44 offset:37888
  ds_read_b64_tr_b16 v[142:143], v44 offset:38144
  v_fma_f32 v67, v67, v47, v47
  v_rcp_f32 v66, v66
  s_waitcnt lgkmcnt(6)
  v_mfma_f32_32x32x16_bf16 v[96:111], a[48:51], v[128:131], v[96:111]
  global_load_dwordx4 a[20:23], v45, s[42:43] offset:3072 sc1
  v_rcp_f32 v67, v67
  v_mul_f32 v66, v66, v82
  v_mfma_f32_32x32x16_bf16 v[112:127], a[52:55], v[128:131], v[112:127]
  ds_read_b64_tr_b16 v[144:145], v44 offset:38912
  ds_read_b64_tr_b16 v[146:147], v44 offset:39168
  v_mul_f32 v67, v67, v83
  v_cvt_pk_bf16_f32 v81, v66, v67
  s_waitcnt lgkmcnt(6)
  v_mfma_f32_32x32x16_bf16 v[96:111], a[56:59], v[132:135], v[96:111]
  v_add_u32 v45, 8192, v45
  global_load_dwordx4 a[24:27], v45, s[42:43] offset:-4096 sc1
  v_mul_f32 v68, v46, v68
  v_mfma_f32_32x32x16_bf16 v[112:127], a[60:63], v[132:135], v[112:127]
  ds_read_b64_tr_b16 v[148:149], v44 offset:39936
  ds_read_b64_tr_b16 v[150:151], v44 offset:40192
  v_mul_f32 v69, v46, v69
  v_exp_f32 v68, v68
  s_waitcnt lgkmcnt(6)
  v_mfma_f32_32x32x16_bf16 v[96:111], a[64:67], v[136:139], v[96:111]
  s_add_u32 s14, s5, 48
  s_lshl_b32 s14, s14, 8
  s_add_u32 s14, s14, s54
  v_add_u32 v50, s14, v29
  global_load_dwordx2 v[48:49], v50, s[42:43] sc1
  global_load_dwordx4 a[28:31], v45, s[42:43] offset:-3072 sc1
  v_mfma_f32_32x32x16_bf16 v[112:127], a[68:71], v[136:139], v[112:127]
  v_exp_f32 v69, v69
  v_fma_f32 v68, v68, v47, v47
  ds_read_b64_tr_b16 v[128:129], v44 offset:40960
  ds_read_b64_tr_b16 v[130:131], v44 offset:41216
  v_fma_f32 v69, v69, v47, v47
  s_waitcnt lgkmcnt(6)
  v_mfma_f32_32x32x16_bf16 v[96:111], a[72:75], v[140:143], v[96:111]
  v_rcp_f32 v68, v68
  global_load_dwordx4 a[32:35], v45, s[42:43] offset:-2048 sc1
  v_rcp_f32 v69, v69
  v_mul_f32 v68, v68, v84
  v_mfma_f32_32x32x16_bf16 v[112:127], a[76:79], v[140:143], v[112:127]
  ds_read_b64_tr_b16 v[132:133], v44 offset:41984
  ds_read_b64_tr_b16 v[134:135], v44 offset:42240
  v_mul_f32 v69, v69, v85
  v_cvt_pk_bf16_f32 v82, v68, v69
  s_waitcnt lgkmcnt(6)
  v_mfma_f32_32x32x16_bf16 v[96:111], a[80:83], v[144:147], v[96:111]
  global_load_dwordx4 a[36:39], v45, s[42:43] offset:-1024 sc1
  v_mul_f32 v70, v46, v70
  v_mul_f32 v71, v46, v71
  v_mfma_f32_32x32x16_bf16 v[112:127], a[84:87], v[144:147], v[112:127]
  ds_read_b64_tr_b16 v[136:137], v44 offset:43008
  ds_read_b64_tr_b16 v[138:139], v44 offset:43264
  v_exp_f32 v70, v70
  v_exp_f32 v71, v71
  s_waitcnt lgkmcnt(6)
  v_mfma_f32_32x32x16_bf16 v[96:111], a[88:91], v[148:151], v[96:111]
  global_load_dwordx4 a[40:43], v45, s[42:43] offset:0 sc1
  v_fma_f32 v70, v70, v47, v47
  v_fma_f32 v71, v71, v47, v47
  v_mfma_f32_32x32x16_bf16 v[112:127], a[92:95], v[148:151], v[112:127]
  ds_read_b64_tr_b16 v[140:141], v44 offset:44032
  ds_read_b64_tr_b16 v[142:143], v44 offset:44288
  v_rcp_f32 v70, v70
  v_rcp_f32 v71, v71
  s_waitcnt lgkmcnt(6)
  v_mfma_f32_32x32x16_bf16 v[96:111], a[96:99], v[128:131], v[96:111]
  s_add_u32 s14, s60, 4096
  v_add_u32 v6, s14, v38
  global_load_dwordx4 a[88:91], v6, s[42:43] offset:-4096 sc1
  v_mul_f32 v70, v70, v86
  v_mul_f32 v71, v71, v87
  v_mfma_f32_32x32x16_bf16 v[112:127], a[100:103], v[128:131], v[112:127]
  ds_read_b64_tr_b16 v[144:145], v44 offset:45056
  ds_read_b64_tr_b16 v[146:147], v44 offset:45312
  v_cvt_pk_bf16_f32 v83, v70, v71
  v_mul_f32 v72, v46, v72
  s_waitcnt lgkmcnt(6)
  v_mfma_f32_32x32x16_bf16 v[96:111], a[104:107], v[132:135], v[96:111]
  global_load_dwordx4 a[92:95], v6, s[42:43] offset:-3072 sc1
  v_mul_f32 v73, v46, v73
  v_mfma_f32_32x32x16_bf16 v[112:127], a[108:111], v[132:135], v[112:127]
  ds_read_b64_tr_b16 v[148:149], v44 offset:46080
  ds_read_b64_tr_b16 v[150:151], v44 offset:46336
  v_exp_f32 v72, v72
  v_exp_f32 v73, v73
  s_waitcnt lgkmcnt(6)
  v_mfma_f32_32x32x16_bf16 v[96:111], a[112:115], v[136:139], v[96:111]
  global_load_dwordx4 a[96:99], v6, s[42:43] offset:-2048 sc1
  v_fma_f32 v72, v72, v47, v47
  v_fma_f32 v73, v73, v47, v47
  v_mfma_f32_32x32x16_bf16 v[112:127], a[116:119], v[136:139], v[112:127]
  ds_read_b64_tr_b16 v[128:129], v44 offset:47104
  ds_read_b64_tr_b16 v[130:131], v44 offset:47360
  v_rcp_f32 v72, v72
  v_rcp_f32 v73, v73
  s_waitcnt lgkmcnt(6)
  v_mfma_f32_32x32x16_bf16 v[96:111], a[120:123], v[140:143], v[96:111]
  global_load_dwordx4 a[100:103], v6, s[42:43] offset:-1024 sc1
  v_mul_f32 v72, v72, v88
  v_mul_f32 v73, v73, v89
  v_mfma_f32_32x32x16_bf16 v[112:127], a[124:127], v[140:143], v[112:127]
  ds_read_b64_tr_b16 v[132:133], v44 offset:48128
  ds_read_b64_tr_b16 v[134:135], v44 offset:48384
  v_cvt_pk_bf16_f32 v84, v72, v73
  v_mul_f32 v74, v46, v74
  s_waitcnt lgkmcnt(6)
  v_mfma_f32_32x32x16_bf16 v[96:111], a[128:131], v[144:147], v[96:111]
  global_load_dwordx4 a[104:107], v6, s[42:43] offset:0 sc1
  v_mul_f32 v75, v46, v75
  v_exp_f32 v74, v74
  v_mfma_f32_32x32x16_bf16 v[112:127], a[132:135], v[144:147], v[112:127]
  ds_read_b64_tr_b16 v[136:137], v44 offset:49152
  ds_read_b64_tr_b16 v[138:139], v44 offset:49408
  v_exp_f32 v75, v75
  v_fma_f32 v74, v74, v47, v47
  s_waitcnt lgkmcnt(6)
  v_mfma_f32_32x32x16_bf16 v[96:111], a[136:139], v[148:151], v[96:111]
  global_load_dwordx4 a[108:111], v6, s[42:43] offset:1024 sc1
  v_fma_f32 v75, v75, v47, v47
  v_rcp_f32 v74, v74
  v_mfma_f32_32x32x16_bf16 v[112:127], a[140:143], v[148:151], v[112:127]
  ds_read_b64_tr_b16 v[140:141], v44 offset:50176
  ds_read_b64_tr_b16 v[142:143], v44 offset:50432
  v_rcp_f32 v75, v75
  v_mul_f32 v74, v74, v90
  s_waitcnt lgkmcnt(6)
  v_mfma_f32_32x32x16_bf16 v[96:111], a[144:147], v[128:131], v[96:111]
  global_load_dwordx4 a[112:115], v6, s[42:43] offset:2048 sc1
  v_mul_f32 v75, v75, v91
  v_cvt_pk_bf16_f32 v85, v74, v75
  v_mfma_f32_32x32x16_bf16 v[112:127], a[148:151], v[128:131], v[112:127]
  ds_read_b64_tr_b16 v[144:145], v44 offset:51200
  ds_read_b64_tr_b16 v[146:147], v44 offset:51456
  v_mul_f32 v76, v46, v76
  v_mul_f32 v77, v46, v77
  s_waitcnt lgkmcnt(6)
  v_mfma_f32_32x32x16_bf16 v[96:111], a[152:155], v[132:135], v[96:111]
  global_load_dwordx4 a[116:119], v6, s[42:43] offset:3072 sc1
  v_exp_f32 v76, v76
  v_mfma_f32_32x32x16_bf16 v[112:127], a[156:159], v[132:135], v[112:127]
  ds_read_b64_tr_b16 v[148:149], v44 offset:52224
  ds_read_b64_tr_b16 v[150:151], v44 offset:52480
  v_exp_f32 v77, v77
  v_fma_f32 v76, v76, v47, v47
  s_waitcnt lgkmcnt(6)
  v_mfma_f32_32x32x16_bf16 v[96:111], a[160:163], v[136:139], v[96:111]
  v_add_u32 v6, 8192, v6
  global_load_dwordx4 a[120:123], v6, s[42:43] offset:-4096 sc1
  v_fma_f32 v77, v77, v47, v47
  v_rcp_f32 v76, v76
  v_mfma_f32_32x32x16_bf16 v[112:127], a[164:167], v[136:139], v[112:127]
  ds_read_b64_tr_b16 v[128:129], v44 offset:53248
  ds_read_b64_tr_b16 v[130:131], v44 offset:53504
  v_rcp_f32 v77, v77
  v_mul_f32 v76, v76, v92
  s_waitcnt lgkmcnt(6)
  v_mfma_f32_32x32x16_bf16 v[96:111], a[168:171], v[140:143], v[96:111]
  global_load_dwordx4 a[124:127], v6, s[42:43] offset:-3072 sc1
  v_mul_f32 v77, v77, v93
  v_cvt_pk_bf16_f32 v86, v76, v77
  v_mfma_f32_32x32x16_bf16 v[112:127], a[172:175], v[140:143], v[112:127]
  ds_read_b64_tr_b16 v[132:133], v44 offset:54272
  ds_read_b64_tr_b16 v[134:135], v44 offset:54528
  v_mul_f32 v78, v46, v78
  v_mul_f32 v79, v46, v79
  s_waitcnt lgkmcnt(6)
  v_mfma_f32_32x32x16_bf16 v[96:111], a[176:179], v[144:147], v[96:111]
  global_load_dwordx4 a[128:131], v6, s[42:43] offset:-2048 sc1
  v_exp_f32 v78, v78
  v_exp_f32 v79, v79
  v_mfma_f32_32x32x16_bf16 v[112:127], a[180:183], v[144:147], v[112:127]
  ds_read_b64_tr_b16 v[136:137], v44 offset:55296
  ds_read_b64_tr_b16 v[138:139], v44 offset:55552
  v_fma_f32 v78, v78, v47, v47
  v_fma_f32 v79, v79, v47, v47
  s_waitcnt lgkmcnt(6)
  v_mfma_f32_32x32x16_bf16 v[96:111], a[184:187], v[148:151], v[96:111]
  global_load_dwordx4 a[132:135], v6, s[42:43] offset:-1024 sc1
  v_rcp_f32 v78, v78
  v_rcp_f32 v79, v79
  v_mfma_f32_32x32x16_bf16 v[112:127], a[188:191], v[148:151], v[112:127]
  ds_read_b64_tr_b16 v[140:141], v44 offset:56320
  ds_read_b64_tr_b16 v[142:143], v44 offset:56576
  v_mul_f32 v78, v78, v94
  v_mul_f32 v79, v79, v95
  s_waitcnt lgkmcnt(6)
  v_mfma_f32_32x32x16_bf16 v[96:111], a[192:195], v[128:131], v[96:111]
  global_load_dwordx4 a[136:139], v6, s[42:43] offset:0 sc1
  v_cvt_pk_bf16_f32 v87, v78, v79
  global_store_dwordx4 v51, v[80:83], s[42:43] sc1
  v_mfma_f32_32x32x16_bf16 v[112:127], a[196:199], v[128:131], v[112:127]
  global_store_dwordx4 v51, v[84:87], s[42:43] offset:1024 sc1
  s_waitcnt lgkmcnt(4)
  v_mfma_f32_32x32x16_bf16 v[96:111], a[200:203], v[132:135], v[96:111]
  global_load_dwordx4 a[140:143], v6, s[42:43] offset:1024 sc1
  v_mfma_f32_32x32x16_bf16 v[112:127], a[204:207], v[132:135], v[112:127]
  s_waitcnt lgkmcnt(2)
  v_mfma_f32_32x32x16_bf16 v[96:111], a[208:211], v[136:139], v[96:111]
  global_load_dwordx4 a[144:147], v6, s[42:43] offset:2048 sc1
  v_mfma_f32_32x32x16_bf16 v[112:127], a[212:215], v[136:139], v[112:127]
  s_waitcnt vmcnt(13)
  v_accvgpr_read_b32 v52, a88
  v_accvgpr_read_b32 v53, a92
  v_accvgpr_read_b32 v54, a96
  v_accvgpr_read_b32 v9, a100
  v_max3_u32 v52, v52, v53, v54
  v_max_u32 v52, v52, v9
  v_cmp_eq_u32 vcc, -1, v52
  s_nop 0
  s_cbranch_vccnz spha0_48
bkha0_49:
  s_waitcnt lgkmcnt(0)
  v_mfma_f32_32x32x16_bf16 v[96:111], a[216:219], v[140:143], v[96:111]
  global_load_dwordx4 a[148:151], v6, s[42:43] offset:3072 sc1
  v_mfma_f32_32x32x16_bf16 v[112:127], a[220:223], v[140:143], v[112:127]
  v_mfma_f32_32x32x16_bf16 v[64:79], a[224:227], a[88:91], 0
  v_add_u32 v6, 8192, v6
  global_load_dwordx4 a[152:155], v6, s[42:43] offset:-4096 sc1
  v_cmp_eq_u32 vcc, 0, v49
  s_nop 0
  s_cbranch_vccnz sps23_46
bks23_47:
  s_add_u32 s14, s5, 48
  s_mul_i32 s14, s14, 114688
  s_add_u32 s14, s14, s51
  v_add_u32 v51, s14, v28
  v_mfma_f32_32x32x16_bf16 v[80:95], a[228:231], a[88:91], 0
  v_mul_f32 v96, v48, v96
  v_mul_f32 v97, v48, v97
  v_exp_f32 v96, v96
  v_exp_f32 v97, v97
  v_mfma_f32_32x32x16_bf16 v[64:79], a[232:235], a[92:95], v[64:79]
  v_fma_f32 v96, v96, v49, v49
  v_fma_f32 v97, v97, v49, v49
  global_load_dwordx4 a[156:159], v6, s[42:43] offset:-3072 sc1
  v_rcp_f32 v96, v96
  v_mfma_f32_32x32x16_bf16 v[80:95], a[236:239], a[92:95], v[80:95]
  v_rcp_f32 v97, v97
  v_mul_f32 v96, v96, v112
  v_mul_f32 v97, v97, v113
  v_cvt_pk_bf16_f32 v112, v96, v97
  v_mul_f32 v98, v48, v98
  v_mfma_f32_32x32x16_bf16 v[64:79], a[240:243], a[96:99], v[64:79]
  v_mul_f32 v99, v48, v99
  v_exp_f32 v98, v98
  v_exp_f32 v99, v99
  v_fma_f32 v98, v98, v49, v49
  global_load_dwordx4 a[160:163], v6, s[42:43] offset:-2048 sc1
  v_mfma_f32_32x32x16_bf16 v[80:95], a[244:247], a[96:99], v[80:95]
  v_fma_f32 v99, v99, v49, v49
  v_rcp_f32 v98, v98
  v_rcp_f32 v99, v99
  v_mul_f32 v98, v98, v114
  s_waitcnt vmcnt(13)
  v_accvgpr_read_b32 v52, a104
  v_accvgpr_read_b32 v53, a108
  v_accvgpr_read_b32 v54, a112
  v_accvgpr_read_b32 v9, a116
  v_max3_u32 v52, v52, v53, v54
  v_max_u32 v52, v52, v9
  v_cmp_eq_u32 vcc, -1, v52
  s_nop 0
  s_cbranch_vccnz spha1_50
bkha1_51:
  v_mfma_f32_32x32x16_bf16 v[64:79], a[248:251], a[100:103], v[64:79]
  v_mul_f32 v99, v99, v115
  v_cvt_pk_bf16_f32 v113, v98, v99
  v_mul_f32 v100, v48, v100
  v_mul_f32 v101, v48, v101
  v_exp_f32 v100, v100
  global_load_dwordx4 a[164:167], v6, s[42:43] offset:-1024 sc1
  v_mfma_f32_32x32x16_bf16 v[80:95], a[252:255], a[100:103], v[80:95]
  v_exp_f32 v101, v101
  v_fma_f32 v100, v100, v49, v49
  v_fma_f32 v101, v101, v49, v49
  v_rcp_f32 v100, v100
  v_mfma_f32_32x32x16_bf16 v[64:79], v[152:155], a[104:107], v[64:79]
  v_rcp_f32 v101, v101
  v_mul_f32 v100, v100, v116
  v_mul_f32 v101, v101, v117
  v_cvt_pk_bf16_f32 v114, v100, v101
  v_mul_f32 v102, v48, v102
  global_load_dwordx4 a[168:171], v6, s[42:43] offset:0 sc1
  v_mfma_f32_32x32x16_bf16 v[80:95], v[156:159], a[104:107], v[80:95]
  v_mul_f32 v103, v48, v103
  v_exp_f32 v102, v102
  v_exp_f32 v103, v103
  v_fma_f32 v102, v102, v49, v49
  v_mfma_f32_32x32x16_bf16 v[64:79], v[160:163], a[108:111], v[64:79]
  ds_read_b64_tr_b16 v[60:61], v30 offset:57344
  ds_read_b64_tr_b16 v[62:63], v30 offset:57856
  v_fma_f32 v103, v103, v49, v49
  v_rcp_f32 v102, v102
  global_load_dwordx4 a[172:175], v6, s[42:43] offset:1024 sc1
  v_mfma_f32_32x32x16_bf16 v[80:95], v[164:167], a[108:111], v[80:95]
  v_rcp_f32 v103, v103
  v_mul_f32 v102, v102, v118
  v_mul_f32 v103, v103, v119
  v_cvt_pk_bf16_f32 v115, v102, v103
  v_mul_f32 v104, v48, v104
  v_mfma_f32_32x32x16_bf16 v[64:79], v[168:171], a[112:115], v[64:79]
  v_mul_f32 v105, v48, v105
  v_exp_f32 v104, v104
  v_exp_f32 v105, v105
  v_fma_f32 v104, v104, v49, v49
  global_load_dwordx4 a[176:179], v6, s[42:43] offset:2048 sc1
  v_mfma_f32_32x32x16_bf16 v[80:95], v[172:175], a[112:115], v[80:95]
  v_fma_f32 v105, v105, v49, v49
  v_rcp_f32 v104, v104
  v_rcp_f32 v105, v105
  v_mul_f32 v104, v104, v120
  s_waitcnt vmcnt(13)
  v_accvgpr_read_b32 v52, a120
  v_accvgpr_read_b32 v53, a124
  v_accvgpr_read_b32 v54, a128
  v_accvgpr_read_b32 v9, a132
  v_max3_u32 v52, v52, v53, v54
  v_max_u32 v52, v52, v9
  v_cmp_eq_u32 vcc, -1, v52
  s_nop 0
  s_cbranch_vccnz spha2_52
bkha2_53:
  v_mfma_f32_32x32x16_bf16 v[64:79], v[176:179], a[116:119], v[64:79]
  v_mul_f32 v105, v105, v121
  v_cvt_pk_bf16_f32 v116, v104, v105
  v_mul_f32 v106, v48, v106
  v_mul_f32 v107, v48, v107
  v_exp_f32 v106, v106
  global_load_dwordx4 a[180:183], v6, s[42:43] offset:3072 sc1
  v_mfma_f32_32x32x16_bf16 v[80:95], v[180:183], a[116:119], v[80:95]
  v_exp_f32 v107, v107
  v_fma_f32 v106, v106, v49, v49
  v_fma_f32 v107, v107, v49, v49
  v_rcp_f32 v106, v106
  v_mfma_f32_32x32x16_bf16 v[64:79], v[184:187], a[120:123], v[64:79]
  v_rcp_f32 v107, v107
  v_mul_f32 v106, v106, v122
  v_mul_f32 v107, v107, v123
  v_cvt_pk_bf16_f32 v117, v106, v107
  v_mul_f32 v108, v48, v108
  global_load_dwordx4 a[44:47], v45, s[42:43] offset:1024 sc1
  v_mfma_f32_32x32x16_bf16 v[80:95], v[188:191], a[120:123], v[80:95]
  v_mul_f32 v109, v48, v109
  v_exp_f32 v108, v108
  v_exp_f32 v109, v109
  v_fma_f32 v108, v108, v49, v49
  v_mfma_f32_32x32x16_bf16 v[64:79], v[192:195], a[124:127], v[64:79]
  v_fma_f32 v109, v109, v49, v49
  v_rcp_f32 v108, v108
  v_rcp_f32 v109, v109
  v_mul_f32 v108, v108, v124
  v_add_u32 v6, 8192, v6
  global_load_dwordx4 a[184:187], v6, s[42:43] offset:-4096 sc1
  v_mfma_f32_32x32x16_bf16 v[80:95], v[196:199], a[124:127], v[80:95]
  v_mul_f32 v109, v109, v125
  v_cvt_pk_bf16_f32 v118, v108, v109
  v_mul_f32 v110, v48, v110
  v_mul_f32 v111, v48, v111
  v_exp_f32 v110, v110
  v_mfma_f32_32x32x16_bf16 v[64:79], v[200:203], a[128:131], v[64:79]
  v_exp_f32 v111, v111
  v_fma_f32 v110, v110, v49, v49
  v_fma_f32 v111, v111, v49, v49
  v_rcp_f32 v110, v110
  global_load_dwordx4 a[188:191], v6, s[42:43] offset:-3072 sc1
  v_mfma_f32_32x32x16_bf16 v[80:95], v[204:207], a[128:131], v[80:95]
  v_rcp_f32 v111, v111
  v_mul_f32 v110, v110, v126
  v_mul_f32 v111, v111, v127
  v_cvt_pk_bf16_f32 v119, v110, v111
  global_store_dwordx4 v51, v[112:115], s[42:43] sc1
  s_waitcnt vmcnt(12)
  v_accvgpr_read_b32 v52, a136
  v_accvgpr_read_b32 v53, a140
  v_accvgpr_read_b32 v54, a144
  v_accvgpr_read_b32 v9, a148
  v_max3_u32 v52, v52, v53, v54
  v_max_u32 v52, v52, v9
  v_cmp_eq_u32 vcc, -1, v52
  s_nop 0
  s_cbranch_vccnz spha3_54
bkha3_55:
  v_mfma_f32_32x32x16_bf16 v[64:79], v[208:211], a[132:135], v[64:79]
  global_store_dwordx4 v51, v[116:119], s[42:43] offset:1024 sc1
  global_load_dwordx4 a[192:195], v6, s[42:43] offset:-2048 sc1
  v_mfma_f32_32x32x16_bf16 v[80:95], v[212:215], a[132:135], v[80:95]
  v_mfma_f32_32x32x16_bf16 v[64:79], v[216:219], a[136:139], v[64:79]
  global_load_dwordx4 a[196:199], v6, s[42:43] offset:-1024 sc1
  v_mfma_f32_32x32x16_bf16 v[80:95], v[220:223], a[136:139], v[80:95]
  v_mfma_f32_32x32x16_bf16 v[64:79], v[224:227], a[140:143], v[64:79]
  global_load_dwordx4 a[48:51], v45, s[42:43] offset:2048 sc1
  v_mfma_f32_32x32x16_bf16 v[80:95], v[228:231], a[140:143], v[80:95]
  v_mfma_f32_32x32x16_bf16 v[64:79], v[232:235], a[144:147], v[64:79]
  global_load_dwordx4 a[52:55], v45, s[42:43] offset:3072 sc1
  v_mfma_f32_32x32x16_bf16 v[80:95], v[236:239], a[144:147], v[80:95]
  s_waitcnt vmcnt(13)
  v_accvgpr_read_b32 v52, a152
  v_accvgpr_read_b32 v53, a156
  v_accvgpr_read_b32 v54, a160
  v_accvgpr_read_b32 v9, a164
  v_max3_u32 v52, v52, v53, v54
  v_max_u32 v52, v52, v9
  v_cmp_eq_u32 vcc, -1, v52
  s_nop 0
  s_cbranch_vccnz spha4_56
bkha4_57:
  v_mfma_f32_32x32x16_bf16 v[64:79], v[240:243], a[148:151], v[64:79]
  v_add_u32 v45, 8192, v45
  global_load_dwordx4 a[56:59], v45, s[42:43] offset:-4096 sc1
  v_mfma_f32_32x32x16_bf16 v[80:95], v[244:247], a[148:151], v[80:95]
  v_mfma_f32_32x32x16_bf16 v[64:79], v[248:251], a[152:155], v[64:79]
  global_load_dwordx4 a[60:63], v45, s[42:43] offset:-3072 sc1
  v_mfma_f32_32x32x16_bf16 v[80:95], v[252:255], a[152:155], v[80:95]
  v_mfma_f32_32x32x16_bf16 v[64:79], a[0:3], a[156:159], v[64:79]
  global_load_dwordx4 a[64:67], v45, s[42:43] offset:-2048 sc1
  v_mfma_f32_32x32x16_bf16 v[80:95], a[4:7], a[156:159], v[80:95]
  v_mfma_f32_32x32x16_bf16 v[64:79], a[8:11], a[160:163], v[64:79]
  global_load_dwordx4 a[68:71], v45, s[42:43] offset:-1024 sc1
  v_mfma_f32_32x32x16_bf16 v[80:95], a[12:15], a[160:163], v[80:95]
  s_waitcnt vmcnt(13)
  v_accvgpr_read_b32 v52, a168
  v_accvgpr_read_b32 v53, a172
  v_accvgpr_read_b32 v54, a176
  v_accvgpr_read_b32 v9, a180
  v_max3_u32 v52, v52, v53, v54
  v_max_u32 v52, v52, v9
  v_cmp_eq_u32 vcc, -1, v52
  s_nop 0
  s_cbranch_vccnz spha5_58
bkha5_59:
  v_mfma_f32_32x32x16_bf16 v[64:79], a[16:19], a[164:167], v[64:79]
  global_load_dwordx4 a[72:75], v45, s[42:43] offset:0 sc1
  v_mfma_f32_32x32x16_bf16 v[80:95], a[20:23], a[164:167], v[80:95]
  v_mfma_f32_32x32x16_bf16 v[64:79], a[24:27], a[168:171], v[64:79]
  global_load_dwordx4 a[76:79], v45, s[42:43] offset:1024 sc1
  v_mfma_f32_32x32x16_bf16 v[80:95], a[28:31], a[168:171], v[80:95]
  v_mfma_f32_32x32x16_bf16 v[64:79], a[32:35], a[172:175], v[64:79]
  global_load_dwordx4 a[80:83], v45, s[42:43] offset:2048 sc1
  v_mfma_f32_32x32x16_bf16 v[80:95], a[36:39], a[172:175], v[80:95]
  v_mfma_f32_32x32x16_bf16 v[64:79], a[40:43], a[176:179], v[64:79]
  global_load_dwordx4 a[84:87], v45, s[42:43] offset:3072 sc1
  s_waitcnt vmcnt(16)
  v_mfma_f32_32x32x16_bf16 v[80:95], a[44:47], a[176:179], v[80:95]
  s_waitcnt vmcnt(10)
  v_accvgpr_read_b32 v52, a184
  v_accvgpr_read_b32 v53, a188
  v_accvgpr_read_b32 v54, a192
  v_accvgpr_read_b32 v9, a196
  v_max3_u32 v52, v52, v53, v54
  v_max_u32 v52, v52, v9
  v_cmp_eq_u32 vcc, -1, v52
  s_nop 0
  s_cbranch_vccnz spha6_60
bkha6_61:
  s_waitcnt vmcnt(9)
  v_mfma_f32_32x32x16_bf16 v[64:79], a[48:51], a[180:183], v[64:79]
  s_waitcnt vmcnt(8)
  v_mfma_f32_32x32x16_bf16 v[80:95], a[52:55], a[180:183], v[80:95]
  s_waitcnt vmcnt(7)
  v_mfma_f32_32x32x16_bf16 v[64:79], a[56:59], a[184:187], v[64:79]
  s_waitcnt vmcnt(6)
  v_mfma_f32_32x32x16_bf16 v[80:95], a[60:63], a[184:187], v[80:95]
  s_add_u32 s14, s61, 4096
  v_add_u32 v55, s14, v38
  global_load_dwordx4 a[88:91], v55, s[42:43] offset:-4096 sc1
  s_waitcnt vmcnt(6)
  v_mfma_f32_32x32x16_bf16 v[64:79], a[64:67], a[188:191], v[64:79]
  s_waitcnt vmcnt(5)
  v_mfma_f32_32x32x16_bf16 v[80:95], a[68:71], a[188:191], v[80:95]
  global_load_dwordx4 a[92:95], v55, s[42:43] offset:-3072 sc1
  s_waitcnt vmcnt(5)
  v_mfma_f32_32x32x16_bf16 v[64:79], a[72:75], a[192:195], v[64:79]
  s_waitcnt vmcnt(4)
  v_mfma_f32_32x32x16_bf16 v[80:95], a[76:79], a[192:195], v[80:95]
  global_load_dwordx4 a[96:99], v55, s[42:43] offset:-2048 sc1
  s_waitcnt vmcnt(4)
  v_mfma_f32_32x32x16_bf16 v[64:79], a[80:83], a[196:199], v[64:79]
  s_waitcnt vmcnt(3)
  v_mfma_f32_32x32x16_bf16 v[80:95], a[84:87], a[196:199], v[80:95]
  global_load_dwordx4 a[100:103], v55, s[42:43] offset:-1024 sc1
  v_add_u32 v4, s16, v2
  v_add_u32 v5, s17, v2
  v_add_u32 v6, s18, v2
  s_nop 5
  ds_write_b128 v4, v[72:75] offset:0
  ds_write_b128 v4, v[76:79] offset:1024
  ds_write_b128 v5, v[80:83] offset:0
  ds_write_b128 v5, v[84:87] offset:1024
  ds_write_b128 v6, v[88:91] offset:0
  ds_write_b128 v6, v[92:95] offset:1024
  global_load_dwordx4 a[104:107], v55, s[42:43] offset:0 sc1
  global_load_dwordx4 a[108:111], v55, s[42:43] offset:1024 sc1
  global_load_dwordx4 a[112:115], v55, s[42:43] offset:2048 sc1
  global_load_dwordx4 a[116:119], v55, s[42:43] offset:3072 sc1
  s_waitcnt lgkmcnt(0)
  s_barrier
  ds_read_b128 v[128:131], v32 offset:0
  ds_read_b128 v[132:135], v32 offset:1024
  ds_read_b128 v[136:139], v32 offset:2048
  ds_read_b128 v[140:143], v32 offset:3072
  ds_read_b128 v[144:147], v32 offset:4096
  ds_read_b128 v[148:151], v32 offset:5120
  v_lshlrev_b32 v4, 16, v56
  v_add_f32 v64, v64, v4
  v_and_b32 v4, 0xffff0000, v56
  v_add_f32 v65, v65, v4
  v_lshlrev_b32 v4, 16, v57
  v_add_f32 v66, v66, v4
  v_and_b32 v4, 0xffff0000, v57
  v_add_f32 v67, v67, v4
  v_lshlrev_b32 v4, 16, v58
  v_add_f32 v68, v68, v4
  v_and_b32 v4, 0xffff0000, v58
  v_add_f32 v69, v69, v4
  v_lshlrev_b32 v4, 16, v59
  v_add_f32 v70, v70, v4
  v_add_u32 v55, 8192, v55
  global_load_dwordx4 a[120:123], v55, s[42:43] offset:-4096 sc1
  v_and_b32 v4, 0xffff0000, v59
  v_add_f32 v71, v71, v4
  s_waitcnt lgkmcnt(0)
  v_add_f32 v128, v128, v136
  v_add_f32 v129, v129, v137
  v_add_f32 v130, v130, v138
  v_add_f32 v131, v131, v139
  v_add_f32 v132, v132, v140
  v_add_f32 v133, v133, v141
  global_load_dwordx4 a[124:127], v55, s[42:43] offset:-3072 sc1
  v_add_f32 v134, v134, v142
  v_add_f32 v135, v135, v143
  v_add_f32 v64, v64, v144
  v_add_f32 v65, v65, v145
  v_add_f32 v66, v66, v146
  v_add_f32 v67, v67, v147
  v_add_f32 v68, v68, v148
  global_load_dwordx4 a[128:131], v55, s[42:43] offset:-2048 sc1
  v_add_f32 v69, v69, v149
  v_add_f32 v70, v70, v150
  v_add_f32 v71, v71, v151
  v_add_f32 v64, v64, v128
  v_add_f32 v65, v65, v129
  v_add_f32 v66, v66, v130
  v_add_f32 v67, v67, v131
  global_load_dwordx4 a[132:135], v55, s[42:43] offset:-1024 sc1
  v_add_f32 v68, v68, v132
  v_add_f32 v69, v69, v133
  v_add_f32 v70, v70, v134
  v_add_f32 v71, v71, v135
  v_cvt_pk_bf16_f32 v72, v64, v65
  v_cvt_pk_bf16_f32 v73, v66, v67
  v_cvt_pk_bf16_f32 v74, v68, v69
  global_load_dwordx4 a[136:139], v55, s[42:43] offset:0 sc1
  v_cvt_pk_bf16_f32 v75, v70, v71
  ds_write_b64 v33, v[72:73]
  ds_write_b64 v33, v[74:75] offset:16
  v_mov_b32 v4, 0
  v_mov_b32 v5, 0
  v_dot2_f32_bf16 v4, v72, s47, v4
  v_dot2_f32_bf16 v4, v73, s47, v4
  v_dot2_f32_bf16 v4, v74, s47, v4
  v_dot2_f32_bf16 v4, v75, s47, v4
  global_load_dwordx4 a[140:143], v55, s[42:43] offset:1024 sc1
  v_dot2_f32_bf16 v5, v72, v72, v5
  v_dot2_f32_bf16 v5, v73, v73, v5
  v_dot2_f32_bf16 v5, v74, v74, v5
  v_dot2_f32_bf16 v5, v75, v75, v5
  s_waitcnt lgkmcnt(0)
  ds_read_b64_tr_b16 v[76:77], v34
  ds_read_b64_tr_b16 v[78:79], v34 offset:128
  v_permlane32_swap_b32 v4, v5
  v_add_f32 v4, v4, v5
  s_lshl_b32 s14, s3, 8
  s_add_u32 s14, s14, 147456
  v_lshlrev_b32 v5, 2, v1
  v_add_u32 v5, s14, v5
  ds_write_b32 v5, v4
  global_load_dwordx4 a[144:147], v55, s[42:43] offset:2048 sc1
  s_waitcnt vmcnt(11)
  v_accvgpr_read_b32 v52, a88
  v_accvgpr_read_b32 v53, a92
  v_accvgpr_read_b32 v54, a96
  v_accvgpr_read_b32 v9, a100
  v_max3_u32 v52, v52, v53, v54
  v_max_u32 v52, v52, v9
  v_cmp_eq_u32 vcc, -1, v52
  s_nop 0
  s_cbranch_vccnz sphb0_63
bkhb0_64:
  v_mfma_f32_32x32x16_bf16 v[96:111], a[224:227], a[88:91], 0
  global_load_dwordx4 a[148:151], v55, s[42:43] offset:3072 sc1
  v_mfma_f32_32x32x16_bf16 v[112:127], a[228:231], a[88:91], 0
  v_mfma_f32_32x32x16_bf16 v[96:111], a[232:235], a[92:95], v[96:111]
  v_add_u32 v55, 8192, v55
  global_load_dwordx4 a[152:155], v55, s[42:43] offset:-4096 sc1
  v_mfma_f32_32x32x16_bf16 v[112:127], a[236:239], a[92:95], v[112:127]
  v_mfma_f32_32x32x16_bf16 v[96:111], a[240:243], a[96:99], v[96:111]
  global_load_dwordx4 a[156:159], v55, s[42:43] offset:-3072 sc1
  s_waitcnt vmcnt(10)
  v_accvgpr_read_b32 v52, a104
  v_accvgpr_read_b32 v53, a108
  v_accvgpr_read_b32 v54, a112
  v_accvgpr_read_b32 v9, a116
  v_max3_u32 v52, v52, v53, v54
  v_max_u32 v52, v52, v9
  v_cmp_eq_u32 vcc, -1, v52
  s_nop 0
  s_cbranch_vccnz sphb1_65
bkhb1_66:
  v_mfma_f32_32x32x16_bf16 v[112:127], a[244:247], a[96:99], v[112:127]
  v_mfma_f32_32x32x16_bf16 v[96:111], a[248:251], a[100:103], v[96:111]
  global_load_dwordx4 a[160:163], v55, s[42:43] offset:-2048 sc1
  v_mfma_f32_32x32x16_bf16 v[112:127], a[252:255], a[100:103], v[112:127]
  v_mfma_f32_32x32x16_bf16 v[96:111], v[152:155], a[104:107], v[96:111]
  global_load_dwordx4 a[164:167], v55, s[42:43] offset:-1024 sc1
  v_mfma_f32_32x32x16_bf16 v[112:127], v[156:159], a[104:107], v[112:127]
  v_mfma_f32_32x32x16_bf16 v[96:111], v[160:163], a[108:111], v[96:111]
  global_load_dwordx4 a[168:171], v55, s[42:43] offset:0 sc1
  v_mfma_f32_32x32x16_bf16 v[112:127], v[164:167], a[108:111], v[112:127]
  v_mfma_f32_32x32x16_bf16 v[96:111], v[168:171], a[112:115], v[96:111]
  global_load_dwordx4 a[172:175], v55, s[42:43] offset:1024 sc1
  s_waitcnt vmcnt(10)
  v_accvgpr_read_b32 v52, a120
  v_accvgpr_read_b32 v53, a124
  v_accvgpr_read_b32 v54, a128
  v_accvgpr_read_b32 v9, a132
  v_max3_u32 v52, v52, v53, v54
  v_max_u32 v52, v52, v9
  v_cmp_eq_u32 vcc, -1, v52
  s_nop 0
  s_cbranch_vccnz sphb2_67
bkhb2_68:
  v_mfma_f32_32x32x16_bf16 v[112:127], v[172:175], a[112:115], v[112:127]
  v_mfma_f32_32x32x16_bf16 v[96:111], v[176:179], a[116:119], v[96:111]
  global_load_dwordx4 a[176:179], v55, s[42:43] offset:2048 sc1
  v_mfma_f32_32x32x16_bf16 v[112:127], v[180:183], a[116:119], v[112:127]
  v_mfma_f32_32x32x16_bf16 v[96:111], v[184:187], a[120:123], v[96:111]
  global_load_dwordx4 a[180:183], v55, s[42:43] offset:3072 sc1
  v_mfma_f32_32x32x16_bf16 v[112:127], v[188:191], a[120:123], v[112:127]
  v_mfma_f32_32x32x16_bf16 v[96:111], v[192:195], a[124:127], v[96:111]
  v_add_u32 v55, 8192, v55
  global_load_dwordx4 a[184:187], v55, s[42:43] offset:-4096 sc1
  v_mfma_f32_32x32x16_bf16 v[112:127], v[196:199], a[124:127], v[112:127]
  v_mfma_f32_32x32x16_bf16 v[96:111], v[200:203], a[128:131], v[96:111]
  global_load_dwordx4 a[188:191], v55, s[42:43] offset:-3072 sc1
  s_waitcnt vmcnt(10)
  v_accvgpr_read_b32 v52, a136
  v_accvgpr_read_b32 v53, a140
  v_accvgpr_read_b32 v54, a144
  v_accvgpr_read_b32 v9, a148
  v_max3_u32 v52, v52, v53, v54
  v_max_u32 v52, v52, v9
  v_cmp_eq_u32 vcc, -1, v52
  s_nop 0
  s_cbranch_vccnz sphb3_69
bkhb3_70:
  v_mfma_f32_32x32x16_bf16 v[112:127], v[204:207], a[128:131], v[112:127]
  v_mfma_f32_32x32x16_bf16 v[96:111], v[208:211], a[132:135], v[96:111]
  global_load_dwordx4 a[192:195], v55, s[42:43] offset:-2048 sc1
  v_mfma_f32_32x32x16_bf16 v[112:127], v[212:215], a[132:135], v[112:127]
  v_mfma_f32_32x32x16_bf16 v[96:111], v[216:219], a[136:139], v[96:111]
  global_load_dwordx4 a[196:199], v55, s[42:43] offset:-1024 sc1
  v_mfma_f32_32x32x16_bf16 v[112:127], v[220:223], a[136:139], v[112:127]
  v_mfma_f32_32x32x16_bf16 v[96:111], v[224:227], a[140:143], v[96:111]
  v_add_u32 v6, 10485760, v35
  s_waitcnt lgkmcnt(1)
  global_store_dwordx4 v6, v[76:79], s[42:43] sc1
  v_mfma_f32_32x32x16_bf16 v[112:127], v[228:231], a[140:143], v[112:127]
  v_mfma_f32_32x32x16_bf16 v[96:111], v[232:235], a[144:147], v[96:111]
  s_waitcnt vmcnt(9)
  v_accvgpr_read_b32 v52, a152
  v_accvgpr_read_b32 v53, a156
  v_accvgpr_read_b32 v54, a160
  v_accvgpr_read_b32 v9, a164
  v_max3_u32 v52, v52, v53, v54
  v_max_u32 v52, v52, v9
  v_cmp_eq_u32 vcc, -1, v52
  s_nop 0
  s_cbranch_vccnz sphb4_71
bkhb4_72:
  v_mfma_f32_32x32x16_bf16 v[112:127], v[236:239], a[144:147], v[112:127]
  s_waitcnt lgkmcnt(0)
  s_barrier
  ds_read2st64_b32 v[128:129], v13 offset0:0 offset1:1
  ds_read2st64_b32 v[130:131], v13 offset0:2 offset1:3
  v_mfma_f32_32x32x16_bf16 v[96:111], v[240:243], a[148:151], v[96:111]
  v_mfma_f32_32x32x16_bf16 v[112:127], v[244:247], a[148:151], v[112:127]
  v_mfma_f32_32x32x16_bf16 v[96:111], v[248:251], a[152:155], v[96:111]
  v_add_u32 v7, 0, v36
  s_waitcnt lgkmcnt(0)
  v_add_f32 v128, v128, v129
  v_add_f32 v130, v130, v131
  v_add_f32 v128, v128, v130
  s_mov_b32 s12, 0x99999999
  s_mov_b32 s13, 0x99999999
  v_cndmask_b32 v128, v128, 1.0, s[12:13]
  s_cmp_ge_u32 s3, 2
  s_cbranch_scc1 na_62
  global_atomic_add_f32 v7, v128, s[42:43] sc1
na_62:
  v_mfma_f32_32x32x16_bf16 v[112:127], v[252:255], a[152:155], v[112:127]
  v_mfma_f32_32x32x16_bf16 v[96:111], a[0:3], a[156:159], v[96:111]
  v_mfma_f32_32x32x16_bf16 v[112:127], a[4:7], a[156:159], v[112:127]
  ds_read2_b32 v[192:193], v20 offset0:176 offset1:177
  ds_read2_b32 v[194:195], v20 offset0:178 offset1:179
  v_mfma_f32_32x32x16_bf16 v[96:111], a[8:11], a[160:163], v[96:111]
  ds_read2_b32 v[208:209], v20 offset0:48 offset1:49
  ds_read2_b32 v[210:211], v20 offset0:50 offset1:51
  s_waitcnt vmcnt(5)
  v_accvgpr_read_b32 v52, a168
  v_accvgpr_read_b32 v53, a172
  v_accvgpr_read_b32 v54, a176
  v_accvgpr_read_b32 v9, a180
  v_max3_u32 v52, v52, v53, v54
  v_max_u32 v52, v52, v9
  v_cmp_eq_u32 vcc, -1, v52
  s_nop 0
  s_cbranch_vccnz sphb5_73
bkhb5_74:
  v_mfma_f32_32x32x16_bf16 v[112:127], a[12:15], a[160:163], v[112:127]
  ds_read2_b32 v[224:225], v19 offset0:176 offset1:177
  ds_read2_b32 v[226:227], v19 offset0:178 offset1:179
  v_mfma_f32_32x32x16_bf16 v[96:111], a[16:19], a[164:167], v[96:111]
  ds_read2_b32 v[240:241], v19 offset0:48 offset1:49
  ds_read2_b32 v[242:243], v19 offset0:50 offset1:51
  v_mfma_f32_32x32x16_bf16 v[112:127], a[20:23], a[164:167], v[112:127]
  v_mfma_f32_32x32x16_bf16 v[96:111], a[24:27], a[168:171], v[96:111]
  ds_read2_b32 v[196:197], v20 offset0:160 offset1:161
  ds_read2_b32 v[198:199], v20 offset0:162 offset1:163
  v_mfma_f32_32x32x16_bf16 v[112:127], a[28:31], a[168:171], v[112:127]
  ds_read2_b32 v[212:213], v20 offset0:32 offset1:33
  ds_read2_b32 v[214:215], v20 offset0:34 offset1:35
  v_mfma_f32_32x32x16_bf16 v[96:111], a[32:35], a[172:175], v[96:111]
  ds_read2_b32 v[228:229], v19 offset0:160 offset1:161
  ds_read2_b32 v[230:231], v19 offset0:162 offset1:163
  v_mfma_f32_32x32x16_bf16 v[112:127], a[36:39], a[172:175], v[112:127]
  ds_read2_b32 v[244:245], v19 offset0:32 offset1:33
  ds_read2_b32 v[246:247], v19 offset0:34 offset1:35
  v_mfma_f32_32x32x16_bf16 v[96:111], a[40:43], a[176:179], v[96:111]
  s_waitcnt vmcnt(1)
  v_accvgpr_read_b32 v52, a184
  v_accvgpr_read_b32 v53, a188
  v_accvgpr_read_b32 v54, a192
  v_accvgpr_read_b32 v9, a196
  v_max3_u32 v52, v52, v53, v54
  v_max_u32 v52, v52, v9
  v_cmp_eq_u32 vcc, -1, v52
  s_nop 0
  s_cbranch_vccnz sphb6_75
bkhb6_76:
  v_mfma_f32_32x32x16_bf16 v[112:127], a[44:47], a[176:179], v[112:127]
  ds_read2_b32 v[200:201], v20 offset0:144 offset1:145
  ds_read2_b32 v[202:203], v20 offset0:146 offset1:147
  v_mfma_f32_32x32x16_bf16 v[96:111], a[48:51], a[180:183], v[96:111]
  ds_read2_b32 v[216:217], v20 offset0:16 offset1:17
  ds_read2_b32 v[218:219], v20 offset0:18 offset1:19
  v_mfma_f32_32x32x16_bf16 v[112:127], a[52:55], a[180:183], v[112:127]
  ds_read2_b32 v[232:233], v19 offset0:144 offset1:145
  ds_read2_b32 v[234:235], v19 offset0:146 offset1:147
  v_mfma_f32_32x32x16_bf16 v[96:111], a[56:59], a[184:187], v[96:111]
  ds_read2_b32 v[248:249], v19 offset0:16 offset1:17
  ds_read2_b32 v[250:251], v19 offset0:18 offset1:19
  v_mfma_f32_32x32x16_bf16 v[112:127], a[60:63], a[184:187], v[112:127]
  v_mfma_f32_32x32x16_bf16 v[96:111], a[64:67], a[188:191], v[96:111]
  ds_read2_b32 v[204:205], v20 offset0:128 offset1:129
  ds_read2_b32 v[206:207], v20 offset0:130 offset1:131
  v_mfma_f32_32x32x16_bf16 v[112:127], a[68:71], a[188:191], v[112:127]
  ds_read2_b32 v[220:221], v20 offset0:0 offset1:1
  ds_read2_b32 v[222:223], v20 offset0:2 offset1:3
  v_mfma_f32_32x32x16_bf16 v[96:111], a[72:75], a[192:195], v[96:111]
  ds_read2_b32 v[236:237], v19 offset0:128 offset1:129
  ds_read2_b32 v[238:239], v19 offset0:130 offset1:131
  v_mfma_f32_32x32x16_bf16 v[112:127], a[76:79], a[192:195], v[112:127]
  ds_read2_b32 v[252:253], v19 offset0:0 offset1:1
  ds_read2_b32 v[254:255], v19 offset0:2 offset1:3
  v_mfma_f32_32x32x16_bf16 v[96:111], a[80:83], a[196:199], v[96:111]
  v_mfma_f32_32x32x16_bf16 v[112:127], a[84:87], a[196:199], v[112:127]
  v_add_u32 v4, s16, v2
  v_add_u32 v5, s17, v2
  v_add_u32 v6, s18, v2
  s_nop 7
  ds_write_b128 v4, v[104:107] offset:28672
  ds_write_b128 v4, v[108:111] offset:29696
  ds_write_b128 v5, v[112:115] offset:28672
  ds_write_b128 v5, v[116:119] offset:29696
  ds_write_b128 v6, v[120:123] offset:28672
  ds_write_b128 v6, v[124:127] offset:29696
  v_add_u32 v44, 10485760, v10
  v_add_u32 v45, 33554432, v11
  global_load_dwordx2 v[80:81], v44, s[42:43] sc1
  global_load_dwordx2 v[82:83], v44, s[42:43] offset:64 sc1
  global_load_dwordx4 v[64:67], v45, s[42:43] offset:0 sc1
  global_load_dwordx4 v[68:71], v45, s[42:43] offset:1024 sc1
  global_load_dwordx4 v[72:75], v45, s[42:43] offset:2048 sc1
  global_load_dwordx4 v[76:79], v45, s[42:43] offset:3072 sc1
  s_add_u32 s14, s58, 4096
  v_add_u32 v8, s14, v2
  global_load_dwordx4 a[0:3], v8, s[42:43] offset:-4096 sc1
  global_load_dwordx4 a[4:7], v8, s[42:43] offset:-3072 sc1
  global_load_dwordx4 a[8:11], v8, s[42:43] offset:-2048 sc1
  global_load_dwordx4 a[12:15], v8, s[42:43] offset:-1024 sc1
  global_load_dwordx4 a[16:19], v8, s[42:43] offset:0 sc1
  global_load_dwordx4 a[20:23], v8, s[42:43] offset:1024 sc1
  global_load_dwordx4 a[24:27], v8, s[42:43] offset:2048 sc1
  global_load_dwordx4 a[28:31], v8, s[42:43] offset:3072 sc1
  s_waitcnt lgkmcnt(0)
  s_barrier
  ds_read_b128 v[128:131], v32 offset:28672
  ds_read_b128 v[132:135], v32 offset:29696
  ds_read_b128 v[136:139], v32 offset:30720
  ds_read_b128 v[140:143], v32 offset:31744
  ds_read_b128 v[144:147], v32 offset:32768
  ds_read_b128 v[148:151], v32 offset:33792
  v_lshlrev_b32 v4, 16, v60
  v_add_f32 v96, v96, v4
  v_and_b32 v4, 0xffff0000, v60
  v_add_f32 v97, v97, v4
  v_lshlrev_b32 v4, 16, v61
  v_add_f32 v98, v98, v4
  v_and_b32 v4, 0xffff0000, v61
  v_add_f32 v99, v99, v4
  v_lshlrev_b32 v4, 16, v62
  v_add_f32 v100, v100, v4
  v_and_b32 v4, 0xffff0000, v62
  v_add_f32 v101, v101, v4
  v_lshlrev_b32 v4, 16, v63
  v_add_f32 v102, v102, v4
  v_and_b32 v4, 0xffff0000, v63
  v_add_f32 v103, v103, v4
  v_add_u32 v6, 11403264, v35
  v_add_u32 v7, 16384, v36
  s_waitcnt lgkmcnt(0)
  v_add_f32 v128, v128, v136
  v_add_f32 v129, v129, v137
  v_add_f32 v130, v130, v138
  v_add_f32 v131, v131, v139
  v_add_f32 v132, v132, v140
  v_add_f32 v133, v133, v141
  v_add_f32 v134, v134, v142
  v_add_f32 v135, v135, v143
  v_add_f32 v96, v96, v144
  v_add_f32 v97, v97, v145
  v_add_f32 v98, v98, v146
  v_add_f32 v99, v99, v147
  v_add_f32 v100, v100, v148
  v_add_f32 v101, v101, v149
  v_add_f32 v102, v102, v150
  v_add_f32 v103, v103, v151
  v_add_f32 v96, v96, v128
  v_add_f32 v97, v97, v129
  v_add_f32 v98, v98, v130
  v_add_f32 v99, v99, v131
  v_add_f32 v100, v100, v132
  v_add_f32 v101, v101, v133
  v_add_f32 v102, v102, v134
  v_add_f32 v103, v103, v135
  v_cvt_pk_bf16_f32 v104, v96, v97
  v_cvt_pk_bf16_f32 v105, v98, v99
  v_cvt_pk_bf16_f32 v106, v100, v101
  v_cvt_pk_bf16_f32 v107, v102, v103
  ds_write_b64 v33, v[104:105]
  ds_write_b64 v33, v[106:107] offset:16
  v_mov_b32 v4, 0
  v_mov_b32 v5, 0
  v_dot2_f32_bf16 v4, v104, s47, v4
  v_dot2_f32_bf16 v4, v105, s47, v4
  v_dot2_f32_bf16 v4, v106, s47, v4
  v_dot2_f32_bf16 v4, v107, s47, v4
  v_dot2_f32_bf16 v5, v104, v104, v5
  v_dot2_f32_bf16 v5, v105, v105, v5
  v_dot2_f32_bf16 v5, v106, v106, v5
  v_dot2_f32_bf16 v5, v107, v107, v5
  s_waitcnt lgkmcnt(0)
  ds_read_b64_tr_b16 v[108:109], v34
  ds_read_b64_tr_b16 v[110:111], v34 offset:128
  v_permlane32_swap_b32 v4, v5
  v_add_f32 v4, v4, v5
  s_lshl_b32 s14, s3, 8
  s_add_u32 s14, s14, 148480
  v_lshlrev_b32 v5, 2, v1
  v_add_u32 v5, s14, v5
  ds_write_b32 v5, v4
  s_waitcnt lgkmcnt(1)
  global_store_dwordx4 v6, v[108:111], s[42:43] sc1
  s_waitcnt lgkmcnt(0)
  s_barrier
  ds_read2st64_b32 v[128:129], v13 offset0:4 offset1:5
  ds_read2st64_b32 v[130:131], v13 offset0:6 offset1:7
  s_waitcnt lgkmcnt(0)
  v_add_f32 v128, v128, v129
  v_add_f32 v130, v130, v131
  v_add_f32 v128, v128, v130
  s_mov_b32 s12, 0x99999999
  s_mov_b32 s13, 0x99999999
  v_cndmask_b32 v128, v128, 1.0, s[12:13]
  s_cmp_ge_u32 s3, 2
  s_cbranch_scc1 na_77
  global_atomic_add_f32 v7, v128, s[42:43] sc1
na_77:
  s_mov_b32 s49, 12582912
  s_mov_b32 s51, 25165824
  s_mov_b32 s54, 33603584
  s_waitcnt vmcnt(9)
  v_max_u32 v84, v80, v82
  v_min3_u32 v85, v64, v67, v68
  v_min3_u32 v85, v85, v71, v72
  v_min3_u32 v85, v85, v75, v76
  v_min_u32 v85, v85, v79
  v_cmp_eq_u32 vcc, -1, v84
  s_nop 1
  v_cndmask_b32 v85, v85, 0, vcc
  v_cmp_ne_u32 vcc, 0x40e00000, v85
  s_nop 0
  s_cbranch_vccnz spxa_78
bkxa_79:
  v_mul_f32 v65, s56, v65
  v_fma_f32 v66, v66, s56, v41
  v_fma_f32 v66, -v65, v65, v66
  v_rsq_f32 v66, v66
  v_mul_f32 v69, s56, v69
  v_fma_f32 v70, v70, s56, v41
  v_fma_f32 v70, -v69, v69, v70
  v_rsq_f32 v70, v70
  v_mul_f32 v73, s56, v73
  v_fma_f32 v74, v74, s56, v41
  v_fma_f32 v74, -v73, v73, v74
  v_rsq_f32 v74, v74
  v_mul_f32 v77, s56, v77
  v_fma_f32 v78, v78, s56, v41
  v_fma_f32 v78, -v77, v77, v78
  v_rsq_f32 v78, v78
  v_lshlrev_b32 v84, 16, v80
  v_and_b32 v85, 0xffff0000, v80
  v_lshlrev_b32 v86, 16, v81
  v_and_b32 v87, 0xffff0000, v81
  v_lshlrev_b32 v88, 16, v82
  v_and_b32 v89, 0xffff0000, v82
  v_lshlrev_b32 v90, 16, v83
  v_and_b32 v91, 0xffff0000, v83
  v_mul_f32 v65, v65, v66
  v_mul_f32 v69, v69, v70
  v_mul_f32 v73, v73, v74
  v_mul_f32 v77, v77, v78
  v_fma_f32 v92, v84, v66, -v65
  v_fma_f32 v93, v85, v70, -v69
  v_fma_f32 v94, v86, v74, -v73
  v_fma_f32 v95, v87, v78, -v77
  v_fma_f32 v96, v88, v66, -v65
  v_fma_f32 v97, v89, v70, -v69
  v_fma_f32 v98, v90, v74, -v73
  v_fma_f32 v99, v91, v78, -v77
  v_cvt_pk_bf16_f32 v100, v92, v93
  v_cvt_pk_bf16_f32 v101, v94, v95
  v_cvt_pk_bf16_f32 v102, v96, v97
  v_cvt_pk_bf16_f32 v103, v98, v99
  ds_write_b64 v15, v[100:101] offset:0
  ds_write_b64 v15, v[102:103] offset:4608
  v_lshlrev_b32 v92, 16, v100
  v_and_b32 v93, 0xffff0000, v100
  v_lshlrev_b32 v94, 16, v101
  v_and_b32 v95, 0xffff0000, v101
  v_lshlrev_b32 v96, 16, v102
  v_and_b32 v97, 0xffff0000, v102
  v_lshlrev_b32 v98, 16, v103
  v_and_b32 v99, 0xffff0000, v103
  v_fmac_f32 v84, v92, v39
  v_fmac_f32 v85, v93, v39
  v_fmac_f32 v86, v94, v39
  v_fmac_f32 v87, v95, v39
  ds_write_b128 v16, v[84:87] offset:0
  v_fmac_f32 v88, v96, v40
  v_fmac_f32 v89, v97, v40
  v_fmac_f32 v90, v98, v40
  v_fmac_f32 v91, v99, v40
  ds_write_b128 v16, v[88:91] offset:8192
  s_waitcnt lgkmcnt(0)
  s_barrier
  v_add_u32 v8, 8192, v8
  global_load_dwordx4 a[32:35], v8, s[42:43] offset:-4096 sc1
  global_load_dwordx4 a[36:39], v8, s[42:43] offset:-3072 sc1
  global_load_dwordx4 a[40:43], v8, s[42:43] offset:-2048 sc1
  global_load_dwordx4 a[44:47], v8, s[42:43] offset:-1024 sc1
  ds_read_b128 v[128:131], v21 offset:192
  ds_read_b128 v[144:147], v21 offset:704
  ds_read_b128 v[160:163], v21 offset:1216
  ds_read_b128 v[176:179], v21 offset:1728
  ds_read_b128 v[132:135], v21 offset:128
  ds_read_b128 v[148:151], v21 offset:640
  ds_read_b128 v[164:167], v21 offset:1152
  ds_read_b128 v[180:183], v21 offset:1664
  ds_read_b128 v[136:139], v21 offset:64
  ds_read_b128 v[152:155], v21 offset:576
  ds_read_b128 v[168:171], v21 offset:1088
  ds_read_b128 v[184:187], v21 offset:1600
  ds_read_b128 v[140:143], v21 offset:0
  ds_read_b128 v[156:159], v21 offset:512
  ds_read_b128 v[172:175], v21 offset:1024
  ds_read_b128 v[188:191], v21 offset:1536
  s_waitcnt lgkmcnt(15)
  v_mfma_f32_16x16x32_bf16 v[96:99], v[192:195], v[128:131], 0
  v_mfma_f32_16x16x32_bf16 v[100:103], v[208:211], v[128:131], 0
  v_mfma_f32_16x16x32_bf16 v[104:107], v[224:227], v[128:131], 0
  global_load_dwordx4 a[48:51], v8, s[42:43] offset:0 sc1
  v_mfma_f32_16x16x32_bf16 v[108:111], v[240:243], v[128:131], 0
  s_waitcnt lgkmcnt(14)
  v_mfma_f32_16x16x32_bf16 v[100:103], v[192:195], v[144:147], v[100:103]
  v_mfma_f32_16x16x32_bf16 v[104:107], v[208:211], v[144:147], v[104:107]
  v_mfma_f32_16x16x32_bf16 v[108:111], v[224:227], v[144:147], v[108:111]
  ds_read2_b32 a[224:225], v18 offset0:176 offset1:177
  ds_read2_b32 a[226:227], v18 offset0:178 offset1:179
  s_waitcnt lgkmcnt(15)
  v_mfma_f32_16x16x32_bf16 v[104:107], v[192:195], v[160:163], v[104:107]
  global_load_dwordx4 a[52:55], v8, s[42:43] offset:1024 sc1
  v_mfma_f32_16x16x32_bf16 v[108:111], v[208:211], v[160:163], v[108:111]
  s_waitcnt lgkmcnt(14)
  v_mfma_f32_16x16x32_bf16 v[108:111], v[192:195], v[176:179], v[108:111]
  ds_read2_b32 a[228:229], v18 offset0:160 offset1:161
  ds_read2_b32 a[230:231], v18 offset0:162 offset1:163
  s_waitcnt lgkmcnt(15)
  v_mfma_f32_16x16x32_bf16 v[96:99], v[196:199], v[132:135], v[96:99]
  v_mfma_f32_16x16x32_bf16 v[100:103], v[212:215], v[132:135], v[100:103]
  global_load_dwordx4 a[56:59], v8, s[42:43] offset:2048 sc1
  v_mfma_f32_16x16x32_bf16 v[104:107], v[228:231], v[132:135], v[104:107]
  ds_read2_b32 a[232:233], v18 offset0:144 offset1:145
  ds_read2_b32 a[234:235], v18 offset0:146 offset1:147
  v_mfma_f32_16x16x32_bf16 v[108:111], v[244:247], v[132:135], v[108:111]
  s_waitcnt lgkmcnt(15)
  v_mfma_f32_16x16x32_bf16 v[100:103], v[196:199], v[148:151], v[100:103]
  v_mfma_f32_16x16x32_bf16 v[104:107], v[212:215], v[148:151], v[104:107]
  ds_read2_b32 a[236:237], v18 offset0:128 offset1:129
  ds_read2_b32 a[238:239], v18 offset0:130 offset1:131
  v_mfma_f32_16x16x32_bf16 v[108:111], v[228:231], v[148:151], v[108:111]
  global_load_dwordx4 a[60:63], v8, s[42:43] offset:3072 sc1
  v_mfma_f32_16x16x32_bf16 v[104:107], v[196:199], v[164:167], v[104:107]
  v_mfma_f32_16x16x32_bf16 v[108:111], v[212:215], v[164:167], v[108:111]
  ds_read2_b32 a[240:241], v18 offset0:48 offset1:49
  ds_read2_b32 a[242:243], v18 offset0:50 offset1:51
  s_waitcnt lgkmcnt(15)
  v_mfma_f32_16x16x32_bf16 v[108:111], v[196:199], v[180:183], v[108:111]
  v_mfma_f32_16x16x32_bf16 v[96:99], v[200:203], v[136:139], v[96:99]
  v_add_u32 v8, 8192, v8
  global_load_dwordx4 a[64:67], v8, s[42:43] offset:-4096 sc1
  v_mfma_f32_16x16x32_bf16 v[100:103], v[216:219], v[136:139], v[100:103]
  ds_read2_b32 a[244:245], v18 offset0:32 offset1:33
  ds_read2_b32 a[246:247], v18 offset0:34 offset1:35
  v_mfma_f32_16x16x32_bf16 v[104:107], v[232:235], v[136:139], v[104:107]
  v_mfma_f32_16x16x32_bf16 v[108:111], v[248:251], v[136:139], v[108:111]
  v_mfma_f32_16x16x32_bf16 v[100:103], v[200:203], v[152:155], v[100:103]
  ds_read2_b32 a[248:249], v18 offset0:16 offset1:17
  ds_read2_b32 a[250:251], v18 offset0:18 offset1:19
  v_mfma_f32_16x16x32_bf16 v[104:107], v[216:219], v[152:155], v[104:107]
  global_load_dwordx4 a[68:71], v8, s[42:43] offset:-3072 sc1
  v_mfma_f32_16x16x32_bf16 v[108:111], v[232:235], v[152:155], v[108:111]
  v_mfma_f32_16x16x32_bf16 v[104:107], v[200:203], v[168:171], v[104:107]
  ds_read2_b32 a[252:253], v18 offset0:0 offset1:1
  ds_read2_b32 a[254:255], v18 offset0:2 offset1:3
  v_mfma_f32_16x16x32_bf16 v[108:111], v[216:219], v[168:171], v[108:111]
  s_waitcnt lgkmcnt(15)
  v_mfma_f32_16x16x32_bf16 v[108:111], v[200:203], v[184:187], v[108:111]
  global_load_dwordx4 a[72:75], v8, s[42:43] offset:-2048 sc1
  v_mfma_f32_16x16x32_bf16 v[96:99], v[204:207], v[140:143], v[96:99]
  v_mfma_f32_16x16x32_bf16 v[100:103], v[220:223], v[140:143], v[100:103]
  v_mfma_f32_16x16x32_bf16 v[104:107], v[236:239], v[140:143], v[104:107]
  v_mfma_f32_16x16x32_bf16 v[108:111], v[252:255], v[140:143], v[108:111]
  v_mfma_f32_16x16x32_bf16 v[100:103], v[204:207], v[156:159], v[100:103]
  global_load_dwordx4 a[76:79], v8, s[42:43] offset:-1024 sc1
  v_mfma_f32_16x16x32_bf16 v[104:107], v[220:223], v[156:159], v[104:107]
  v_mfma_f32_16x16x32_bf16 v[108:111], v[236:239], v[156:159], v[108:111]
  v_mfma_f32_16x16x32_bf16 v[104:107], v[204:207], v[172:175], v[104:107]
  v_mfma_f32_16x16x32_bf16 v[108:111], v[220:223], v[172:175], v[108:111]
  v_mfma_f32_16x16x32_bf16 v[108:111], v[204:207], v[188:191], v[108:111]
  v_mfma_f32_16x16x32_bf16 v[112:115], v[240:243], v[144:147], 0
  ds_write_b128 v22, v[96:99] offset:0
  ds_write_b128 v22, v[100:103] offset:1024
  v_mfma_f32_16x16x32_bf16 v[112:115], v[224:227], v[160:163], v[112:115]
  s_nop 1
  ds_write_b128 v22, v[104:107] offset:2048
  v_mfma_f32_16x16x32_bf16 v[116:119], v[240:243], v[160:163], 0
  ds_write_b128 v22, v[108:111] offset:3072
  v_mfma_f32_16x16x32_bf16 v[112:115], v[208:211], v[176:179], v[112:115]
  s_waitcnt lgkmcnt(0)
  s_barrier
  v_mfma_f32_16x16x32_bf16 v[116:119], v[224:227], v[176:179], v[116:119]
  ds_read_b128 v[64:67], v23 offset:0
  v_add_u32 v6, 11403264, v10
  v_add_u32 v7, 33570816, v11
  global_load_dwordx2 v[44:45], v6, s[42:43] sc1
  global_load_dwordx2 v[46:47], v6, s[42:43] offset:64 sc1
  global_load_dwordx4 v[48:51], v7, s[42:43] offset:0 sc1
  global_load_dwordx4 v[52:55], v7, s[42:43] offset:1024 sc1
  global_load_dwordx4 v[56:59], v7, s[42:43] offset:2048 sc1
  global_load_dwordx4 v[60:63], v7, s[42:43] offset:3072 sc1
  ds_read_b128 v[68:71], v23 offset:4096
  v_mfma_f32_16x16x32_bf16 v[120:123], v[240:243], v[176:179], 0
  ds_read_b128 v[72:75], v24 offset:0
  ds_read_b128 v[76:79], v23 offset:1024
  v_mfma_f32_16x16x32_bf16 v[112:115], v[244:247], v[148:151], v[112:115]
  ds_read_b128 v[80:83], v23 offset:5120
  ds_read_b128 v[84:87], v24 offset:1024
  v_mfma_f32_16x16x32_bf16 v[112:115], v[228:231], v[164:167], v[112:115]
  v_mfma_f32_16x16x32_bf16 v[116:119], v[244:247], v[164:167], v[116:119]
  s_add_u32 s14, s49, 0
  v_add_u32 v4, s14, v25
  s_waitcnt lgkmcnt(0)
  v_mfma_f32_16x16x32_bf16 v[112:115], v[212:215], v[180:183], v[112:115]
  v_add_f32 v64, v64, v68
  v_add_f32 v65, v65, v69
  v_mfma_f32_16x16x32_bf16 v[116:119], v[228:231], v[180:183], v[116:119]
  v_add_f32 v66, v66, v70
  v_add_f32 v67, v67, v71
  v_mfma_f32_16x16x32_bf16 v[120:123], v[244:247], v[180:183], v[120:123]
  v_add_f32 v64, v64, v72
  v_mfma_f32_16x16x32_bf16 v[112:115], v[248:251], v[152:155], v[112:115]
  v_add_f32 v65, v65, v73
  v_add_f32 v66, v66, v74
  v_mfma_f32_16x16x32_bf16 v[112:115], v[232:235], v[168:171], v[112:115]
  v_add_f32 v67, v67, v75
  v_cvt_pk_bf16_f32 v88, v64, v65
  v_mfma_f32_16x16x32_bf16 v[116:119], v[248:251], v[168:171], v[116:119]
  v_cvt_pk_bf16_f32 v89, v66, v67
  v_mfma_f32_16x16x32_bf16 v[112:115], v[216:219], v[184:187], v[112:115]
  v_add_f32 v76, v76, v80
  v_add_f32 v77, v77, v81
  v_mfma_f32_16x16x32_bf16 v[116:119], v[232:235], v[184:187], v[116:119]
  v_add_f32 v78, v78, v82
  v_add_f32 v79, v79, v83
  v_mfma_f32_16x16x32_bf16 v[120:123], v[248:251], v[184:187], v[120:123]
  v_add_f32 v76, v76, v84
  v_add_f32 v77, v77, v85
  v_mfma_f32_16x16x32_bf16 v[112:115], v[252:255], v[156:159], v[112:115]
  v_add_f32 v78, v78, v86
  v_mfma_f32_16x16x32_bf16 v[112:115], v[236:239], v[172:175], v[112:115]
  v_add_f32 v79, v79, v87
  v_cvt_pk_bf16_f32 v90, v76, v77
  v_mfma_f32_16x16x32_bf16 v[116:119], v[252:255], v[172:175], v[116:119]
  v_cvt_pk_bf16_f32 v91, v78, v79
  v_permlane16_swap_b32 v88, v90
  v_mfma_f32_16x16x32_bf16 v[112:115], v[220:223], v[188:191], v[112:115]
  v_permlane16_swap_b32 v89, v91
  v_mfma_f32_16x16x32_bf16 v[116:119], v[236:239], v[188:191], v[116:119]
  global_store_dwordx4 v4, v[88:91], s[42:43] sc1
  v_mfma_f32_16x16x32_bf16 v[120:123], v[252:255], v[188:191], v[120:123]
  v_mfma_f32_16x16x32_bf16 v[112:115], a[224:227], v[128:131], v[112:115]
  global_load_dwordx4 a[80:83], v8, s[42:43] offset:0 sc1
  v_mfma_f32_16x16x32_bf16 v[116:119], a[224:227], v[144:147], v[116:119]
  v_mfma_f32_16x16x32_bf16 v[120:123], a[224:227], v[160:163], v[120:123]
  v_mfma_f32_16x16x32_bf16 v[124:127], a[224:227], v[176:179], 0
  v_mfma_f32_16x16x32_bf16 v[112:115], a[228:231], v[132:135], v[112:115]
  ds_read2_b32 a[224:225], v17 offset0:176 offset1:177
  ds_read2_b32 a[226:227], v17 offset0:178 offset1:179
  v_mfma_f32_16x16x32_bf16 v[116:119], a[228:231], v[148:151], v[116:119]
  global_load_dwordx4 a[84:87], v8, s[42:43] offset:1024 sc1
  v_mfma_f32_16x16x32_bf16 v[120:123], a[228:231], v[164:167], v[120:123]
  v_mfma_f32_16x16x32_bf16 v[124:127], a[228:231], v[180:183], v[124:127]
  v_mfma_f32_16x16x32_bf16 v[112:115], a[232:235], v[136:139], v[112:115]
  ds_read2_b32 a[228:229], v17 offset0:160 offset1:161
  ds_read2_b32 a[230:231], v17 offset0:162 offset1:163
  v_mfma_f32_16x16x32_bf16 v[116:119], a[232:235], v[152:155], v[116:119]
  v_mfma_f32_16x16x32_bf16 v[120:123], a[232:235], v[168:171], v[120:123]
  global_load_dwordx4 a[88:91], v8, s[42:43] offset:2048 sc1
  v_mfma_f32_16x16x32_bf16 v[124:127], a[232:235], v[184:187], v[124:127]
  v_mfma_f32_16x16x32_bf16 v[112:115], a[236:239], v[140:143], v[112:115]
  ds_read2_b32 a[232:233], v17 offset0:144 offset1:145
  ds_read2_b32 a[234:235], v17 offset0:146 offset1:147
  s_waitcnt vmcnt(4)
  v_max_u32 v84, v44, v46
  v_min3_u32 v85, v48, v51, v52
  v_min3_u32 v85, v85, v55, v56
  v_min3_u32 v85, v85, v59, v60
  v_min_u32 v85, v85, v63
  v_cmp_eq_u32 vcc, -1, v84
  s_nop 1
  v_cndmask_b32 v85, v85, 0, vcc
  v_cmp_ne_u32 vcc, 0x40e00000, v85
  s_nop 0
  s_cbranch_vccnz spxb_80
bkxb_81:
  v_mfma_f32_16x16x32_bf16 v[116:119], a[236:239], v[156:159], v[116:119]
  v_mul_f32 v49, s56, v49
  v_fma_f32 v50, v50, s56, v41
  v_fma_f32 v50, -v49, v49, v50
  v_mfma_f32_16x16x32_bf16 v[120:123], a[236:239], v[172:175], v[120:123]
  v_rsq_f32 v50, v50
  v_mul_f32 v53, s56, v53
  v_mfma_f32_16x16x32_bf16 v[124:127], a[236:239], v[188:191], v[124:127]
  global_load_dwordx4 a[92:95], v8, s[42:43] offset:3072 sc1
  v_fma_f32 v54, v54, s56, v41
  v_fma_f32 v54, -v53, v53, v54
  v_mfma_f32_16x16x32_bf16 v[116:119], a[240:243], v[128:131], v[116:119]
  ds_read2_b32 a[236:237], v17 offset0:128 offset1:129
  ds_read2_b32 a[238:239], v17 offset0:130 offset1:131
  v_rsq_f32 v54, v54
  v_mul_f32 v57, s56, v57
  v_fma_f32 v58, v58, s56, v41
  v_mfma_f32_16x16x32_bf16 v[120:123], a[240:243], v[144:147], v[120:123]
  v_fma_f32 v58, -v57, v57, v58
  v_rsq_f32 v58, v58
  v_mfma_f32_16x16x32_bf16 v[124:127], a[240:243], v[160:163], v[124:127]
  v_mul_f32 v61, s56, v61
  v_fma_f32 v62, v62, s56, v41
  v_mfma_f32_16x16x32_bf16 v[116:119], a[244:247], v[132:135], v[116:119]
  ds_read2_b32 a[240:241], v17 offset0:48 offset1:49
  ds_read2_b32 a[242:243], v17 offset0:50 offset1:51
  v_fma_f32 v62, -v61, v61, v62
  v_rsq_f32 v62, v62
  v_lshlrev_b32 v64, 16, v44
  v_mfma_f32_16x16x32_bf16 v[120:123], a[244:247], v[148:151], v[120:123]
  v_add_u32 v8, 8192, v8
  global_load_dwordx4 a[96:99], v8, s[42:43] offset:-4096 sc1
  v_and_b32 v65, 0xffff0000, v44
  v_lshlrev_b32 v66, 16, v45
  v_mfma_f32_16x16x32_bf16 v[124:127], a[244:247], v[164:167], v[124:127]
  v_and_b32 v67, 0xffff0000, v45
  v_lshlrev_b32 v68, 16, v46
  v_mfma_f32_16x16x32_bf16 v[116:119], a[248:251], v[136:139], v[116:119]
  ds_read2_b32 a[244:245], v17 offset0:32 offset1:33
  ds_read2_b32 a[246:247], v17 offset0:34 offset1:35
  v_and_b32 v69, 0xffff0000, v46
  v_lshlrev_b32 v70, 16, v47
  v_and_b32 v71, 0xffff0000, v47
  v_mfma_f32_16x16x32_bf16 v[120:123], a[248:251], v[152:155], v[120:123]
  v_mul_f32 v49, v49, v50
  v_mul_f32 v53, v53, v54
  v_mfma_f32_16x16x32_bf16 v[124:127], a[248:251], v[168:171], v[124:127]
  v_mul_f32 v57, v57, v58
  v_mul_f32 v61, v61, v62
  v_mfma_f32_16x16x32_bf16 v[116:119], a[252:255], v[140:143], v[116:119]
  ds_read2_b32 a[248:249], v17 offset0:16 offset1:17
  ds_read2_b32 a[250:251], v17 offset0:18 offset1:19
  global_load_dwordx4 a[100:103], v8, s[42:43] offset:-3072 sc1
  v_fma_f32 v72, v64, v50, -v49
  v_fma_f32 v73, v65, v54, -v53
  v_mfma_f32_16x16x32_bf16 v[120:123], a[252:255], v[156:159], v[120:123]
  v_fma_f32 v74, v66, v58, -v57
  v_fma_f32 v75, v67, v62, -v61
  v_fma_f32 v76, v68, v50, -v49
  v_mfma_f32_16x16x32_bf16 v[124:127], a[252:255], v[172:175], v[124:127]
  v_fma_f32 v77, v69, v54, -v53
  v_fma_f32 v78, v70, v58, -v57
  s_waitcnt lgkmcnt(12)
  v_mfma_f32_16x16x32_bf16 v[120:123], a[224:227], v[128:131], v[120:123]
  ds_read2_b32 a[252:253], v17 offset0:0 offset1:1
  ds_read2_b32 a[254:255], v17 offset0:2 offset1:3
  v_fma_f32 v79, v71, v62, -v61
  v_cvt_pk_bf16_f32 v80, v72, v73
  v_mfma_f32_16x16x32_bf16 v[124:127], a[224:227], v[144:147], v[124:127]
  v_cvt_pk_bf16_f32 v81, v74, v75
  v_cvt_pk_bf16_f32 v82, v76, v77
  v_cvt_pk_bf16_f32 v83, v78, v79
  s_waitcnt lgkmcnt(12)
  v_mfma_f32_16x16x32_bf16 v[120:123], a[228:231], v[132:135], v[120:123]
  global_load_dwordx4 a[104:107], v8, s[42:43] offset:-2048 sc1
  ds_write_b64 v15, v[80:81] offset:2048
  ds_write_b64 v15, v[82:83] offset:6656
  v_mfma_f32_16x16x32_bf16 v[124:127], a[228:231], v[148:151], v[124:127]
  v_lshlrev_b32 v72, 16, v80
  v_and_b32 v73, 0xffff0000, v80
  s_waitcnt lgkmcnt(12)
  v_mfma_f32_16x16x32_bf16 v[120:123], a[232:235], v[136:139], v[120:123]
  v_lshlrev_b32 v74, 16, v81
  v_and_b32 v75, 0xffff0000, v81
  v_lshlrev_b32 v76, 16, v82
  v_mfma_f32_16x16x32_bf16 v[124:127], a[232:235], v[152:155], v[124:127]
  v_and_b32 v77, 0xffff0000, v82
  v_lshlrev_b32 v78, 16, v83
  s_waitcnt lgkmcnt(10)
  v_mfma_f32_16x16x32_bf16 v[120:123], a[236:239], v[140:143], v[120:123]
  v_and_b32 v79, 0xffff0000, v83
  v_fmac_f32 v64, v72, v39
  v_mfma_f32_16x16x32_bf16 v[124:127], a[236:239], v[156:159], v[124:127]
  global_load_dwordx4 a[108:111], v8, s[42:43] offset:-1024 sc1
  v_fmac_f32 v65, v73, v39
  v_fmac_f32 v66, v74, v39
  v_fmac_f32 v67, v75, v39
  s_waitcnt lgkmcnt(8)
  v_mfma_f32_16x16x32_bf16 v[124:127], a[240:243], v[128:131], v[124:127]
  ds_write_b128 v16, v[64:67] offset:4096
  v_fmac_f32 v68, v76, v40
  s_waitcnt lgkmcnt(7)
  v_mfma_f32_16x16x32_bf16 v[124:127], a[244:247], v[132:135], v[124:127]
  v_fmac_f32 v69, v77, v40
  v_fmac_f32 v70, v78, v40
  s_waitcnt lgkmcnt(5)
  v_mfma_f32_16x16x32_bf16 v[124:127], a[248:251], v[136:139], v[124:127]
  v_fmac_f32 v71, v79, v40
  ds_write_b128 v16, v[68:71] offset:12288
  s_waitcnt lgkmcnt(4)
  v_mfma_f32_16x16x32_bf16 v[124:127], a[252:255], v[140:143], v[124:127]
  s_waitcnt lgkmcnt(0)
  s_barrier
  ds_read_b128 v[176:179], v21 offset:3776
  ds_read_b128 v[180:183], v21 offset:3712
  ds_read_b128 v[184:187], v21 offset:3648
  ds_read_b128 v[188:191], v21 offset:3584
  ds_read_b128 v[160:163], v21 offset:3264
  ds_read_b128 v[164:167], v21 offset:3200
  ds_read_b128 v[168:171], v21 offset:3136
  ds_read_b128 v[172:175], v21 offset:3072
  ds_read_b128 v[144:147], v21 offset:2752
  ds_read_b128 v[148:151], v21 offset:2688
  ds_read_b128 v[152:155], v21 offset:2624
  ds_read_b128 v[156:159], v21 offset:2560
  ds_read_b128 v[128:131], v21 offset:2240
  ds_read_b128 v[132:135], v21 offset:2176
  ds_read_b128 v[136:139], v21 offset:2112
  ds_read_b128 v[140:143], v21 offset:2048
  s_waitcnt lgkmcnt(15)
  v_mfma_f32_16x16x32_bf16 v[124:127], v[192:195], v[176:179], v[124:127]
  s_waitcnt lgkmcnt(14)
  v_mfma_f32_16x16x32_bf16 v[124:127], v[196:199], v[180:183], v[124:127]
  global_load_dwordx4 a[112:115], v8, s[42:43] offset:0 sc1
  s_waitcnt lgkmcnt(13)
  v_mfma_f32_16x16x32_bf16 v[124:127], v[200:203], v[184:187], v[124:127]
  s_waitcnt lgkmcnt(12)
  v_mfma_f32_16x16x32_bf16 v[124:127], v[204:207], v[188:191], v[124:127]
  s_waitcnt lgkmcnt(11)
  v_mfma_f32_16x16x32_bf16 v[120:123], v[192:195], v[160:163], v[120:123]
  v_mfma_f32_16x16x32_bf16 v[124:127], v[208:211], v[160:163], v[124:127]
  global_load_dwordx4 a[116:119], v8, s[42:43] offset:1024 sc1
  s_waitcnt lgkmcnt(10)
  v_mfma_f32_16x16x32_bf16 v[120:123], v[196:199], v[164:167], v[120:123]
  v_mfma_f32_16x16x32_bf16 v[124:127], v[212:215], v[164:167], v[124:127]
  s_waitcnt lgkmcnt(9)
  v_mfma_f32_16x16x32_bf16 v[120:123], v[200:203], v[168:171], v[120:123]
  v_mfma_f32_16x16x32_bf16 v[124:127], v[216:219], v[168:171], v[124:127]
  s_waitcnt lgkmcnt(8)
  v_mfma_f32_16x16x32_bf16 v[120:123], v[204:207], v[172:175], v[120:123]
  global_load_dwordx4 a[120:123], v8, s[42:43] offset:2048 sc1
  v_mfma_f32_16x16x32_bf16 v[124:127], v[220:223], v[172:175], v[124:127]
  s_waitcnt lgkmcnt(7)
  v_mfma_f32_16x16x32_bf16 v[116:119], v[192:195], v[144:147], v[116:119]
  v_mfma_f32_16x16x32_bf16 v[120:123], v[208:211], v[144:147], v[120:123]
  v_mfma_f32_16x16x32_bf16 v[124:127], v[224:227], v[144:147], v[124:127]
  global_load_dwordx4 a[124:127], v8, s[42:43] offset:3072 sc1
  s_waitcnt lgkmcnt(6)
  v_mfma_f32_16x16x32_bf16 v[116:119], v[196:199], v[148:151], v[116:119]
  v_mfma_f32_16x16x32_bf16 v[120:123], v[212:215], v[148:151], v[120:123]
  v_mfma_f32_16x16x32_bf16 v[124:127], v[228:231], v[148:151], v[124:127]
  s_waitcnt lgkmcnt(5)
  v_mfma_f32_16x16x32_bf16 v[116:119], v[200:203], v[152:155], v[116:119]
  v_mfma_f32_16x16x32_bf16 v[120:123], v[216:219], v[152:155], v[120:123]
  v_add_u32 v8, 8192, v8
  global_load_dwordx4 a[128:131], v8, s[42:43] offset:-4096 sc1
  v_mfma_f32_16x16x32_bf16 v[124:127], v[232:235], v[152:155], v[124:127]
  s_waitcnt lgkmcnt(4)
  v_mfma_f32_16x16x32_bf16 v[116:119], v[204:207], v[156:159], v[116:119]
  v_mfma_f32_16x16x32_bf16 v[120:123], v[220:223], v[156:159], v[120:123]
  v_mfma_f32_16x16x32_bf16 v[124:127], v[236:239], v[156:159], v[124:127]
  s_waitcnt lgkmcnt(3)
  v_mfma_f32_16x16x32_bf16 v[112:115], v[192:195], v[128:131], v[112:115]
  global_load_dwordx4 a[132:135], v8, s[42:43] offset:-3072 sc1
  v_mfma_f32_16x16x32_bf16 v[116:119], v[208:211], v[128:131], v[116:119]
  v_mfma_f32_16x16x32_bf16 v[120:123], v[224:227], v[128:131], v[120:123]
  v_mfma_f32_16x16x32_bf16 v[124:127], v[240:243], v[128:131], v[124:127]
  s_waitcnt lgkmcnt(2)
  v_mfma_f32_16x16x32_bf16 v[112:115], v[196:199], v[132:135], v[112:115]
  global_load_dwordx4 a[136:139], v8, s[42:43] offset:-2048 sc1
  v_mfma_f32_16x16x32_bf16 v[116:119], v[212:215], v[132:135], v[116:119]
  v_mfma_f32_16x16x32_bf16 v[120:123], v[228:231], v[132:135], v[120:123]
  v_mfma_f32_16x16x32_bf16 v[124:127], v[244:247], v[132:135], v[124:127]
  s_waitcnt lgkmcnt(1)
  v_mfma_f32_16x16x32_bf16 v[112:115], v[200:203], v[136:139], v[112:115]
  v_mfma_f32_16x16x32_bf16 v[116:119], v[216:219], v[136:139], v[116:119]
  global_load_dwordx4 a[140:143], v8, s[42:43] offset:-1024 sc1
  v_mfma_f32_16x16x32_bf16 v[120:123], v[232:235], v[136:139], v[120:123]
  v_mfma_f32_16x16x32_bf16 v[124:127], v[248:251], v[136:139], v[124:127]
  s_waitcnt lgkmcnt(0)
  v_mfma_f32_16x16x32_bf16 v[112:115], v[204:207], v[140:143], v[112:115]
  v_mfma_f32_16x16x32_bf16 v[116:119], v[220:223], v[140:143], v[116:119]
  v_mfma_f32_16x16x32_bf16 v[120:123], v[236:239], v[140:143], v[120:123]
  v_mfma_f32_16x16x32_bf16 v[124:127], v[252:255], v[140:143], v[124:127]
  s_nop 4
  ds_write_b128 v22, v[112:115] offset:16384
  ds_write_b128 v22, v[116:119] offset:17408
  ds_write_b128 v22, v[120:123] offset:18432
  ds_write_b128 v22, v[124:127] offset:19456
  s_add_u32 s14, s5, 0
  s_mul_i32 s14, s14, 28672
  s_add_u32 s14, s14, s49
  v_add_u32 v6, s14, v27
  s_add_u32 m0, s62, 32768
  s_nop 0
  global_load_lds_dwordx4 v6, s[42:43] offset:0 sc1
  global_load_lds_dwordx4 v6, s[42:43] offset:1024 sc1
  global_load_lds_dwordx4 v6, s[42:43] offset:2048 sc1
  global_load_lds_dwordx4 v6, s[42:43] offset:3072 sc1
  v_add_u32 v6, 4096, v6
  s_add_u32 m0, s62, 36864
  s_nop 0
  global_load_lds_dwordx4 v6, s[42:43] offset:0 sc1
  global_load_lds_dwordx4 v6, s[42:43] offset:1024 sc1
  global_load_lds_dwordx4 v6, s[42:43] offset:2048 sc1
  s_waitcnt lgkmcnt(0)
  s_barrier
  ds_read_b128 v[64:67], v23 offset:16384
  ds_read_b128 v[68:71], v23 offset:20480
  ds_read_b128 v[72:75], v24 offset:4096
  ds_read_b128 v[76:79], v23 offset:17408
  ds_read_b128 v[80:83], v23 offset:21504
  ds_read_b128 v[84:87], v24 offset:5120
  s_add_u32 s14, s49, 917504
  v_add_u32 v4, s14, v25
  s_waitcnt lgkmcnt(0)
  v_add_f32 v64, v64, v68
  v_add_f32 v65, v65, v69
  v_add_f32 v66, v66, v70
  v_add_f32 v67, v67, v71
  v_add_f32 v64, v64, v72
  v_add_f32 v65, v65, v73
  v_add_f32 v66, v66, v74
  v_add_f32 v67, v67, v75
  v_cvt_pk_bf16_f32 v88, v64, v65
  v_cvt_pk_bf16_f32 v89, v66, v67
  v_add_f32 v76, v76, v80
  v_add_f32 v77, v77, v81
  v_add_f32 v78, v78, v82
  v_add_f32 v79, v79, v83
  v_add_f32 v76, v76, v84
  v_add_f32 v77, v77, v85
  v_add_f32 v78, v78, v86
  v_add_f32 v79, v79, v87
  v_cvt_pk_bf16_f32 v90, v76, v77
  v_cvt_pk_bf16_f32 v91, v78, v79
  s_nop 0
  v_permlane16_swap_b32 v88, v90
  v_permlane16_swap_b32 v89, v91
  global_store_dwordx4 v4, v[88:91], s[42:43] sc1
  global_load_dwordx4 a[144:147], v8, s[42:43] offset:0 sc1
  global_load_dwordx4 a[148:151], v8, s[42:43] offset:1024 sc1
  global_load_dwordx4 a[152:155], v8, s[42:43] offset:2048 sc1
  global_load_dwordx4 a[156:159], v8, s[42:43] offset:3072 sc1
  v_add_u32 v8, 8192, v8
  global_load_dwordx4 a[160:163], v8, s[42:43] offset:-4096 sc1
  global_load_dwordx4 a[164:167], v8, s[42:43] offset:-3072 sc1
  v_add_u32 v44, 57344, v26
  s_lshl_b32 s9, s8, 4
  s_add_u32 s9, s9, s5
  s_mul_i32 s60, s9, 114688
  s_add_u32 s60, s60, s51
  s_add_u32 s61, s60, 3670016
  s_waitcnt vmcnt(7)
  ds_read2st64_b32 v[60:61], v31 offset0:0 offset1:4
  ds_read2st64_b32 v[62:63], v31 offset0:8 offset1:12
  ds_read2st64_b32 v[52:53], v31 offset0:16 offset1:20
  ds_read2st64_b32 v[4:5], v31 offset0:24 offset1:24
  s_waitcnt lgkmcnt(0)
  v_max3_u32 v54, v60, v61, v62
  v_max3_u32 v54, v54, v63, v52
  v_max3_u32 v54, v54, v53, v4
  v_cmp_eq_u32 vcc, -1, v54
  s_nop 0
  s_cbranch_vccnz sptile0_82
bktile0_83:
  s_barrier
  ds_read_b64_tr_b16 v[128:129], v26 offset:0
  ds_read_b64_tr_b16 v[130:131], v26 offset:256
  ds_read_b64_tr_b16 v[132:133], v26 offset:1024
  ds_read_b64_tr_b16 v[134:135], v26 offset:1280
  ds_read_b64_tr_b16 v[136:137], v26 offset:2048
  ds_read_b64_tr_b16 v[138:139], v26 offset:2304
  ds_read_b64_tr_b16 v[140:141], v26 offset:3072
  ds_read_b64_tr_b16 v[142:143], v26 offset:3328
  s_waitcnt lgkmcnt(6)
  v_mfma_f32_32x32x16_bf16 v[64:79], a[0:3], v[128:131], 0
  v_mfma_f32_32x32x16_bf16 v[80:95], a[4:7], v[128:131], 0
  ds_read_b64_tr_b16 v[144:145], v26 offset:4096
  ds_read_b64_tr_b16 v[146:147], v26 offset:4352
  s_add_u32 s14, s5, 16
  s_mul_i32 s14, s14, 28672
  s_add_u32 s14, s14, s49
  v_add_u32 v7, s14, v27
  s_add_u32 m0, s62, 61440
  s_nop 0
  global_load_lds_dwordx4 v7, s[42:43] offset:0 sc1
  s_waitcnt lgkmcnt(6)
  v_mfma_f32_32x32x16_bf16 v[64:79], a[8:11], v[132:135], v[64:79]
  v_mfma_f32_32x32x16_bf16 v[80:95], a[12:15], v[132:135], v[80:95]
  ds_read_b64_tr_b16 v[148:149], v26 offset:5120
  ds_read_b64_tr_b16 v[150:151], v26 offset:5376
  global_load_lds_dwordx4 v7, s[42:43] offset:1024 sc1
  s_waitcnt lgkmcnt(6)
  v_mfma_f32_32x32x16_bf16 v[64:79], a[16:19], v[136:139], v[64:79]
  v_mfma_f32_32x32x16_bf16 v[80:95], a[20:23], v[136:139], v[80:95]
  ds_read_b64_tr_b16 v[128:129], v26 offset:6144
  ds_read_b64_tr_b16 v[130:131], v26 offset:6400
  global_load_lds_dwordx4 v7, s[42:43] offset:2048 sc1
  s_waitcnt lgkmcnt(6)
  v_mfma_f32_32x32x16_bf16 v[64:79], a[24:27], v[140:143], v[64:79]
  v_mfma_f32_32x32x16_bf16 v[80:95], a[28:31], v[140:143], v[80:95]
  ds_read_b64_tr_b16 v[132:133], v26 offset:7168
  ds_read_b64_tr_b16 v[134:135], v26 offset:7424
  global_load_lds_dwordx4 v7, s[42:43] offset:3072 sc1
  s_waitcnt lgkmcnt(6)
  v_mfma_f32_32x32x16_bf16 v[64:79], a[32:35], v[144:147], v[64:79]
  v_mfma_f32_32x32x16_bf16 v[80:95], a[36:39], v[144:147], v[80:95]
  ds_read_b64_tr_b16 v[136:137], v26 offset:8192
  ds_read_b64_tr_b16 v[138:139], v26 offset:8448
  v_add_u32 v7, 4096, v7
  s_add_u32 m0, s62, 65536
  s_nop 0
  global_load_lds_dwordx4 v7, s[42:43] offset:0 sc1
  s_waitcnt lgkmcnt(6)
  v_mfma_f32_32x32x16_bf16 v[64:79], a[40:43], v[148:151], v[64:79]
  v_mfma_f32_32x32x16_bf16 v[80:95], a[44:47], v[148:151], v[80:95]
  ds_read_b64_tr_b16 v[140:141], v26 offset:9216
  ds_read_b64_tr_b16 v[142:143], v26 offset:9472
  global_load_dwordx4 a[168:171], v8, s[42:43] offset:-2048 sc1
  s_waitcnt lgkmcnt(6)
  v_mfma_f32_32x32x16_bf16 v[64:79], a[48:51], v[128:131], v[64:79]
  v_mfma_f32_32x32x16_bf16 v[80:95], a[52:55], v[128:131], v[80:95]
  ds_read_b64_tr_b16 v[144:145], v26 offset:10240
  ds_read_b64_tr_b16 v[146:147], v26 offset:10496
  global_load_dwordx4 a[172:175], v8, s[42:43] offset:-1024 sc1
  s_waitcnt lgkmcnt(6)
  v_mfma_f32_32x32x16_bf16 v[64:79], a[56:59], v[132:135], v[64:79]
  v_mfma_f32_32x32x16_bf16 v[80:95], a[60:63], v[132:135], v[80:95]
  ds_read_b64_tr_b16 v[148:149], v26 offset:11264
  ds_read_b64_tr_b16 v[150:151], v26 offset:11520
  global_load_lds_dwordx4 v7, s[42:43] offset:1024 sc1
  s_waitcnt lgkmcnt(6)
  v_mfma_f32_32x32x16_bf16 v[64:79], a[64:67], v[136:139], v[64:79]
  v_mfma_f32_32x32x16_bf16 v[80:95], a[68:71], v[136:139], v[80:95]
  ds_read_b64_tr_b16 v[128:129], v26 offset:12288
  ds_read_b64_tr_b16 v[130:131], v26 offset:12544
  global_load_dwordx4 a[176:179], v8, s[42:43] offset:0 sc1
  s_waitcnt lgkmcnt(6)
  v_mfma_f32_32x32x16_bf16 v[64:79], a[72:75], v[140:143], v[64:79]
  v_mfma_f32_32x32x16_bf16 v[80:95], a[76:79], v[140:143], v[80:95]
  ds_read_b64_tr_b16 v[132:133], v26 offset:13312
  ds_read_b64_tr_b16 v[134:135], v26 offset:13568
  global_load_dwordx4 a[180:183], v8, s[42:43] offset:1024 sc1
  s_waitcnt lgkmcnt(6)
  v_mfma_f32_32x32x16_bf16 v[64:79], a[80:83], v[144:147], v[64:79]
  v_mfma_f32_32x32x16_bf16 v[80:95], a[84:87], v[144:147], v[80:95]
  ds_read_b64_tr_b16 v[136:137], v26 offset:14336
  ds_read_b64_tr_b16 v[138:139], v26 offset:14592
  global_load_lds_dwordx4 v7, s[42:43] offset:2048 sc1
  s_waitcnt lgkmcnt(6)
  v_mfma_f32_32x32x16_bf16 v[64:79], a[88:91], v[148:151], v[64:79]
  v_mfma_f32_32x32x16_bf16 v[80:95], a[92:95], v[148:151], v[80:95]
  ds_read_b64_tr_b16 v[140:141], v26 offset:15360
  ds_read_b64_tr_b16 v[142:143], v26 offset:15616
  global_load_dwordx4 a[184:187], v8, s[42:43] offset:2048 sc1
  s_waitcnt lgkmcnt(6)
  v_mfma_f32_32x32x16_bf16 v[64:79], a[96:99], v[128:131], v[64:79]
  v_mfma_f32_32x32x16_bf16 v[80:95], a[100:103], v[128:131], v[80:95]
  ds_read_b64_tr_b16 v[144:145], v26 offset:16384
  ds_read_b64_tr_b16 v[146:147], v26 offset:16640
  global_load_dwordx4 a[188:191], v8, s[42:43] offset:3072 sc1
  s_waitcnt lgkmcnt(6)
  v_mfma_f32_32x32x16_bf16 v[64:79], a[104:107], v[132:135], v[64:79]
  v_mfma_f32_32x32x16_bf16 v[80:95], a[108:111], v[132:135], v[80:95]
  ds_read_b64_tr_b16 v[148:149], v26 offset:17408
  ds_read_b64_tr_b16 v[150:151], v26 offset:17664
  v_add_u32 v8, 8192, v8
  global_load_dwordx4 a[192:195], v8, s[42:43] offset:-4096 sc1
  s_waitcnt lgkmcnt(6)
  v_mfma_f32_32x32x16_bf16 v[64:79], a[112:115], v[136:139], v[64:79]
  v_mfma_f32_32x32x16_bf16 v[80:95], a[116:119], v[136:139], v[80:95]
  ds_read_b64_tr_b16 v[128:129], v26 offset:18432
  ds_read_b64_tr_b16 v[130:131], v26 offset:18688
  global_load_dwordx4 a[196:199], v8, s[42:43] offset:-3072 sc1
  s_waitcnt lgkmcnt(6)
  v_mfma_f32_32x32x16_bf16 v[64:79], a[120:123], v[140:143], v[64:79]
  v_mfma_f32_32x32x16_bf16 v[80:95], a[124:127], v[140:143], v[80:95]
  ds_read_b64_tr_b16 v[132:133], v26 offset:19456
  ds_read_b64_tr_b16 v[134:135], v26 offset:19712
  s_add_u32 s14, s59, 4096
  v_add_u32 v55, s14, v2
  global_load_dwordx4 a[224:227], v55, s[42:43] offset:-4096 sc1
  s_waitcnt lgkmcnt(6)
  v_mfma_f32_32x32x16_bf16 v[64:79], a[128:131], v[144:147], v[64:79]
  v_mfma_f32_32x32x16_bf16 v[80:95], a[132:135], v[144:147], v[80:95]
  ds_read_b64_tr_b16 v[136:137], v26 offset:20480
  ds_read_b64_tr_b16 v[138:139], v26 offset:20736
  global_load_dwordx4 a[228:231], v55, s[42:43] offset:-3072 sc1
  s_waitcnt lgkmcnt(6)
  v_mfma_f32_32x32x16_bf16 v[64:79], a[136:139], v[148:151], v[64:79]
  v_mfma_f32_32x32x16_bf16 v[80:95], a[140:143], v[148:151], v[80:95]
  ds_read_b64_tr_b16 v[140:141], v26 offset:21504
  ds_read_b64_tr_b16 v[142:143], v26 offset:21760
  global_load_dwordx4 a[232:235], v55, s[42:43] offset:-2048 sc1
  s_waitcnt lgkmcnt(6)
  s_waitcnt vmcnt(23)
  v_mfma_f32_32x32x16_bf16 v[64:79], a[144:147], v[128:131], v[64:79]
  s_waitcnt vmcnt(22)
  v_mfma_f32_32x32x16_bf16 v[80:95], a[148:151], v[128:131], v[80:95]
  ds_read_b64_tr_b16 v[144:145], v26 offset:22528
  ds_read_b64_tr_b16 v[146:147], v26 offset:22784
  global_load_dwordx4 a[236:239], v55, s[42:43] offset:-1024 sc1
  s_waitcnt lgkmcnt(6)
  s_waitcnt vmcnt(22)
  v_mfma_f32_32x32x16_bf16 v[64:79], a[152:155], v[132:135], v[64:79]
  s_waitcnt vmcnt(21)
  v_mfma_f32_32x32x16_bf16 v[80:95], a[156:159], v[132:135], v[80:95]
  ds_read_b64_tr_b16 v[148:149], v26 offset:23552
  ds_read_b64_tr_b16 v[150:151], v26 offset:23808
  global_load_dwordx4 a[240:243], v55, s[42:43] offset:0 sc1
  s_waitcnt lgkmcnt(6)
  s_waitcnt vmcnt(21)
  v_mfma_f32_32x32x16_bf16 v[64:79], a[160:163], v[136:139], v[64:79]
  s_waitcnt vmcnt(20)
  v_mfma_f32_32x32x16_bf16 v[80:95], a[164:167], v[136:139], v[80:95]
  ds_read_b64_tr_b16 v[128:129], v26 offset:24576
  ds_read_b64_tr_b16 v[130:131], v26 offset:24832
  global_load_dwordx4 a[244:247], v55, s[42:43] offset:1024 sc1
  s_waitcnt lgkmcnt(6)
  s_waitcnt vmcnt(15)
  v_mfma_f32_32x32x16_bf16 v[64:79], a[168:171], v[140:143], v[64:79]
  s_waitcnt vmcnt(10)
  ds_read2st64_b32 v[60:61], v31 offset0:112 offset1:116
  ds_read2st64_b32 v[62:63], v31 offset0:120 offset1:124
  ds_read2st64_b32 v[52:53], v31 offset0:128 offset1:132
  ds_read2st64_b32 v[4:5], v31 offset0:136 offset1:136
  v_mfma_f32_32x32x16_bf16 v[80:95], a[172:175], v[140:143], v[80:95]
  ds_read_b64_tr_b16 v[132:133], v26 offset:25600
  ds_read_b64_tr_b16 v[134:135], v26 offset:25856
  global_load_dwordx4 a[248:251], v55, s[42:43] offset:2048 sc1
  s_waitcnt lgkmcnt(10)
  v_mfma_f32_32x32x16_bf16 v[64:79], a[176:179], v[144:147], v[64:79]
  v_mfma_f32_32x32x16_bf16 v[80:95], a[180:183], v[144:147], v[80:95]
  ds_read_b64_tr_b16 v[136:137], v26 offset:26624
  ds_read_b64_tr_b16 v[138:139], v26 offset:26880
  global_load_dwordx4 a[252:255], v55, s[42:43] offset:3072 sc1
  s_waitcnt lgkmcnt(10)
  s_waitcnt vmcnt(11)
  v_mfma_f32_32x32x16_bf16 v[64:79], a[184:187], v[148:151], v[64:79]
  s_waitcnt lgkmcnt(4)
  v_max3_u32 v54, v60, v61, v62
  v_max3_u32 v54, v54, v63, v52
  v_max3_u32 v54, v54, v53, v4
  v_cmp_eq_u32 vcc, -1, v54
  s_nop 0
  s_cbranch_vccnz sptile1_86
bktile1_87:
  s_waitcnt vmcnt(10)
  v_mfma_f32_32x32x16_bf16 v[80:95], a[188:191], v[148:151], v[80:95]
  ds_read_b64_tr_b16 v[140:141], v26 offset:27648
  ds_read_b64_tr_b16 v[142:143], v26 offset:27904
  v_add_u32 v55, 8192, v55
  global_load_dwordx4 v[152:155], v55, s[42:43] offset:-4096 sc1
  s_barrier
  s_waitcnt vmcnt(10)
  v_mfma_f32_32x32x16_bf16 v[64:79], a[192:195], v[128:131], v[64:79]
  s_waitcnt vmcnt(9)
  v_mfma_f32_32x32x16_bf16 v[80:95], a[196:199], v[128:131], v[80:95]
  ds_read_b64_tr_b16 v[144:145], v26 offset:28672
  ds_read_b64_tr_b16 v[146:147], v26 offset:28928
  global_load_dwordx4 v[156:159], v55, s[42:43] offset:-3072 sc1
  s_waitcnt lgkmcnt(6)
  v_mfma_f32_32x32x16_bf16 v[64:79], a[200:203], v[132:135], v[64:79]
  v_mfma_f32_32x32x16_bf16 v[80:95], a[204:207], v[132:135], v[80:95]
  ds_read_b64_tr_b16 v[148:149], v26 offset:29696
  ds_read_b64_tr_b16 v[150:151], v26 offset:29952
  global_load_dwordx4 v[160:163], v55, s[42:43] offset:-2048 sc1
  s_waitcnt lgkmcnt(6)
  v_mfma_f32_32x32x16_bf16 v[64:79], a[208:211], v[136:139], v[64:79]
  v_mfma_f32_32x32x16_bf16 v[80:95], a[212:215], v[136:139], v[80:95]
  ds_read_b64_tr_b16 v[128:129], v26 offset:30720
  ds_read_b64_tr_b16 v[130:131], v26 offset:30976
  s_add_u32 s14, s5, 32
  s_mul_i32 s14, s14, 28672
  s_add_u32 s14, s14, s49
  v_add_u32 v7, s14, v27
  s_add_u32 m0, s62, 90112
  s_nop 0
  global_load_lds_dwordx4 v7, s[42:43] offset:0 sc1
  s_waitcnt lgkmcnt(6)
  v_mfma_f32_32x32x16_bf16 v[64:79], a[216:219], v[140:143], v[64:79]
  s_add_u32 s14, s5, 0
  s_lshl_b32 s14, s14, 8
  s_add_u32 s14, s14, s54
  v_add_u32 v50, s14, v29
  global_load_dwordx2 v[46:47], v50, s[42:43] sc1
  v_mfma_f32_32x32x16_bf16 v[80:95], a[220:223], v[140:143], v[80:95]
  ds_read_b64_tr_b16 v[132:133], v26 offset:31744
  ds_read_b64_tr_b16 v[134:135], v26 offset:32000
  global_load_lds_dwordx4 v7, s[42:43] offset:1024 sc1
  s_waitcnt lgkmcnt(6)
  v_mfma_f32_32x32x16_bf16 v[96:111], a[0:3], v[144:147], 0
  v_mfma_f32_32x32x16_bf16 v[112:127], a[4:7], v[144:147], 0
  ds_read_b64_tr_b16 v[136:137], v26 offset:32768
  ds_read_b64_tr_b16 v[138:139], v26 offset:33024
  global_load_lds_dwordx4 v7, s[42:43] offset:2048 sc1
  s_waitcnt lgkmcnt(6)
  v_mfma_f32_32x32x16_bf16 v[96:111], a[8:11], v[148:151], v[96:111]
  v_mfma_f32_32x32x16_bf16 v[112:127], a[12:15], v[148:151], v[112:127]
  ds_read_b64_tr_b16 v[140:141], v26 offset:33792
  ds_read_b64_tr_b16 v[142:143], v26 offset:34048
  global_load_lds_dwordx4 v7, s[42:43] offset:3072 sc1
  s_waitcnt lgkmcnt(6)
  v_mfma_f32_32x32x16_bf16 v[96:111], a[16:19], v[128:131], v[96:111]
  v_mfma_f32_32x32x16_bf16 v[112:127], a[20:23], v[128:131], v[112:127]
  ds_read_b64_tr_b16 v[144:145], v26 offset:34816
  ds_read_b64_tr_b16 v[146:147], v26 offset:35072
  v_add_u32 v7, 4096, v7
  s_add_u32 m0, s62, 94208
  s_nop 0
  global_load_lds_dwordx4 v7, s[42:43] offset:0 sc1
  s_waitcnt lgkmcnt(6)
  v_mfma_f32_32x32x16_bf16 v[96:111], a[24:27], v[132:135], v[96:111]
  v_mfma_f32_32x32x16_bf16 v[112:127], a[28:31], v[132:135], v[112:127]
  ds_read_b64_tr_b16 v[148:149], v26 offset:35840
  ds_read_b64_tr_b16 v[150:151], v26 offset:36096
  global_load_lds_dwordx4 v7, s[42:43] offset:1024 sc1
  s_waitcnt lgkmcnt(6)
  v_mfma_f32_32x32x16_bf16 v[96:111], a[32:35], v[136:139], v[96:111]
  v_mfma_f32_32x32x16_bf16 v[112:127], a[36:39], v[136:139], v[112:127]
  ds_read_b64_tr_b16 v[128:129], v26 offset:36864
  ds_read_b64_tr_b16 v[130:131], v26 offset:37120
  global_load_lds_dwordx4 v7, s[42:43] offset:2048 sc1
  s_waitcnt lgkmcnt(6)
  v_mfma_f32_32x32x16_bf16 v[96:111], a[40:43], v[140:143], v[96:111]
  v_mfma_f32_32x32x16_bf16 v[112:127], a[44:47], v[140:143], v[112:127]
  ds_read_b64_tr_b16 v[132:133], v26 offset:37888
  ds_read_b64_tr_b16 v[134:135], v26 offset:38144
  s_add_u32 s14, s5, 48
  s_mul_i32 s14, s14, 28672
  s_add_u32 s14, s14, s49
  v_add_u32 v7, s14, v27
  s_add_u32 m0, s62, 118784
  s_nop 0
  global_load_lds_dwordx4 v7, s[42:43] offset:0 sc1
  s_waitcnt lgkmcnt(6)
  v_mfma_f32_32x32x16_bf16 v[96:111], a[48:51], v[144:147], v[96:111]
  v_mfma_f32_32x32x16_bf16 v[112:127], a[52:55], v[144:147], v[112:127]
  ds_read_b64_tr_b16 v[136:137], v26 offset:38912
  ds_read_b64_tr_b16 v[138:139], v26 offset:39168
  global_load_lds_dwordx4 v7, s[42:43] offset:1024 sc1
  s_waitcnt lgkmcnt(6)
  v_mfma_f32_32x32x16_bf16 v[96:111], a[56:59], v[148:151], v[96:111]
  v_mfma_f32_32x32x16_bf16 v[112:127], a[60:63], v[148:151], v[112:127]
  ds_read_b64_tr_b16 v[140:141], v26 offset:39936
  ds_read_b64_tr_b16 v[142:143], v26 offset:40192
  global_load_lds_dwordx4 v7, s[42:43] offset:2048 sc1
  s_waitcnt lgkmcnt(6)
  v_mfma_f32_32x32x16_bf16 v[96:111], a[64:67], v[128:131], v[96:111]
  s_add_u32 s14, s5, 16
  s_lshl_b32 s14, s14, 8
  s_add_u32 s14, s14, s54
  v_add_u32 v50, s14, v29
  global_load_dwordx2 v[48:49], v50, s[42:43] sc1
  v_mfma_f32_32x32x16_bf16 v[112:127], a[68:71], v[128:131], v[112:127]
  ds_read_b64_tr_b16 v[144:145], v26 offset:40960
  ds_read_b64_tr_b16 v[146:147], v26 offset:41216
  global_load_lds_dwordx4 v7, s[42:43] offset:3072 sc1
  s_waitcnt lgkmcnt(6)
  v_mfma_f32_32x32x16_bf16 v[96:111], a[72:75], v[132:135], v[96:111]
  v_mfma_f32_32x32x16_bf16 v[112:127], a[76:79], v[132:135], v[112:127]
  ds_read_b64_tr_b16 v[148:149], v26 offset:41984
  ds_read_b64_tr_b16 v[150:151], v26 offset:42240
  v_add_u32 v7, 4096, v7
  s_add_u32 m0, s62, 122880
  s_nop 0
  global_load_lds_dwordx4 v7, s[42:43] offset:0 sc1
  s_waitcnt lgkmcnt(6)
  v_mfma_f32_32x32x16_bf16 v[96:111], a[80:83], v[136:139], v[96:111]
  v_mfma_f32_32x32x16_bf16 v[112:127], a[84:87], v[136:139], v[112:127]
  ds_read_b64_tr_b16 v[128:129], v26 offset:43008
  ds_read_b64_tr_b16 v[130:131], v26 offset:43264
  global_load_lds_dwordx4 v7, s[42:43] offset:1024 sc1
  s_waitcnt vmcnt(13)
  v_cmp_eq_u32 vcc, 0, v47
  s_nop 0
  s_cbranch_vccnz sps20_84
bks20_85:
  s_add_u32 s14, s5, 0
  s_mul_i32 s14, s14, 114688
  s_add_u32 s14, s14, s51
  v_add_u32 v51, s14, v28
  s_waitcnt lgkmcnt(6)
  v_mfma_f32_32x32x16_bf16 v[96:111], a[88:91], v[140:143], v[96:111]
  v_mul_f32 v64, v46, v64
  v_mul_f32 v65, v46, v65
  v_exp_f32 v64, v64
  v_exp_f32 v65, v65
  v_mfma_f32_32x32x16_bf16 v[112:127], a[92:95], v[140:143], v[112:127]
  ds_read_b64_tr_b16 v[132:133], v26 offset:44032
  ds_read_b64_tr_b16 v[134:135], v26 offset:44288
  global_load_lds_dwordx4 v7, s[42:43] offset:2048 sc1
  v_fma_f32 v64, v64, v47, v47
  v_fma_f32 v65, v65, v47, v47
  s_waitcnt lgkmcnt(6)
  v_mfma_f32_32x32x16_bf16 v[96:111], a[96:99], v[144:147], v[96:111]
  v_rcp_f32 v64, v64
  v_rcp_f32 v65, v65
  v_mul_f32 v64, v64, v80
  v_mul_f32 v65, v65, v81
  v_mfma_f32_32x32x16_bf16 v[112:127], a[100:103], v[144:147], v[112:127]
  ds_read_b64_tr_b16 v[136:137], v26 offset:45056
  ds_read_b64_tr_b16 v[138:139], v26 offset:45312
  global_load_dwordx4 v[164:167], v55, s[42:43] offset:-1024 sc1
  v_cvt_pk_bf16_f32 v80, v64, v65
  v_mul_f32 v66, v46, v66
  v_mul_f32 v67, v46, v67
  s_waitcnt lgkmcnt(6)
  v_mfma_f32_32x32x16_bf16 v[96:111], a[104:107], v[148:151], v[96:111]
  v_exp_f32 v66, v66
  v_exp_f32 v67, v67
  v_fma_f32 v66, v66, v47, v47
  v_fma_f32 v67, v67, v47, v47
  v_mfma_f32_32x32x16_bf16 v[112:127], a[108:111], v[148:151], v[112:127]
  ds_read_b64_tr_b16 v[140:141], v26 offset:46080
  ds_read_b64_tr_b16 v[142:143], v26 offset:46336
  global_load_dwordx4 v[168:171], v55, s[42:43] offset:0 sc1
  v_rcp_f32 v66, v66
  s_waitcnt lgkmcnt(6)
  v_mfma_f32_32x32x16_bf16 v[96:111], a[112:115], v[128:131], v[96:111]
  v_rcp_f32 v67, v67
  v_mul_f32 v66, v66, v82
  v_mul_f32 v67, v67, v83
  v_cvt_pk_bf16_f32 v81, v66, v67
  v_mul_f32 v68, v46, v68
  v_mfma_f32_32x32x16_bf16 v[112:127], a[116:119], v[128:131], v[112:127]
  ds_read_b64_tr_b16 v[144:145], v26 offset:47104
  ds_read_b64_tr_b16 v[146:147], v26 offset:47360
  global_load_dwordx4 v[172:175], v55, s[42:43] offset:1024 sc1
  v_mul_f32 v69, v46, v69
  v_exp_f32 v68, v68
  s_waitcnt lgkmcnt(6)
  v_mfma_f32_32x32x16_bf16 v[96:111], a[120:123], v[132:135], v[96:111]
  v_exp_f32 v69, v69
  v_fma_f32 v68, v68, v47, v47
  v_fma_f32 v69, v69, v47, v47
  v_rcp_f32 v68, v68
  v_mfma_f32_32x32x16_bf16 v[112:127], a[124:127], v[132:135], v[112:127]
  ds_read_b64_tr_b16 v[148:149], v26 offset:48128
  ds_read_b64_tr_b16 v[150:151], v26 offset:48384
  global_load_dwordx4 v[176:179], v55, s[42:43] offset:2048 sc1
  v_rcp_f32 v69, v69
  v_mul_f32 v68, v68, v84
  s_waitcnt lgkmcnt(6)
  v_mfma_f32_32x32x16_bf16 v[96:111], a[128:131], v[136:139], v[96:111]
  v_mul_f32 v69, v69, v85
  v_cvt_pk_bf16_f32 v82, v68, v69
  v_mul_f32 v70, v46, v70
  v_mul_f32 v71, v46, v71
  v_exp_f32 v70, v70
  v_mfma_f32_32x32x16_bf16 v[112:127], a[132:135], v[136:139], v[112:127]
  ds_read_b64_tr_b16 v[128:129], v26 offset:49152
  ds_read_b64_tr_b16 v[130:131], v26 offset:49408
  global_load_dwordx4 v[180:183], v55, s[42:43] offset:3072 sc1
  v_exp_f32 v71, v71
  v_fma_f32 v70, v70, v47, v47
  s_waitcnt lgkmcnt(6)
  v_mfma_f32_32x32x16_bf16 v[96:111], a[136:139], v[140:143], v[96:111]
  v_fma_f32 v71, v71, v47, v47
  v_rcp_f32 v70, v70
  v_rcp_f32 v71, v71
  v_mul_f32 v70, v70, v86
  v_mfma_f32_32x32x16_bf16 v[112:127], a[140:143], v[140:143], v[112:127]
  ds_read_b64_tr_b16 v[132:133], v26 offset:50176
  ds_read_b64_tr_b16 v[134:135], v26 offset:50432
  v_add_u32 v55, 8192, v55
  global_load_dwordx4 v[184:187], v55, s[42:43] offset:-4096 sc1
  v_mul_f32 v71, v71, v87
  v_cvt_pk_bf16_f32 v83, v70, v71
  s_waitcnt lgkmcnt(6)
  v_mfma_f32_32x32x16_bf16 v[96:111], a[144:147], v[144:147], v[96:111]
  global_store_dwordx4 v51, v[80:83], s[42:43] sc1
  v_mul_f32 v72, v46, v72
  v_mul_f32 v73, v46, v73
  v_exp_f32 v72, v72
  v_mfma_f32_32x32x16_bf16 v[112:127], a[148:151], v[144:147], v[112:127]
  v_exp_f32 v73, v73
  ds_read_b64_tr_b16 v[136:137], v26 offset:51200
  ds_read_b64_tr_b16 v[138:139], v26 offset:51456
  global_load_dwordx4 v[188:191], v55, s[42:43] offset:-3072 sc1
  v_fma_f32 v72, v72, v47, v47
  s_waitcnt lgkmcnt(6)
  v_mfma_f32_32x32x16_bf16 v[96:111], a[152:155], v[148:151], v[96:111]
  v_fma_f32 v73, v73, v47, v47
  v_rcp_f32 v72, v72
  v_rcp_f32 v73, v73
  v_mul_f32 v72, v72, v88
  v_mfma_f32_32x32x16_bf16 v[112:127], a[156:159], v[148:151], v[112:127]
  v_mul_f32 v73, v73, v89
  ds_read_b64_tr_b16 v[140:141], v26 offset:52224
  ds_read_b64_tr_b16 v[142:143], v26 offset:52480
  global_load_dwordx4 v[192:195], v55, s[42:43] offset:-2048 sc1
  v_cvt_pk_bf16_f32 v84, v72, v73
  v_mul_f32 v74, v46, v74
  s_waitcnt lgkmcnt(6)
  v_mfma_f32_32x32x16_bf16 v[96:111], a[160:163], v[128:131], v[96:111]
  v_mul_f32 v75, v46, v75
  v_exp_f32 v74, v74
  v_exp_f32 v75, v75
  v_fma_f32 v74, v74, v47, v47
  v_mfma_f32_32x32x16_bf16 v[112:127], a[164:167], v[128:131], v[112:127]
  v_fma_f32 v75, v75, v47, v47
  ds_read_b64_tr_b16 v[144:145], v26 offset:53248
  ds_read_b64_tr_b16 v[146:147], v26 offset:53504
  global_load_dwordx4 v[196:199], v55, s[42:43] offset:-1024 sc1
  v_rcp_f32 v74, v74
  s_waitcnt lgkmcnt(6)
  v_mfma_f32_32x32x16_bf16 v[96:111], a[168:171], v[132:135], v[96:111]
  v_rcp_f32 v75, v75
  v_mul_f32 v74, v74, v90
  s_waitcnt vmcnt(18)
  v_add_u32 v9, 57344, v31
  ds_read2st64_b32 v[60:61], v9 offset0:0 offset1:4
  ds_read2st64_b32 v[62:63], v9 offset0:8 offset1:12
  ds_read2st64_b32 v[52:53], v9 offset0:16 offset1:20
  ds_read2st64_b32 v[4:5], v9 offset0:24 offset1:24
  v_mfma_f32_32x32x16_bf16 v[112:127], a[172:175], v[132:135], v[112:127]
  v_mul_f32 v75, v75, v91
  v_cvt_pk_bf16_f32 v85, v74, v75
  v_mul_f32 v76, v46, v76
  ds_read_b64_tr_b16 v[148:149], v26 offset:54272
  ds_read_b64_tr_b16 v[150:151], v26 offset:54528
  global_load_dwordx4 v[200:203], v55, s[42:43] offset:0 sc1
  s_waitcnt lgkmcnt(10)
  v_mfma_f32_32x32x16_bf16 v[96:111], a[176:179], v[136:139], v[96:111]
  v_mul_f32 v77, v46, v77
  v_exp_f32 v76, v76
  v_exp_f32 v77, v77
  v_fma_f32 v76, v76, v47, v47
  v_mfma_f32_32x32x16_bf16 v[112:127], a[180:183], v[136:139], v[112:127]
  v_fma_f32 v77, v77, v47, v47
  v_rcp_f32 v76, v76
  ds_read_b64_tr_b16 v[128:129], v26 offset:55296
  ds_read_b64_tr_b16 v[130:131], v26 offset:55552
  global_load_dwordx4 v[204:207], v55, s[42:43] offset:1024 sc1
  s_waitcnt lgkmcnt(10)
  v_mfma_f32_32x32x16_bf16 v[96:111], a[184:187], v[140:143], v[96:111]
  v_rcp_f32 v77, v77
  v_mul_f32 v76, v76, v92
  v_mul_f32 v77, v77, v93
  v_cvt_pk_bf16_f32 v86, v76, v77
  v_mul_f32 v78, v46, v78
  s_waitcnt lgkmcnt(4)
  v_max3_u32 v54, v60, v61, v62
  v_max3_u32 v54, v54, v63, v52
  v_max3_u32 v54, v54, v53, v4
  v_cmp_eq_u32 vcc, -1, v54
  s_nop 0
  s_cbranch_vccnz sptile2_90
bktile2_91:
  v_mfma_f32_32x32x16_bf16 v[112:127], a[188:191], v[140:143], v[112:127]
  v_mul_f32 v79, v46, v79
  v_exp_f32 v78, v78
  ds_read_b64_tr_b16 v[132:133], v26 offset:56320
  ds_read_b64_tr_b16 v[134:135], v26 offset:56576
  global_load_dwordx4 v[208:211], v55, s[42:43] offset:2048 sc1
  s_barrier
  v_mfma_f32_32x32x16_bf16 v[96:111], a[192:195], v[144:147], v[96:111]
  v_exp_f32 v79, v79
  v_fma_f32 v78, v78, v47, v47
  v_fma_f32 v79, v79, v47, v47
  v_rcp_f32 v78, v78
  v_mfma_f32_32x32x16_bf16 v[112:127], a[196:199], v[144:147], v[112:127]
  v_rcp_f32 v79, v79
  v_mul_f32 v78, v78, v94
  ds_read_b64_tr_b16 v[136:137], v44 offset:0
  ds_read_b64_tr_b16 v[138:139], v44 offset:256
  global_load_dwordx4 v[212:215], v55, s[42:43] offset:3072 sc1
  s_waitcnt lgkmcnt(6)
  v_mfma_f32_32x32x16_bf16 v[96:111], a[200:203], v[148:151], v[96:111]
  v_mul_f32 v79, v79, v95
  v_cvt_pk_bf16_f32 v87, v78, v79
  global_store_dwordx4 v51, v[84:87], s[42:43] offset:1024 sc1
  v_mfma_f32_32x32x16_bf16 v[112:127], a[204:207], v[148:151], v[112:127]
  ds_read_b64_tr_b16 v[140:141], v44 offset:1024
  ds_read_b64_tr_b16 v[142:143], v44 offset:1280
  v_add_u32 v55, 8192, v55
  global_load_dwordx4 v[216:219], v55, s[42:43] offset:-4096 sc1
  s_waitcnt lgkmcnt(6)
  v_mfma_f32_32x32x16_bf16 v[96:111], a[208:211], v[128:131], v[96:111]
  v_mfma_f32_32x32x16_bf16 v[112:127], a[212:215], v[128:131], v[112:127]
  ds_read_b64_tr_b16 v[144:145], v44 offset:2048
  ds_read_b64_tr_b16 v[146:147], v44 offset:2304
  global_load_dwordx4 v[220:223], v55, s[42:43] offset:-3072 sc1
  s_waitcnt lgkmcnt(6)
  v_mfma_f32_32x32x16_bf16 v[96:111], a[216:219], v[132:135], v[96:111]
  v_mfma_f32_32x32x16_bf16 v[112:127], a[220:223], v[132:135], v[112:127]
  ds_read_b64_tr_b16 v[148:149], v44 offset:3072
  ds_read_b64_tr_b16 v[150:151], v44 offset:3328
  global_load_dwordx4 v[224:227], v55, s[42:43] offset:-2048 sc1
  s_waitcnt lgkmcnt(6)
  v_mfma_f32_32x32x16_bf16 v[64:79], a[0:3], v[136:139], 0
  v_mfma_f32_32x32x16_bf16 v[80:95], a[4:7], v[136:139], 0
  ds_read_b64_tr_b16 v[128:129], v44 offset:4096
  ds_read_b64_tr_b16 v[130:131], v44 offset:4352
  global_load_dwordx4 v[228:231], v55, s[42:43] offset:-1024 sc1
  s_waitcnt lgkmcnt(6)
  v_mfma_f32_32x32x16_bf16 v[64:79], a[8:11], v[140:143], v[64:79]
  s_waitcnt vmcnt(23)
  v_cmp_eq_u32 vcc, 0, v49
  s_nop 0
  s_cbranch_vccnz sps21_88
bks21_89:
  s_add_u32 s14, s5, 16
  s_mul_i32 s14, s14, 114688
  s_add_u32 s14, s14, s51
  v_add_u32 v51, s14, v28
  v_mfma_f32_32x32x16_bf16 v[80:95], a[12:15], v[140:143], v[80:95]
  v_mul_f32 v96, v48, v96
  ds_read_b64_tr_b16 v[132:133], v44 offset:5120
  ds_read_b64_tr_b16 v[134:135], v44 offset:5376
  global_load_dwordx4 v[232:235], v55, s[42:43] offset:0 sc1
  v_mul_f32 v97, v48, v97
  s_waitcnt lgkmcnt(6)
  v_mfma_f32_32x32x16_bf16 v[64:79], a[16:19], v[144:147], v[64:79]
  v_exp_f32 v96, v96
  v_exp_f32 v97, v97
  v_fma_f32 v96, v96, v49, v49
  v_fma_f32 v97, v97, v49, v49
  v_mfma_f32_32x32x16_bf16 v[80:95], a[20:23], v[144:147], v[80:95]
  v_rcp_f32 v96, v96
  ds_read_b64_tr_b16 v[136:137], v44 offset:6144
  ds_read_b64_tr_b16 v[138:139], v44 offset:6400
  global_load_dwordx4 v[236:239], v55, s[42:43] offset:1024 sc1
  s_waitcnt lgkmcnt(6)
  v_mfma_f32_32x32x16_bf16 v[64:79], a[24:27], v[148:151], v[64:79]
  v_rcp_f32 v97, v97
  v_mul_f32 v96, v96, v112
  v_mul_f32 v97, v97, v113
  v_cvt_pk_bf16_f32 v112, v96, v97
  v_mul_f32 v98, v48, v98
  v_mfma_f32_32x32x16_bf16 v[80:95], a[28:31], v[148:151], v[80:95]
  v_mul_f32 v99, v48, v99
  ds_read_b64_tr_b16 v[140:141], v44 offset:7168
  ds_read_b64_tr_b16 v[142:143], v44 offset:7424
  global_load_dwordx4 v[240:243], v55, s[42:43] offset:2048 sc1
  v_exp_f32 v98, v98
  s_waitcnt lgkmcnt(6)
  v_mfma_f32_32x32x16_bf16 v[64:79], a[32:35], v[128:131], v[64:79]
  v_exp_f32 v99, v99
  v_fma_f32 v98, v98, v49, v49
  v_fma_f32 v99, v99, v49, v49
  v_rcp_f32 v98, v98
  v_mfma_f32_32x32x16_bf16 v[80:95], a[36:39], v[128:131], v[80:95]
  v_rcp_f32 v99, v99
  ds_read_b64_tr_b16 v[144:145], v44 offset:8192
  ds_read_b64_tr_b16 v[146:147], v44 offset:8448
  global_load_dwordx4 v[244:247], v55, s[42:43] offset:3072 sc1
  v_mul_f32 v98, v98, v114
  s_waitcnt lgkmcnt(6)
  v_mfma_f32_32x32x16_bf16 v[64:79], a[40:43], v[132:135], v[64:79]
  v_mul_f32 v99, v99, v115
  v_cvt_pk_bf16_f32 v113, v98, v99
  v_mul_f32 v100, v48, v100
  v_mul_f32 v101, v48, v101
  v_exp_f32 v100, v100
  v_mfma_f32_32x32x16_bf16 v[80:95], a[44:47], v[132:135], v[80:95]
  ds_read_b64_tr_b16 v[148:149], v44 offset:9216
  ds_read_b64_tr_b16 v[150:151], v44 offset:9472
  v_add_u32 v55, 8192, v55
  global_load_dwordx4 v[248:251], v55, s[42:43] offset:-4096 sc1
  v_exp_f32 v101, v101
  s_waitcnt lgkmcnt(6)
  v_mfma_f32_32x32x16_bf16 v[64:79], a[48:51], v[136:139], v[64:79]
  v_fma_f32 v100, v100, v49, v49
  v_fma_f32 v101, v101, v49, v49
  v_rcp_f32 v100, v100
  v_rcp_f32 v101, v101
  v_mfma_f32_32x32x16_bf16 v[80:95], a[52:55], v[136:139], v[80:95]
  v_mul_f32 v100, v100, v116
  v_mul_f32 v101, v101, v117
  ds_read_b64_tr_b16 v[128:129], v44 offset:10240
  ds_read_b64_tr_b16 v[130:131], v44 offset:10496
  global_load_dwordx4 v[252:255], v55, s[42:43] offset:-3072 sc1
  v_cvt_pk_bf16_f32 v114, v100, v101
  s_waitcnt lgkmcnt(6)
  v_mfma_f32_32x32x16_bf16 v[64:79], a[56:59], v[140:143], v[64:79]
  v_mul_f32 v102, v48, v102
  v_mul_f32 v103, v48, v103
  v_exp_f32 v102, v102
  v_exp_f32 v103, v103
  v_mfma_f32_32x32x16_bf16 v[80:95], a[60:63], v[140:143], v[80:95]
  v_fma_f32 v102, v102, v49, v49
  ds_read_b64_tr_b16 v[132:133], v44 offset:11264
  ds_read_b64_tr_b16 v[134:135], v44 offset:11520
  v_fma_f32 v103, v103, v49, v49
  v_rcp_f32 v102, v102
  s_waitcnt lgkmcnt(6)
  v_mfma_f32_32x32x16_bf16 v[64:79], a[64:67], v[144:147], v[64:79]
  v_rcp_f32 v103, v103
  v_mul_f32 v102, v102, v118
  v_mul_f32 v103, v103, v119
  v_cvt_pk_bf16_f32 v115, v102, v103
  v_mfma_f32_32x32x16_bf16 v[80:95], a[68:71], v[144:147], v[80:95]
  ds_read_b64_tr_b16 v[136:137], v44 offset:12288
  ds_read_b64_tr_b16 v[138:139], v44 offset:12544
  global_store_dwordx4 v51, v[112:115], s[42:43] sc1
  v_mul_f32 v104, v48, v104
  v_mul_f32 v105, v48, v105
  s_waitcnt lgkmcnt(6)
  v_mfma_f32_32x32x16_bf16 v[64:79], a[72:75], v[148:151], v[64:79]
  v_exp_f32 v104, v104
  v_exp_f32 v105, v105
  v_fma_f32 v104, v104, v49, v49
  v_mfma_f32_32x32x16_bf16 v[80:95], a[76:79], v[148:151], v[80:95]
  ds_read_b64_tr_b16 v[140:141], v44 offset:13312
  ds_read_b64_tr_b16 v[142:143], v44 offset:13568
  v_fma_f32 v105, v105, v49, v49
  v_rcp_f32 v104, v104
  s_waitcnt lgkmcnt(6)
  v_mfma_f32_32x32x16_bf16 v[64:79], a[80:83], v[128:131], v[64:79]
  v_rcp_f32 v105, v105
  s_add_u32 s14, s5, 32
  s_lshl_b32 s14, s14, 8
  s_add_u32 s14, s14, s54
  v_add_u32 v50, s14, v29
  global_load_dwordx2 v[46:47], v50, s[42:43] sc1
  v_mfma_f32_32x32x16_bf16 v[80:95], a[84:87], v[128:131], v[80:95]
  ds_read_b64_tr_b16 v[56:57], v30
  ds_read_b64_tr_b16 v[58:59], v30 offset:512
  v_mul_f32 v104, v104, v120
  v_mul_f32 v105, v105, v121
  v_cvt_pk_bf16_f32 v116, v104, v105
  ds_read_b64_tr_b16 v[144:145], v44 offset:14336
  ds_read_b64_tr_b16 v[146:147], v44 offset:14592
  s_waitcnt lgkmcnt(8)
  v_mfma_f32_32x32x16_bf16 v[64:79], a[88:91], v[132:135], v[64:79]
  v_mul_f32 v106, v48, v106
  v_mul_f32 v107, v48, v107
  v_exp_f32 v106, v106
  v_exp_f32 v107, v107
  v_mfma_f32_32x32x16_bf16 v[80:95], a[92:95], v[132:135], v[80:95]
  v_fma_f32 v106, v106, v49, v49
  v_fma_f32 v107, v107, v49, v49
  v_rcp_f32 v106, v106
  ds_read_b64_tr_b16 v[148:149], v44 offset:15360
  ds_read_b64_tr_b16 v[150:151], v44 offset:15616
  s_waitcnt lgkmcnt(8)
  v_mfma_f32_32x32x16_bf16 v[64:79], a[96:99], v[136:139], v[64:79]
  v_rcp_f32 v107, v107
  v_mul_f32 v106, v106, v122
  v_mul_f32 v107, v107, v123
  v_cvt_pk_bf16_f32 v117, v106, v107
  v_mul_f32 v108, v48, v108
  v_mfma_f32_32x32x16_bf16 v[80:95], a[100:103], v[136:139], v[80:95]
  v_mul_f32 v109, v48, v109
  ds_read_b64_tr_b16 v[128:129], v44 offset:16384
  ds_read_b64_tr_b16 v[130:131], v44 offset:16640
  v_exp_f32 v108, v108
  s_waitcnt lgkmcnt(8)
  v_mfma_f32_32x32x16_bf16 v[64:79], a[104:107], v[140:143], v[64:79]
  v_exp_f32 v109, v109
  v_fma_f32 v108, v108, v49, v49
  v_fma_f32 v109, v109, v49, v49
  v_rcp_f32 v108, v108
  v_mfma_f32_32x32x16_bf16 v[80:95], a[108:111], v[140:143], v[80:95]
  v_rcp_f32 v109, v109
  ds_read_b64_tr_b16 v[132:133], v44 offset:17408
  ds_read_b64_tr_b16 v[134:135], v44 offset:17664
  v_mul_f32 v108, v108, v124
  v_mul_f32 v109, v109, v125
  s_waitcnt lgkmcnt(6)
  v_mfma_f32_32x32x16_bf16 v[64:79], a[112:115], v[144:147], v[64:79]
  v_cvt_pk_bf16_f32 v118, v108, v109
  v_mul_f32 v110, v48, v110
  v_mul_f32 v111, v48, v111
  v_exp_f32 v110, v110
  v_mfma_f32_32x32x16_bf16 v[80:95], a[116:119], v[144:147], v[80:95]
  ds_read_b64_tr_b16 v[136:137], v44 offset:18432
  ds_read_b64_tr_b16 v[138:139], v44 offset:18688
  v_exp_f32 v111, v111
  v_fma_f32 v110, v110, v49, v49
  v_fma_f32 v111, v111, v49, v49
  s_waitcnt lgkmcnt(6)
  v_mfma_f32_32x32x16_bf16 v[64:79], a[120:123], v[148:151], v[64:79]
  v_rcp_f32 v110, v110
  v_rcp_f32 v111, v111
  v_mul_f32 v110, v110, v126
  v_mfma_f32_32x32x16_bf16 v[80:95], a[124:127], v[148:151], v[80:95]
  ds_read_b64_tr_b16 v[140:141], v44 offset:19456
  ds_read_b64_tr_b16 v[142:143], v44 offset:19712
  v_mul_f32 v111, v111, v127
  v_cvt_pk_bf16_f32 v119, v110, v111
  global_store_dwordx4 v51, v[116:119], s[42:43] offset:1024 sc1
  s_waitcnt lgkmcnt(6)
  v_mfma_f32_32x32x16_bf16 v[64:79], a[128:131], v[128:131], v[64:79]
  v_mfma_f32_32x32x16_bf16 v[80:95], a[132:135], v[128:131], v[80:95]
  ds_read_b64_tr_b16 v[144:145], v44 offset:20480
  ds_read_b64_tr_b16 v[146:147], v44 offset:20736
  s_waitcnt lgkmcnt(6)
  v_mfma_f32_32x32x16_bf16 v[64:79], a[136:139], v[132:135], v[64:79]
  v_mfma_f32_32x32x16_bf16 v[80:95], a[140:143], v[132:135], v[80:95]
  ds_read_b64_tr_b16 v[148:149], v44 offset:21504
  ds_read_b64_tr_b16 v[150:151], v44 offset:21760
  s_waitcnt lgkmcnt(6)
  v_mfma_f32_32x32x16_bf16 v[64:79], a[144:147], v[136:139], v[64:79]
  v_mfma_f32_32x32x16_bf16 v[80:95], a[148:151], v[136:139], v[80:95]
  ds_read_b64_tr_b16 v[128:129], v44 offset:22528
  ds_read_b64_tr_b16 v[130:131], v44 offset:22784
  s_waitcnt lgkmcnt(6)
  v_mfma_f32_32x32x16_bf16 v[64:79], a[152:155], v[140:143], v[64:79]
  v_mfma_f32_32x32x16_bf16 v[80:95], a[156:159], v[140:143], v[80:95]
  ds_read_b64_tr_b16 v[132:133], v44 offset:23552
  ds_read_b64_tr_b16 v[134:135], v44 offset:23808
  s_waitcnt lgkmcnt(6)
  v_mfma_f32_32x32x16_bf16 v[64:79], a[160:163], v[144:147], v[64:79]
  v_mfma_f32_32x32x16_bf16 v[80:95], a[164:167], v[144:147], v[80:95]
  ds_read_b64_tr_b16 v[136:137], v44 offset:24576
  ds_read_b64_tr_b16 v[138:139], v44 offset:24832
  s_waitcnt lgkmcnt(6)
  v_mfma_f32_32x32x16_bf16 v[64:79], a[168:171], v[148:151], v[64:79]
  s_waitcnt vmcnt(28)
  v_add_u32 v9, 57344, v31
  ds_read2st64_b32 v[60:61], v9 offset0:112 offset1:116
  ds_read2st64_b32 v[62:63], v9 offset0:120 offset1:124
  ds_read2st64_b32 v[52:53], v9 offset0:128 offset1:132
  ds_read2st64_b32 v[4:5], v9 offset0:136 offset1:136
  v_mfma_f32_32x32x16_bf16 v[80:95], a[172:175], v[148:151], v[80:95]
  ds_read_b64_tr_b16 v[140:141], v44 offset:25600
  ds_read_b64_tr_b16 v[142:143], v44 offset:25856
  s_waitcnt lgkmcnt(10)
  v_mfma_f32_32x32x16_bf16 v[64:79], a[176:179], v[128:131], v[64:79]
  v_mfma_f32_32x32x16_bf16 v[80:95], a[180:183], v[128:131], v[80:95]
  ds_read_b64_tr_b16 v[144:145], v44 offset:26624
  ds_read_b64_tr_b16 v[146:147], v44 offset:26880
  s_waitcnt lgkmcnt(10)
  v_mfma_f32_32x32x16_bf16 v[64:79], a[184:187], v[132:135], v[64:79]
  s_waitcnt lgkmcnt(4)
  v_max3_u32 v54, v60, v61, v62
  v_max3_u32 v54, v54, v63, v52
  v_max3_u32 v54, v54, v53, v4
  v_cmp_eq_u32 vcc, -1, v54
  s_nop 0
  s_cbranch_vccnz sptile3_94
bktile3_95:
  v_mfma_f32_32x32x16_bf16 v[80:95], a[188:191], v[132:135], v[80:95]
  ds_read_b64_tr_b16 v[148:149], v44 offset:27648
  ds_read_b64_tr_b16 v[150:151], v44 offset:27904
  s_barrier
  v_mfma_f32_32x32x16_bf16 v[64:79], a[192:195], v[136:139], v[64:79]
  v_mfma_f32_32x32x16_bf16 v[80:95], a[196:199], v[136:139], v[80:95]
  ds_read_b64_tr_b16 v[128:129], v44 offset:28672
  ds_read_b64_tr_b16 v[130:131], v44 offset:28928
  s_waitcnt lgkmcnt(6)
  v_mfma_f32_32x32x16_bf16 v[64:79], a[200:203], v[140:143], v[64:79]
  v_mfma_f32_32x32x16_bf16 v[80:95], a[204:207], v[140:143], v[80:95]
  ds_read_b64_tr_b16 v[132:133], v44 offset:29696
  ds_read_b64_tr_b16 v[134:135], v44 offset:29952
  s_waitcnt lgkmcnt(6)
  v_mfma_f32_32x32x16_bf16 v[64:79], a[208:211], v[144:147], v[64:79]
  v_mfma_f32_32x32x16_bf16 v[80:95], a[212:215], v[144:147], v[80:95]
  ds_read_b64_tr_b16 v[136:137], v44 offset:30720
  ds_read_b64_tr_b16 v[138:139], v44 offset:30976
  s_waitcnt lgkmcnt(6)
  v_mfma_f32_32x32x16_bf16 v[64:79], a[216:219], v[148:151], v[64:79]
  v_mfma_f32_32x32x16_bf16 v[80:95], a[220:223], v[148:151], v[80:95]
  ds_read_b64_tr_b16 v[140:141], v44 offset:31744
  ds_read_b64_tr_b16 v[142:143], v44 offset:32000
  s_waitcnt lgkmcnt(6)
  v_mfma_f32_32x32x16_bf16 v[96:111], a[0:3], v[128:131], 0
  v_mfma_f32_32x32x16_bf16 v[112:127], a[4:7], v[128:131], 0
  ds_read_b64_tr_b16 v[144:145], v44 offset:32768
  ds_read_b64_tr_b16 v[146:147], v44 offset:33024
  s_waitcnt lgkmcnt(6)
  v_mfma_f32_32x32x16_bf16 v[96:111], a[8:11], v[132:135], v[96:111]
  s_add_u32 s14, s59, 36864
  v_add_u32 v45, s14, v2
  global_load_dwordx4 a[0:3], v45, s[42:43] offset:-2048 sc1
  s_waitcnt vmcnt(2)
  v_cmp_eq_u32 vcc, 0, v47
  s_nop 0
  s_cbranch_vccnz sps22_92
bks22_93:
  s_add_u32 s14, s5, 32
  s_mul_i32 s14, s14, 114688
  s_add_u32 s14, s14, s51
  v_add_u32 v51, s14, v28
  v_mfma_f32_32x32x16_bf16 v[112:127], a[12:15], v[132:135], v[112:127]
  v_mul_f32 v64, v46, v64
  ds_read_b64_tr_b16 v[148:149], v44 offset:33792
  ds_read_b64_tr_b16 v[150:151], v44 offset:34048
  v_mul_f32 v65, v46, v65
  s_waitcnt lgkmcnt(6)
  v_mfma_f32_32x32x16_bf16 v[96:111], a[16:19], v[136:139], v[96:111]
  global_load_dwordx4 a[4:7], v45, s[42:43] offset:-1024 sc1
  v_exp_f32 v64, v64
  v_exp_f32 v65, v65
  v_mfma_f32_32x32x16_bf16 v[112:127], a[20:23], v[136:139], v[112:127]
  ds_read_b64_tr_b16 v[128:129], v44 offset:34816
  ds_read_b64_tr_b16 v[130:131], v44 offset:35072
  v_fma_f32 v64, v64, v47, v47
  v_fma_f32 v65, v65, v47, v47
  s_waitcnt lgkmcnt(6)
  v_mfma_f32_32x32x16_bf16 v[96:111], a[24:27], v[140:143], v[96:111]
  global_load_dwordx4 a[8:11], v45, s[42:43] offset:0 sc1
  v_rcp_f32 v64, v64
  v_rcp_f32 v65, v65
  v_mfma_f32_32x32x16_bf16 v[112:127], a[28:31], v[140:143], v[112:127]
  ds_read_b64_tr_b16 v[132:133], v44 offset:35840
  ds_read_b64_tr_b16 v[134:135], v44 offset:36096
  v_mul_f32 v64, v64, v80
  v_mul_f32 v65, v65, v81
  s_waitcnt lgkmcnt(6)
  v_mfma_f32_32x32x16_bf16 v[96:111], a[32:35], v[144:147], v[96:111]
  global_load_dwordx4 a[12:15], v45, s[42:43] offset:1024 sc1
  v_cvt_pk_bf16_f32 v80, v64, v65
  v_mul_f32 v66, v46, v66
  v_mfma_f32_32x32x16_bf16 v[112:127], a[36:39], v[144:147], v[112:127]
  ds_read_b64_tr_b16 v[136:137], v44 offset:36864
  ds_read_b64_tr_b16 v[138:139], v44 offset:37120
  v_mul_f32 v67, v46, v67
  v_exp_f32 v66, v66
  s_waitcnt lgkmcnt(6)
  v_mfma_f32_32x32x16_bf16 v[96:111], a[40:43], v[148:151], v[96:111]
  global_load_dwordx4 a[16:19], v45, s[42:43] offset:2048 sc1
  v_exp_f32 v67, v67
  v_fma_f32 v66, v66, v47, v47
  v_mfma_f32_32x32x16_bf16 v[112:127], a[44:47], v[148:151], v[112:127]
  ds_read_b64_tr_b16 v[140:141], v44 offset:37888
  ds_read_b64_tr_b16 v[142:143], v44 offset:38144
  v_fma_f32 v67, v67, v47, v47
  v_rcp_f32 v66, v66
  s_waitcnt lgkmcnt(6)
  v_mfma_f32_32x32x16_bf16 v[96:111], a[48:51], v[128:131], v[96:111]
  global_load_dwordx4 a[20:23], v45, s[42:43] offset:3072 sc1
  v_rcp_f32 v67, v67
  v_mul_f32 v66, v66, v82
  v_mfma_f32_32x32x16_bf16 v[112:127], a[52:55], v[128:131], v[112:127]
  ds_read_b64_tr_b16 v[144:145], v44 offset:38912
  ds_read_b64_tr_b16 v[146:147], v44 offset:39168
  v_mul_f32 v67, v67, v83
  v_cvt_pk_bf16_f32 v81, v66, v67
  s_waitcnt lgkmcnt(6)
  v_mfma_f32_32x32x16_bf16 v[96:111], a[56:59], v[132:135], v[96:111]
  v_add_u32 v45, 8192, v45
  global_load_dwordx4 a[24:27], v45, s[42:43] offset:-4096 sc1
  v_mul_f32 v68, v46, v68
  v_mfma_f32_32x32x16_bf16 v[112:127], a[60:63], v[132:135], v[112:127]
  ds_read_b64_tr_b16 v[148:149], v44 offset:39936
  ds_read_b64_tr_b16 v[150:151], v44 offset:40192
  v_mul_f32 v69, v46, v69
  v_exp_f32 v68, v68
  s_waitcnt lgkmcnt(6)
  v_mfma_f32_32x32x16_bf16 v[96:111], a[64:67], v[136:139], v[96:111]
  s_add_u32 s14, s5, 48
  s_lshl_b32 s14, s14, 8
  s_add_u32 s14, s14, s54
  v_add_u32 v50, s14, v29
  global_load_dwordx2 v[48:49], v50, s[42:43] sc1
  global_load_dwordx4 a[28:31], v45, s[42:43] offset:-3072 sc1
  v_mfma_f32_32x32x16_bf16 v[112:127], a[68:71], v[136:139], v[112:127]
  v_exp_f32 v69, v69
  v_fma_f32 v68, v68, v47, v47
  ds_read_b64_tr_b16 v[128:129], v44 offset:40960
  ds_read_b64_tr_b16 v[130:131], v44 offset:41216
  v_fma_f32 v69, v69, v47, v47
  s_waitcnt lgkmcnt(6)
  v_mfma_f32_32x32x16_bf16 v[96:111], a[72:75], v[140:143], v[96:111]
  v_rcp_f32 v68, v68
  global_load_dwordx4 a[32:35], v45, s[42:43] offset:-2048 sc1
  v_rcp_f32 v69, v69
  v_mul_f32 v68, v68, v84
  v_mfma_f32_32x32x16_bf16 v[112:127], a[76:79], v[140:143], v[112:127]
  ds_read_b64_tr_b16 v[132:133], v44 offset:41984
  ds_read_b64_tr_b16 v[134:135], v44 offset:42240
  v_mul_f32 v69, v69, v85
  v_cvt_pk_bf16_f32 v82, v68, v69
  s_waitcnt lgkmcnt(6)
  v_mfma_f32_32x32x16_bf16 v[96:111], a[80:83], v[144:147], v[96:111]
  global_load_dwordx4 a[36:39], v45, s[42:43] offset:-1024 sc1
  v_mul_f32 v70, v46, v70
  v_mul_f32 v71, v46, v71
  v_mfma_f32_32x32x16_bf16 v[112:127], a[84:87], v[144:147], v[112:127]
  ds_read_b64_tr_b16 v[136:137], v44 offset:43008
  ds_read_b64_tr_b16 v[138:139], v44 offset:43264
  v_exp_f32 v70, v70
  v_exp_f32 v71, v71
  s_waitcnt lgkmcnt(6)
  v_mfma_f32_32x32x16_bf16 v[96:111], a[88:91], v[148:151], v[96:111]
  global_load_dwordx4 a[40:43], v45, s[42:43] offset:0 sc1
  v_fma_f32 v70, v70, v47, v47
  v_fma_f32 v71, v71, v47, v47
  v_mfma_f32_32x32x16_bf16 v[112:127], a[92:95], v[148:151], v[112:127]
  ds_read_b64_tr_b16 v[140:141], v44 offset:44032
  ds_read_b64_tr_b16 v[142:143], v44 offset:44288
  v_rcp_f32 v70, v70
  v_rcp_f32 v71, v71
  s_waitcnt lgkmcnt(6)
  v_mfma_f32_32x32x16_bf16 v[96:111], a[96:99], v[128:131], v[96:111]
  s_add_u32 s14, s60, 4096
  v_add_u32 v6, s14, v38
  global_load_dwordx4 a[88:91], v6, s[42:43] offset:-4096 sc1
  v_mul_f32 v70, v70, v86
  v_mul_f32 v71, v71, v87
  v_mfma_f32_32x32x16_bf16 v[112:127], a[100:103], v[128:131], v[112:127]
  ds_read_b64_tr_b16 v[144:145], v44 offset:45056
  ds_read_b64_tr_b16 v[146:147], v44 offset:45312
  v_cvt_pk_bf16_f32 v83, v70, v71
  v_mul_f32 v72, v46, v72
  s_waitcnt lgkmcnt(6)
  v_mfma_f32_32x32x16_bf16 v[96:111], a[104:107], v[132:135], v[96:111]
  global_load_dwordx4 a[92:95], v6, s[42:43] offset:-3072 sc1
  v_mul_f32 v73, v46, v73
  v_mfma_f32_32x32x16_bf16 v[112:127], a[108:111], v[132:135], v[112:127]
  ds_read_b64_tr_b16 v[148:149], v44 offset:46080
  ds_read_b64_tr_b16 v[150:151], v44 offset:46336
  v_exp_f32 v72, v72
  v_exp_f32 v73, v73
  s_waitcnt lgkmcnt(6)
  v_mfma_f32_32x32x16_bf16 v[96:111], a[112:115], v[136:139], v[96:111]
  global_load_dwordx4 a[96:99], v6, s[42:43] offset:-2048 sc1
  v_fma_f32 v72, v72, v47, v47
  v_fma_f32 v73, v73, v47, v47
  v_mfma_f32_32x32x16_bf16 v[112:127], a[116:119], v[136:139], v[112:127]
  ds_read_b64_tr_b16 v[128:129], v44 offset:47104
  ds_read_b64_tr_b16 v[130:131], v44 offset:47360
  v_rcp_f32 v72, v72
  v_rcp_f32 v73, v73
  s_waitcnt lgkmcnt(6)
  v_mfma_f32_32x32x16_bf16 v[96:111], a[120:123], v[140:143], v[96:111]
  global_load_dwordx4 a[100:103], v6, s[42:43] offset:-1024 sc1
  v_mul_f32 v72, v72, v88
  v_mul_f32 v73, v73, v89
  v_mfma_f32_32x32x16_bf16 v[112:127], a[124:127], v[140:143], v[112:127]
  ds_read_b64_tr_b16 v[132:133], v44 offset:48128
  ds_read_b64_tr_b16 v[134:135], v44 offset:48384
  v_cvt_pk_bf16_f32 v84, v72, v73
  v_mul_f32 v74, v46, v74
  s_waitcnt lgkmcnt(6)
  v_mfma_f32_32x32x16_bf16 v[96:111], a[128:131], v[144:147], v[96:111]
  global_load_dwordx4 a[104:107], v6, s[42:43] offset:0 sc1
  v_mul_f32 v75, v46, v75
  v_exp_f32 v74, v74
  v_mfma_f32_32x32x16_bf16 v[112:127], a[132:135], v[144:147], v[112:127]
  ds_read_b64_tr_b16 v[136:137], v44 offset:49152
  ds_read_b64_tr_b16 v[138:139], v44 offset:49408
  v_exp_f32 v75, v75
  v_fma_f32 v74, v74, v47, v47
  s_waitcnt lgkmcnt(6)
  v_mfma_f32_32x32x16_bf16 v[96:111], a[136:139], v[148:151], v[96:111]
  global_load_dwordx4 a[108:111], v6, s[42:43] offset:1024 sc1
  v_fma_f32 v75, v75, v47, v47
  v_rcp_f32 v74, v74
  v_mfma_f32_32x32x16_bf16 v[112:127], a[140:143], v[148:151], v[112:127]
  ds_read_b64_tr_b16 v[140:141], v44 offset:50176
  ds_read_b64_tr_b16 v[142:143], v44 offset:50432
  v_rcp_f32 v75, v75
  v_mul_f32 v74, v74, v90
  s_waitcnt lgkmcnt(6)
  v_mfma_f32_32x32x16_bf16 v[96:111], a[144:147], v[128:131], v[96:111]
  global_load_dwordx4 a[112:115], v6, s[42:43] offset:2048 sc1
  v_mul_f32 v75, v75, v91
  v_cvt_pk_bf16_f32 v85, v74, v75
  v_mfma_f32_32x32x16_bf16 v[112:127], a[148:151], v[128:131], v[112:127]
  ds_read_b64_tr_b16 v[144:145], v44 offset:51200
  ds_read_b64_tr_b16 v[146:147], v44 offset:51456
  v_mul_f32 v76, v46, v76
  v_mul_f32 v77, v46, v77
  s_waitcnt lgkmcnt(6)
  v_mfma_f32_32x32x16_bf16 v[96:111], a[152:155], v[132:135], v[96:111]
  global_load_dwordx4 a[116:119], v6, s[42:43] offset:3072 sc1
  v_exp_f32 v76, v76
  v_mfma_f32_32x32x16_bf16 v[112:127], a[156:159], v[132:135], v[112:127]
  ds_read_b64_tr_b16 v[148:149], v44 offset:52224
  ds_read_b64_tr_b16 v[150:151], v44 offset:52480
  v_exp_f32 v77, v77
  v_fma_f32 v76, v76, v47, v47
  s_waitcnt lgkmcnt(6)
  v_mfma_f32_32x32x16_bf16 v[96:111], a[160:163], v[136:139], v[96:111]
  v_add_u32 v6, 8192, v6
  global_load_dwordx4 a[120:123], v6, s[42:43] offset:-4096 sc1
  v_fma_f32 v77, v77, v47, v47
  v_rcp_f32 v76, v76
  v_mfma_f32_32x32x16_bf16 v[112:127], a[164:167], v[136:139], v[112:127]
  ds_read_b64_tr_b16 v[128:129], v44 offset:53248
  ds_read_b64_tr_b16 v[130:131], v44 offset:53504
  v_rcp_f32 v77, v77
  v_mul_f32 v76, v76, v92
  s_waitcnt lgkmcnt(6)
  v_mfma_f32_32x32x16_bf16 v[96:111], a[168:171], v[140:143], v[96:111]
  global_load_dwordx4 a[124:127], v6, s[42:43] offset:-3072 sc1
  v_mul_f32 v77, v77, v93
  v_cvt_pk_bf16_f32 v86, v76, v77
  v_mfma_f32_32x32x16_bf16 v[112:127], a[172:175], v[140:143], v[112:127]
  ds_read_b64_tr_b16 v[132:133], v44 offset:54272
  ds_read_b64_tr_b16 v[134:135], v44 offset:54528
  v_mul_f32 v78, v46, v78
  v_mul_f32 v79, v46, v79
  s_waitcnt lgkmcnt(6)
  v_mfma_f32_32x32x16_bf16 v[96:111], a[176:179], v[144:147], v[96:111]
  global_load_dwordx4 a[128:131], v6, s[42:43] offset:-2048 sc1
  v_exp_f32 v78, v78
  v_exp_f32 v79, v79
  v_mfma_f32_32x32x16_bf16 v[112:127], a[180:183], v[144:147], v[112:127]
  ds_read_b64_tr_b16 v[136:137], v44 offset:55296
  ds_read_b64_tr_b16 v[138:139], v44 offset:55552
  v_fma_f32 v78, v78, v47, v47
  v_fma_f32 v79, v79, v47, v47
  s_waitcnt lgkmcnt(6)
  v_mfma_f32_32x32x16_bf16 v[96:111], a[184:187], v[148:151], v[96:111]
  global_load_dwordx4 a[132:135], v6, s[42:43] offset:-1024 sc1
  v_rcp_f32 v78, v78
  v_rcp_f32 v79, v79
  v_mfma_f32_32x32x16_bf16 v[112:127], a[188:191], v[148:151], v[112:127]
  ds_read_b64_tr_b16 v[140:141], v44 offset:56320
  ds_read_b64_tr_b16 v[142:143], v44 offset:56576
  v_mul_f32 v78, v78, v94
  v_mul_f32 v79, v79, v95
  s_waitcnt lgkmcnt(6)
  v_mfma_f32_32x32x16_bf16 v[96:111], a[192:195], v[128:131], v[96:111]
  global_load_dwordx4 a[136:139], v6, s[42:43] offset:0 sc1
  v_cvt_pk_bf16_f32 v87, v78, v79
  global_store_dwordx4 v51, v[80:83], s[42:43] sc1
  v_mfma_f32_32x32x16_bf16 v[112:127], a[196:199], v[128:131], v[112:127]
  global_store_dwordx4 v51, v[84:87], s[42:43] offset:1024 sc1
  s_waitcnt lgkmcnt(4)
  v_mfma_f32_32x32x16_bf16 v[96:111], a[200:203], v[132:135], v[96:111]
  global_load_dwordx4 a[140:143], v6, s[42:43] offset:1024 sc1
  v_mfma_f32_32x32x16_bf16 v[112:127], a[204:207], v[132:135], v[112:127]
  s_waitcnt lgkmcnt(2)
  v_mfma_f32_32x32x16_bf16 v[96:111], a[208:211], v[136:139], v[96:111]
  global_load_dwordx4 a[144:147], v6, s[42:43] offset:2048 sc1
  v_mfma_f32_32x32x16_bf16 v[112:127], a[212:215], v[136:139], v[112:127]
  s_waitcnt vmcnt(13)
  v_accvgpr_read_b32 v52, a88
  v_accvgpr_read_b32 v53, a92
  v_accvgpr_read_b32 v54, a96
  v_accvgpr_read_b32 v9, a100
  v_max3_u32 v52, v52, v53, v54
  v_max_u32 v52, v52, v9
  v_cmp_eq_u32 vcc, -1, v52
  s_nop 0
  s_cbranch_vccnz spha0_98
bkha0_99:
  s_waitcnt lgkmcnt(0)
  v_mfma_f32_32x32x16_bf16 v[96:111], a[216:219], v[140:143], v[96:111]
  global_load_dwordx4 a[148:151], v6, s[42:43] offset:3072 sc1
  v_mfma_f32_32x32x16_bf16 v[112:127], a[220:223], v[140:143], v[112:127]
  v_mfma_f32_32x32x16_bf16 v[64:79], a[224:227], a[88:91], 0
  v_add_u32 v6, 8192, v6
  global_load_dwordx4 a[152:155], v6, s[42:43] offset:-4096 sc1
  v_cmp_eq_u32 vcc, 0, v49
  s_nop 0
  s_cbranch_vccnz sps23_96
bks23_97:
  s_add_u32 s14, s5, 48
  s_mul_i32 s14, s14, 114688
  s_add_u32 s14, s14, s51
  v_add_u32 v51, s14, v28
  v_mfma_f32_32x32x16_bf16 v[80:95], a[228:231], a[88:91], 0
  v_mul_f32 v96, v48, v96
  v_mul_f32 v97, v48, v97
  v_exp_f32 v96, v96
  v_exp_f32 v97, v97
  v_mfma_f32_32x32x16_bf16 v[64:79], a[232:235], a[92:95], v[64:79]
  v_fma_f32 v96, v96, v49, v49
  v_fma_f32 v97, v97, v49, v49
  global_load_dwordx4 a[156:159], v6, s[42:43] offset:-3072 sc1
  v_rcp_f32 v96, v96
  v_mfma_f32_32x32x16_bf16 v[80:95], a[236:239], a[92:95], v[80:95]
  v_rcp_f32 v97, v97
  v_mul_f32 v96, v96, v112
  v_mul_f32 v97, v97, v113
  v_cvt_pk_bf16_f32 v112, v96, v97
  v_mul_f32 v98, v48, v98
  v_mfma_f32_32x32x16_bf16 v[64:79], a[240:243], a[96:99], v[64:79]
  v_mul_f32 v99, v48, v99
  v_exp_f32 v98, v98
  v_exp_f32 v99, v99
  v_fma_f32 v98, v98, v49, v49
  global_load_dwordx4 a[160:163], v6, s[42:43] offset:-2048 sc1
  v_mfma_f32_32x32x16_bf16 v[80:95], a[244:247], a[96:99], v[80:95]
  v_fma_f32 v99, v99, v49, v49
  v_rcp_f32 v98, v98
  v_rcp_f32 v99, v99
  v_mul_f32 v98, v98, v114
  s_waitcnt vmcnt(13)
  v_accvgpr_read_b32 v52, a104
  v_accvgpr_read_b32 v53, a108
  v_accvgpr_read_b32 v54, a112
  v_accvgpr_read_b32 v9, a116
  v_max3_u32 v52, v52, v53, v54
  v_max_u32 v52, v52, v9
  v_cmp_eq_u32 vcc, -1, v52
  s_nop 0
  s_cbranch_vccnz spha1_100
bkha1_101:
  v_mfma_f32_32x32x16_bf16 v[64:79], a[248:251], a[100:103], v[64:79]
  v_mul_f32 v99, v99, v115
  v_cvt_pk_bf16_f32 v113, v98, v99
  v_mul_f32 v100, v48, v100
  v_mul_f32 v101, v48, v101
  v_exp_f32 v100, v100
  global_load_dwordx4 a[164:167], v6, s[42:43] offset:-1024 sc1
  v_mfma_f32_32x32x16_bf16 v[80:95], a[252:255], a[100:103], v[80:95]
  v_exp_f32 v101, v101
  v_fma_f32 v100, v100, v49, v49
  v_fma_f32 v101, v101, v49, v49
  v_rcp_f32 v100, v100
  v_mfma_f32_32x32x16_bf16 v[64:79], v[152:155], a[104:107], v[64:79]
  v_rcp_f32 v101, v101
  v_mul_f32 v100, v100, v116
  v_mul_f32 v101, v101, v117
  v_cvt_pk_bf16_f32 v114, v100, v101
  v_mul_f32 v102, v48, v102
  global_load_dwordx4 a[168:171], v6, s[42:43] offset:0 sc1
  v_mfma_f32_32x32x16_bf16 v[80:95], v[156:159], a[104:107], v[80:95]
  v_mul_f32 v103, v48, v103
  v_exp_f32 v102, v102
  v_exp_f32 v103, v103
  v_fma_f32 v102, v102, v49, v49
  v_mfma_f32_32x32x16_bf16 v[64:79], v[160:163], a[108:111], v[64:79]
  ds_read_b64_tr_b16 v[60:61], v30 offset:57344
  ds_read_b64_tr_b16 v[62:63], v30 offset:57856
  v_fma_f32 v103, v103, v49, v49
  v_rcp_f32 v102, v102
  global_load_dwordx4 a[172:175], v6, s[42:43] offset:1024 sc1
  v_mfma_f32_32x32x16_bf16 v[80:95], v[164:167], a[108:111], v[80:95]
  v_rcp_f32 v103, v103
  v_mul_f32 v102, v102, v118
  v_mul_f32 v103, v103, v119
  v_cvt_pk_bf16_f32 v115, v102, v103
  v_mul_f32 v104, v48, v104
  v_mfma_f32_32x32x16_bf16 v[64:79], v[168:171], a[112:115], v[64:79]
  v_mul_f32 v105, v48, v105
  v_exp_f32 v104, v104
  v_exp_f32 v105, v105
  v_fma_f32 v104, v104, v49, v49
  global_load_dwordx4 a[176:179], v6, s[42:43] offset:2048 sc1
  v_mfma_f32_32x32x16_bf16 v[80:95], v[172:175], a[112:115], v[80:95]
  v_fma_f32 v105, v105, v49, v49
  v_rcp_f32 v104, v104
  v_rcp_f32 v105, v105
  v_mul_f32 v104, v104, v120
  s_waitcnt vmcnt(13)
  v_accvgpr_read_b32 v52, a120
  v_accvgpr_read_b32 v53, a124
  v_accvgpr_read_b32 v54, a128
  v_accvgpr_read_b32 v9, a132
  v_max3_u32 v52, v52, v53, v54
  v_max_u32 v52, v52, v9
  v_cmp_eq_u32 vcc, -1, v52
  s_nop 0
  s_cbranch_vccnz spha2_102
bkha2_103:
  v_mfma_f32_32x32x16_bf16 v[64:79], v[176:179], a[116:119], v[64:79]
  v_mul_f32 v105, v105, v121
  v_cvt_pk_bf16_f32 v116, v104, v105
  v_mul_f32 v106, v48, v106
  v_mul_f32 v107, v48, v107
  v_exp_f32 v106, v106
  global_load_dwordx4 a[180:183], v6, s[42:43] offset:3072 sc1
  v_mfma_f32_32x32x16_bf16 v[80:95], v[180:183], a[116:119], v[80:95]
  v_exp_f32 v107, v107
  v_fma_f32 v106, v106, v49, v49
  v_fma_f32 v107, v107, v49, v49
  v_rcp_f32 v106, v106
  v_mfma_f32_32x32x16_bf16 v[64:79], v[184:187], a[120:123], v[64:79]
  v_rcp_f32 v107, v107
  v_mul_f32 v106, v106, v122
  v_mul_f32 v107, v107, v123
  v_cvt_pk_bf16_f32 v117, v106, v107
  v_mul_f32 v108, v48, v108
  global_load_dwordx4 a[44:47], v45, s[42:43] offset:1024 sc1
  v_mfma_f32_32x32x16_bf16 v[80:95], v[188:191], a[120:123], v[80:95]
  v_mul_f32 v109, v48, v109
  v_exp_f32 v108, v108
  v_exp_f32 v109, v109
  v_fma_f32 v108, v108, v49, v49
  v_mfma_f32_32x32x16_bf16 v[64:79], v[192:195], a[124:127], v[64:79]
  v_fma_f32 v109, v109, v49, v49
  v_rcp_f32 v108, v108
  v_rcp_f32 v109, v109
  v_mul_f32 v108, v108, v124
  v_add_u32 v6, 8192, v6
  global_load_dwordx4 a[184:187], v6, s[42:43] offset:-4096 sc1
  v_mfma_f32_32x32x16_bf16 v[80:95], v[196:199], a[124:127], v[80:95]
  v_mul_f32 v109, v109, v125
  v_cvt_pk_bf16_f32 v118, v108, v109
  v_mul_f32 v110, v48, v110
  v_mul_f32 v111, v48, v111
  v_exp_f32 v110, v110
  v_mfma_f32_32x32x16_bf16 v[64:79], v[200:203], a[128:131], v[64:79]
  v_exp_f32 v111, v111
  v_fma_f32 v110, v110, v49, v49
  v_fma_f32 v111, v111, v49, v49
  v_rcp_f32 v110, v110
  global_load_dwordx4 a[188:191], v6, s[42:43] offset:-3072 sc1
  v_mfma_f32_32x32x16_bf16 v[80:95], v[204:207], a[128:131], v[80:95]
  v_rcp_f32 v111, v111
  v_mul_f32 v110, v110, v126
  v_mul_f32 v111, v111, v127
  v_cvt_pk_bf16_f32 v119, v110, v111
  global_store_dwordx4 v51, v[112:115], s[42:43] sc1
  s_waitcnt vmcnt(12)
  v_accvgpr_read_b32 v52, a136
  v_accvgpr_read_b32 v53, a140
  v_accvgpr_read_b32 v54, a144
  v_accvgpr_read_b32 v9, a148
  v_max3_u32 v52, v52, v53, v54
  v_max_u32 v52, v52, v9
  v_cmp_eq_u32 vcc, -1, v52
  s_nop 0
  s_cbranch_vccnz spha3_104
bkha3_105:
  v_mfma_f32_32x32x16_bf16 v[64:79], v[208:211], a[132:135], v[64:79]
  global_store_dwordx4 v51, v[116:119], s[42:43] offset:1024 sc1
  global_load_dwordx4 a[192:195], v6, s[42:43] offset:-2048 sc1
  v_mfma_f32_32x32x16_bf16 v[80:95], v[212:215], a[132:135], v[80:95]
  v_mfma_f32_32x32x16_bf16 v[64:79], v[216:219], a[136:139], v[64:79]
  global_load_dwordx4 a[196:199], v6, s[42:43] offset:-1024 sc1
  v_mfma_f32_32x32x16_bf16 v[80:95], v[220:223], a[136:139], v[80:95]
  v_mfma_f32_32x32x16_bf16 v[64:79], v[224:227], a[140:143], v[64:79]
  global_load_dwordx4 a[48:51], v45, s[42:43] offset:2048 sc1
  v_mfma_f32_32x32x16_bf16 v[80:95], v[228:231], a[140:143], v[80:95]
  v_mfma_f32_32x32x16_bf16 v[64:79], v[232:235], a[144:147], v[64:79]
  global_load_dwordx4 a[52:55], v45, s[42:43] offset:3072 sc1
  v_mfma_f32_32x32x16_bf16 v[80:95], v[236:239], a[144:147], v[80:95]
  s_waitcnt vmcnt(13)
  v_accvgpr_read_b32 v52, a152
  v_accvgpr_read_b32 v53, a156
  v_accvgpr_read_b32 v54, a160
  v_accvgpr_read_b32 v9, a164
  v_max3_u32 v52, v52, v53, v54
  v_max_u32 v52, v52, v9
  v_cmp_eq_u32 vcc, -1, v52
  s_nop 0
  s_cbranch_vccnz spha4_106
bkha4_107:
  v_mfma_f32_32x32x16_bf16 v[64:79], v[240:243], a[148:151], v[64:79]
  v_add_u32 v45, 8192, v45
  global_load_dwordx4 a[56:59], v45, s[42:43] offset:-4096 sc1
  v_mfma_f32_32x32x16_bf16 v[80:95], v[244:247], a[148:151], v[80:95]
  v_mfma_f32_32x32x16_bf16 v[64:79], v[248:251], a[152:155], v[64:79]
  global_load_dwordx4 a[60:63], v45, s[42:43] offset:-3072 sc1
  v_mfma_f32_32x32x16_bf16 v[80:95], v[252:255], a[152:155], v[80:95]
  v_mfma_f32_32x32x16_bf16 v[64:79], a[0:3], a[156:159], v[64:79]
  global_load_dwordx4 a[64:67], v45, s[42:43] offset:-2048 sc1
  v_mfma_f32_32x32x16_bf16 v[80:95], a[4:7], a[156:159], v[80:95]
  v_mfma_f32_32x32x16_bf16 v[64:79], a[8:11], a[160:163], v[64:79]
  global_load_dwordx4 a[68:71], v45, s[42:43] offset:-1024 sc1
  v_mfma_f32_32x32x16_bf16 v[80:95], a[12:15], a[160:163], v[80:95]
  s_waitcnt vmcnt(13)
  v_accvgpr_read_b32 v52, a168
  v_accvgpr_read_b32 v53, a172
  v_accvgpr_read_b32 v54, a176
  v_accvgpr_read_b32 v9, a180
  v_max3_u32 v52, v52, v53, v54
  v_max_u32 v52, v52, v9
  v_cmp_eq_u32 vcc, -1, v52
  s_nop 0
  s_cbranch_vccnz spha5_108
bkha5_109:
  v_mfma_f32_32x32x16_bf16 v[64:79], a[16:19], a[164:167], v[64:79]
  global_load_dwordx4 a[72:75], v45, s[42:43] offset:0 sc1
  v_mfma_f32_32x32x16_bf16 v[80:95], a[20:23], a[164:167], v[80:95]
  v_mfma_f32_32x32x16_bf16 v[64:79], a[24:27], a[168:171], v[64:79]
  global_load_dwordx4 a[76:79], v45, s[42:43] offset:1024 sc1
  v_mfma_f32_32x32x16_bf16 v[80:95], a[28:31], a[168:171], v[80:95]
  v_mfma_f32_32x32x16_bf16 v[64:79], a[32:35], a[172:175], v[64:79]
  global_load_dwordx4 a[80:83], v45, s[42:43] offset:2048 sc1
  v_mfma_f32_32x32x16_bf16 v[80:95], a[36:39], a[172:175], v[80:95]
  v_mfma_f32_32x32x16_bf16 v[64:79], a[40:43], a[176:179], v[64:79]
  global_load_dwordx4 a[84:87], v45, s[42:43] offset:3072 sc1
  s_waitcnt vmcnt(16)
  v_mfma_f32_32x32x16_bf16 v[80:95], a[44:47], a[176:179], v[80:95]
  s_waitcnt vmcnt(10)
  v_accvgpr_read_b32 v52, a184
  v_accvgpr_read_b32 v53, a188
  v_accvgpr_read_b32 v54, a192
  v_accvgpr_read_b32 v9, a196
  v_max3_u32 v52, v52, v53, v54
  v_max_u32 v52, v52, v9
  v_cmp_eq_u32 vcc, -1, v52
  s_nop 0
  s_cbranch_vccnz spha6_110
bkha6_111:
  s_waitcnt vmcnt(9)
  v_mfma_f32_32x32x16_bf16 v[64:79], a[48:51], a[180:183], v[64:79]
  s_waitcnt vmcnt(8)
  v_mfma_f32_32x32x16_bf16 v[80:95], a[52:55], a[180:183], v[80:95]
  s_waitcnt vmcnt(7)
  v_mfma_f32_32x32x16_bf16 v[64:79], a[56:59], a[184:187], v[64:79]
  s_waitcnt vmcnt(6)
  v_mfma_f32_32x32x16_bf16 v[80:95], a[60:63], a[184:187], v[80:95]
  s_add_u32 s14, s61, 4096
  v_add_u32 v55, s14, v38
  global_load_dwordx4 a[88:91], v55, s[42:43] offset:-4096 sc1
  s_waitcnt vmcnt(6)
  v_mfma_f32_32x32x16_bf16 v[64:79], a[64:67], a[188:191], v[64:79]
  s_waitcnt vmcnt(5)
  v_mfma_f32_32x32x16_bf16 v[80:95], a[68:71], a[188:191], v[80:95]
  global_load_dwordx4 a[92:95], v55, s[42:43] offset:-3072 sc1
  s_waitcnt vmcnt(5)
  v_mfma_f32_32x32x16_bf16 v[64:79], a[72:75], a[192:195], v[64:79]
  s_waitcnt vmcnt(4)
  v_mfma_f32_32x32x16_bf16 v[80:95], a[76:79], a[192:195], v[80:95]
  global_load_dwordx4 a[96:99], v55, s[42:43] offset:-2048 sc1
  s_waitcnt vmcnt(4)
  v_mfma_f32_32x32x16_bf16 v[64:79], a[80:83], a[196:199], v[64:79]
  s_waitcnt vmcnt(3)
  v_mfma_f32_32x32x16_bf16 v[80:95], a[84:87], a[196:199], v[80:95]
  global_load_dwordx4 a[100:103], v55, s[42:43] offset:-1024 sc1
  v_add_u32 v4, s16, v2
  v_add_u32 v5, s17, v2
  v_add_u32 v6, s18, v2
  s_nop 5
  ds_write_b128 v4, v[72:75] offset:0
  ds_write_b128 v4, v[76:79] offset:1024
  ds_write_b128 v5, v[80:83] offset:0
  ds_write_b128 v5, v[84:87] offset:1024
  ds_write_b128 v6, v[88:91] offset:0
  ds_write_b128 v6, v[92:95] offset:1024
  global_load_dwordx4 a[104:107], v55, s[42:43] offset:0 sc1
  global_load_dwordx4 a[108:111], v55, s[42:43] offset:1024 sc1
  global_load_dwordx4 a[112:115], v55, s[42:43] offset:2048 sc1
  global_load_dwordx4 a[116:119], v55, s[42:43] offset:3072 sc1
  s_waitcnt lgkmcnt(0)
  s_barrier
  ds_read_b128 v[128:131], v32 offset:0
  ds_read_b128 v[132:135], v32 offset:1024
  ds_read_b128 v[136:139], v32 offset:2048
  ds_read_b128 v[140:143], v32 offset:3072
  ds_read_b128 v[144:147], v32 offset:4096
  ds_read_b128 v[148:151], v32 offset:5120
  v_lshlrev_b32 v4, 16, v56
  v_add_f32 v64, v64, v4
  v_and_b32 v4, 0xffff0000, v56
  v_add_f32 v65, v65, v4
  v_lshlrev_b32 v4, 16, v57
  v_add_f32 v66, v66, v4
  v_and_b32 v4, 0xffff0000, v57
  v_add_f32 v67, v67, v4
  v_lshlrev_b32 v4, 16, v58
  v_add_f32 v68, v68, v4
  v_add_u32 v55, 8192, v55
  global_load_dwordx4 a[120:123], v55, s[42:43] offset:-4096 sc1
  v_and_b32 v4, 0xffff0000, v58
  v_add_f32 v69, v69, v4
  v_lshlrev_b32 v4, 16, v59
  v_add_f32 v70, v70, v4
  v_and_b32 v4, 0xffff0000, v59
  v_add_f32 v71, v71, v4
  s_waitcnt lgkmcnt(0)
  v_add_f32 v128, v128, v136
  v_add_f32 v129, v129, v137
  global_load_dwordx4 a[124:127], v55, s[42:43] offset:-3072 sc1
  v_add_f32 v130, v130, v138
  v_add_f32 v131, v131, v139
  v_add_f32 v132, v132, v140
  v_add_f32 v133, v133, v141
  v_add_f32 v134, v134, v142
  global_load_dwordx4 a[128:131], v55, s[42:43] offset:-2048 sc1
  v_add_f32 v135, v135, v143
  v_add_f32 v64, v64, v144
  v_add_f32 v65, v65, v145
  v_add_f32 v66, v66, v146
  v_add_f32 v67, v67, v147
  global_load_dwordx4 a[132:135], v55, s[42:43] offset:-1024 sc1
  v_add_f32 v68, v68, v148
  v_add_f32 v69, v69, v149
  v_add_f32 v70, v70, v150
  v_add_f32 v71, v71, v151
  v_add_f32 v64, v64, v128
  global_load_dwordx4 a[136:139], v55, s[42:43] offset:0 sc1
  v_add_f32 v65, v65, v129
  v_add_f32 v66, v66, v130
  v_add_f32 v67, v67, v131
  v_add_f32 v68, v68, v132
  v_add_f32 v69, v69, v133
  global_load_dwordx4 a[140:143], v55, s[42:43] offset:1024 sc1
  v_add_f32 v70, v70, v134
  v_add_f32 v71, v71, v135
  v_cvt_pk_bf16_f32 v72, v64, v65
  v_cvt_pk_bf16_f32 v73, v66, v67
  v_cvt_pk_bf16_f32 v74, v68, v69
  global_load_dwordx4 a[144:147], v55, s[42:43] offset:2048 sc1
  v_cvt_pk_bf16_f32 v75, v70, v71
  v_permlane32_swap_b32 v72, v74
  s_nop 0
  v_permlane32_swap_b32 v73, v75
  s_waitcnt vmcnt(11)
  v_accvgpr_read_b32 v52, a88
  v_accvgpr_read_b32 v53, a92
  v_accvgpr_read_b32 v54, a96
  v_accvgpr_read_b32 v9, a100
  v_max3_u32 v52, v52, v53, v54
  v_max_u32 v52, v52, v9
  v_cmp_eq_u32 vcc, -1, v52
  s_nop 0
  s_cbranch_vccnz sphb0_112
bkhb0_113:
  v_mfma_f32_32x32x16_bf16 v[96:111], a[224:227], a[88:91], 0
  global_load_dwordx4 a[148:151], v55, s[42:43] offset:3072 sc1
  v_mfma_f32_32x32x16_bf16 v[112:127], a[228:231], a[88:91], 0
  v_mfma_f32_32x32x16_bf16 v[96:111], a[232:235], a[92:95], v[96:111]
  v_add_u32 v55, 8192, v55
  global_load_dwordx4 a[152:155], v55, s[42:43] offset:-4096 sc1
  v_mfma_f32_32x32x16_bf16 v[112:127], a[236:239], a[92:95], v[112:127]
  v_mfma_f32_32x32x16_bf16 v[96:111], a[240:243], a[96:99], v[96:111]
  global_load_dwordx4 a[156:159], v55, s[42:43] offset:-3072 sc1
  s_waitcnt vmcnt(10)
  v_accvgpr_read_b32 v52, a104
  v_accvgpr_read_b32 v53, a108
  v_accvgpr_read_b32 v54, a112
  v_accvgpr_read_b32 v9, a116
  v_max3_u32 v52, v52, v53, v54
  v_max_u32 v52, v52, v9
  v_cmp_eq_u32 vcc, -1, v52
  s_nop 0
  s_cbranch_vccnz sphb1_114
bkhb1_115:
  v_mfma_f32_32x32x16_bf16 v[112:127], a[244:247], a[96:99], v[112:127]
  v_mfma_f32_32x32x16_bf16 v[96:111], a[248:251], a[100:103], v[96:111]
  global_load_dwordx4 a[160:163], v55, s[42:43] offset:-2048 sc1
  v_mfma_f32_32x32x16_bf16 v[112:127], a[252:255], a[100:103], v[112:127]
  v_mfma_f32_32x32x16_bf16 v[96:111], v[152:155], a[104:107], v[96:111]
  global_load_dwordx4 a[164:167], v55, s[42:43] offset:-1024 sc1
  v_mfma_f32_32x32x16_bf16 v[112:127], v[156:159], a[104:107], v[112:127]
  v_mfma_f32_32x32x16_bf16 v[96:111], v[160:163], a[108:111], v[96:111]
  global_load_dwordx4 a[168:171], v55, s[42:43] offset:0 sc1
  v_mfma_f32_32x32x16_bf16 v[112:127], v[164:167], a[108:111], v[112:127]
  v_mfma_f32_32x32x16_bf16 v[96:111], v[168:171], a[112:115], v[96:111]
  global_load_dwordx4 a[172:175], v55, s[42:43] offset:1024 sc1
  s_waitcnt vmcnt(10)
  v_accvgpr_read_b32 v52, a120
  v_accvgpr_read_b32 v53, a124
  v_accvgpr_read_b32 v54, a128
  v_accvgpr_read_b32 v9, a132
  v_max3_u32 v52, v52, v53, v54
  v_max_u32 v52, v52, v9
  v_cmp_eq_u32 vcc, -1, v52
  s_nop 0
  s_cbranch_vccnz sphb2_116
bkhb2_117:
  v_mfma_f32_32x32x16_bf16 v[112:127], v[172:175], a[112:115], v[112:127]
  v_mfma_f32_32x32x16_bf16 v[96:111], v[176:179], a[116:119], v[96:111]
  global_load_dwordx4 a[176:179], v55, s[42:43] offset:2048 sc1
  v_mfma_f32_32x32x16_bf16 v[112:127], v[180:183], a[116:119], v[112:127]
  v_mfma_f32_32x32x16_bf16 v[96:111], v[184:187], a[120:123], v[96:111]
  global_load_dwordx4 a[180:183], v55, s[42:43] offset:3072 sc1
  v_mfma_f32_32x32x16_bf16 v[112:127], v[188:191], a[120:123], v[112:127]
  v_mfma_f32_32x32x16_bf16 v[96:111], v[192:195], a[124:127], v[96:111]
  v_add_u32 v55, 8192, v55
  global_load_dwordx4 a[184:187], v55, s[42:43] offset:-4096 sc1
  v_mfma_f32_32x32x16_bf16 v[112:127], v[196:199], a[124:127], v[112:127]
  v_mfma_f32_32x32x16_bf16 v[96:111], v[200:203], a[128:131], v[96:111]
  global_load_dwordx4 a[188:191], v55, s[42:43] offset:-3072 sc1
  s_waitcnt vmcnt(10)
  v_accvgpr_read_b32 v52, a136
  v_accvgpr_read_b32 v53, a140
  v_accvgpr_read_b32 v54, a144
  v_accvgpr_read_b32 v9, a148
  v_max3_u32 v52, v52, v53, v54
  v_max_u32 v52, v52, v9
  v_cmp_eq_u32 vcc, -1, v52
  s_nop 0
  s_cbranch_vccnz sphb3_118
bkhb3_119:
  v_mfma_f32_32x32x16_bf16 v[112:127], v[204:207], a[128:131], v[112:127]
  v_mfma_f32_32x32x16_bf16 v[96:111], v[208:211], a[132:135], v[96:111]
  global_load_dwordx4 a[192:195], v55, s[42:43] offset:-2048 sc1
  v_mfma_f32_32x32x16_bf16 v[112:127], v[212:215], a[132:135], v[112:127]
  v_mfma_f32_32x32x16_bf16 v[96:111], v[216:219], a[136:139], v[96:111]
  global_load_dwordx4 a[196:199], v55, s[42:43] offset:-1024 sc1
  v_mfma_f32_32x32x16_bf16 v[112:127], v[220:223], a[136:139], v[112:127]
  v_mfma_f32_32x32x16_bf16 v[96:111], v[224:227], a[140:143], v[96:111]
  v_add_u32 v6, 0, v37
  global_store_dwordx4 v6, v[72:75], s[38:39]
  v_mfma_f32_32x32x16_bf16 v[112:127], v[228:231], a[140:143], v[112:127]
  v_mfma_f32_32x32x16_bf16 v[96:111], v[232:235], a[144:147], v[96:111]
  s_waitcnt vmcnt(9)
  v_accvgpr_read_b32 v52, a152
  v_accvgpr_read_b32 v53, a156
  v_accvgpr_read_b32 v54, a160
  v_accvgpr_read_b32 v9, a164
  v_max3_u32 v52, v52, v53, v54
  v_max_u32 v52, v52, v9
  v_cmp_eq_u32 vcc, -1, v52
  s_nop 0
  s_cbranch_vccnz sphb4_120
bkhb4_121:
  v_mfma_f32_32x32x16_bf16 v[112:127], v[236:239], a[144:147], v[112:127]
  v_mfma_f32_32x32x16_bf16 v[96:111], v[240:243], a[148:151], v[96:111]
  v_mfma_f32_32x32x16_bf16 v[112:127], v[244:247], a[148:151], v[112:127]
  v_mfma_f32_32x32x16_bf16 v[96:111], v[248:251], a[152:155], v[96:111]
  v_mfma_f32_32x32x16_bf16 v[112:127], v[252:255], a[152:155], v[112:127]
  v_mfma_f32_32x32x16_bf16 v[96:111], a[0:3], a[156:159], v[96:111]
  v_mfma_f32_32x32x16_bf16 v[112:127], a[4:7], a[156:159], v[112:127]
  v_mfma_f32_32x32x16_bf16 v[96:111], a[8:11], a[160:163], v[96:111]
  s_waitcnt vmcnt(5)
  v_accvgpr_read_b32 v52, a168
  v_accvgpr_read_b32 v53, a172
  v_accvgpr_read_b32 v54, a176
  v_accvgpr_read_b32 v9, a180
  v_max3_u32 v52, v52, v53, v54
  v_max_u32 v52, v52, v9
  v_cmp_eq_u32 vcc, -1, v52
  s_nop 0
  s_cbranch_vccnz sphb5_122
bkhb5_123:
  v_mfma_f32_32x32x16_bf16 v[112:127], a[12:15], a[160:163], v[112:127]
  v_mfma_f32_32x32x16_bf16 v[96:111], a[16:19], a[164:167], v[96:111]
  v_mfma_f32_32x32x16_bf16 v[112:127], a[20:23], a[164:167], v[112:127]
  v_mfma_f32_32x32x16_bf16 v[96:111], a[24:27], a[168:171], v[96:111]
  v_mfma_f32_32x32x16_bf16 v[112:127], a[28:31], a[168:171], v[112:127]
  v_mfma_f32_32x32x16_bf16 v[96:111], a[32:35], a[172:175], v[96:111]
  v_mfma_f32_32x32x16_bf16 v[112:127], a[36:39], a[172:175], v[112:127]
  v_mfma_f32_32x32x16_bf16 v[96:111], a[40:43], a[176:179], v[96:111]
  s_waitcnt vmcnt(1)
  v_accvgpr_read_b32 v52, a184
  v_accvgpr_read_b32 v53, a188
  v_accvgpr_read_b32 v54, a192
  v_accvgpr_read_b32 v9, a196
  v_max3_u32 v52, v52, v53, v54
  v_max_u32 v52, v52, v9
  v_cmp_eq_u32 vcc, -1, v52
  s_nop 0
  s_cbranch_vccnz sphb6_124
bkhb6_125:
  v_mfma_f32_32x32x16_bf16 v[112:127], a[44:47], a[176:179], v[112:127]
  v_mfma_f32_32x32x16_bf16 v[96:111], a[48:51], a[180:183], v[96:111]
  v_mfma_f32_32x32x16_bf16 v[112:127], a[52:55], a[180:183], v[112:127]
  v_mfma_f32_32x32x16_bf16 v[96:111], a[56:59], a[184:187], v[96:111]
  v_mfma_f32_32x32x16_bf16 v[112:127], a[60:63], a[184:187], v[112:127]
  v_mfma_f32_32x32x16_bf16 v[96:111], a[64:67], a[188:191], v[96:111]
  v_mfma_f32_32x32x16_bf16 v[112:127], a[68:71], a[188:191], v[112:127]
  v_mfma_f32_32x32x16_bf16 v[96:111], a[72:75], a[192:195], v[96:111]
  v_mfma_f32_32x32x16_bf16 v[112:127], a[76:79], a[192:195], v[112:127]
  v_mfma_f32_32x32x16_bf16 v[96:111], a[80:83], a[196:199], v[96:111]
  v_mfma_f32_32x32x16_bf16 v[112:127], a[84:87], a[196:199], v[112:127]
  v_add_u32 v4, s16, v2
  v_add_u32 v5, s17, v2
  v_add_u32 v6, s18, v2
  s_nop 7
  ds_write_b128 v4, v[104:107] offset:28672
  ds_write_b128 v4, v[108:111] offset:29696
  ds_write_b128 v5, v[112:115] offset:28672
  ds_write_b128 v5, v[116:119] offset:29696
  ds_write_b128 v6, v[120:123] offset:28672
  ds_write_b128 v6, v[124:127] offset:29696
  s_waitcnt lgkmcnt(0)
  s_barrier
  ds_read_b128 v[128:131], v32 offset:28672
  ds_read_b128 v[132:135], v32 offset:29696
  ds_read_b128 v[136:139], v32 offset:30720
  ds_read_b128 v[140:143], v32 offset:31744
  ds_read_b128 v[144:147], v32 offset:32768
  ds_read_b128 v[148:151], v32 offset:33792
  v_lshlrev_b32 v4, 16, v60
  v_add_f32 v96, v96, v4
  v_and_b32 v4, 0xffff0000, v60
  v_add_f32 v97, v97, v4
  v_lshlrev_b32 v4, 16, v61
  v_add_f32 v98, v98, v4
  v_and_b32 v4, 0xffff0000, v61
  v_add_f32 v99, v99, v4
  v_lshlrev_b32 v4, 16, v62
  v_add_f32 v100, v100, v4
  v_and_b32 v4, 0xffff0000, v62
  v_add_f32 v101, v101, v4
  v_lshlrev_b32 v4, 16, v63
  v_add_f32 v102, v102, v4
  v_and_b32 v4, 0xffff0000, v63
  v_add_f32 v103, v103, v4
  v_add_u32 v6, 917504, v37
  s_waitcnt lgkmcnt(0)
  v_add_f32 v128, v128, v136
  v_add_f32 v129, v129, v137
  v_add_f32 v130, v130, v138
  v_add_f32 v131, v131, v139
  v_add_f32 v132, v132, v140
  v_add_f32 v133, v133, v141
  v_add_f32 v134, v134, v142
  v_add_f32 v135, v135, v143
  v_add_f32 v96, v96, v144
  v_add_f32 v97, v97, v145
  v_add_f32 v98, v98, v146
  v_add_f32 v99, v99, v147
  v_add_f32 v100, v100, v148
  v_add_f32 v101, v101, v149
  v_add_f32 v102, v102, v150
  v_add_f32 v103, v103, v151
  v_add_f32 v96, v96, v128
  v_add_f32 v97, v97, v129
  v_add_f32 v98, v98, v130
  v_add_f32 v99, v99, v131
  v_add_f32 v100, v100, v132
  v_add_f32 v101, v101, v133
  v_add_f32 v102, v102, v134
  v_add_f32 v103, v103, v135
  v_cvt_pk_bf16_f32 v104, v96, v97
  v_cvt_pk_bf16_f32 v105, v98, v99
  v_cvt_pk_bf16_f32 v106, v100, v101
  v_cvt_pk_bf16_f32 v107, v102, v103
  s_nop 0
  v_permlane32_swap_b32 v104, v106
  v_permlane32_swap_b32 v105, v107
  global_store_dwordx4 v6, v[104:107], s[38:39]
  s_waitcnt vmcnt(0)
  s_endpgm
L_helper:
  s_sub_u32 s5, s2, 224
  s_mul_i32 s62, s3, 7168
  s_mov_b32 s56, 0x3b124925
  s_mov_b32 s57, 0xbfb8aa3b
  v_mov_b32 v120, -1
  v_mov_b32 v121, -1
  v_mov_b32 v122, -1
  v_mov_b32 v123, -1
  v_lshlrev_b32 v125, 4, v0
  s_mul_i32 s9, s5, 28672
  s_add_u32 s9, s9, 8388608
  s_mov_b32 s10, 4
hf_126:
  v_add_u32 v124, s9, v125
  s_mov_b32 s11, 1
hfi_127:
  global_store_dwordx4 v124, v[120:123], s[42:43] sc1
  v_add_u32 v124, 4096, v124
  global_store_dwordx4 v124, v[120:123], s[42:43] sc1
  v_add_u32 v124, 4096, v124
  global_store_dwordx4 v124, v[120:123], s[42:43] sc1
  v_add_u32 v124, 4096, v124
  global_store_dwordx4 v124, v[120:123], s[42:43] sc1
  v_add_u32 v124, 4096, v124
  global_store_dwordx4 v124, v[120:123], s[42:43] sc1
  v_add_u32 v124, 4096, v124
  global_store_dwordx4 v124, v[120:123], s[42:43] sc1
  v_add_u32 v124, 4096, v124
  global_store_dwordx4 v124, v[120:123], s[42:43] sc1
  v_add_u32 v124, 4096, v124
  s_sub_u32 s11, s11, 1
  s_cmp_lg_u32 s11, 0
  s_cbranch_scc1 hfi_127
  s_add_u32 s9, s9, 458752
  s_sub_u32 s10, s10, 1
  s_cmp_lg_u32 s10, 0
  s_cbranch_scc1 hf_126
  s_mul_i32 s9, s5, 28672
  s_add_u32 s9, s9, 10485760
  s_mov_b32 s10, 4
hf_128:
  v_add_u32 v124, s9, v125
  s_mov_b32 s11, 1
hfi_129:
  global_store_dwordx4 v124, v[120:123], s[42:43] sc1
  v_add_u32 v124, 4096, v124
  global_store_dwordx4 v124, v[120:123], s[42:43] sc1
  v_add_u32 v124, 4096, v124
  global_store_dwordx4 v124, v[120:123], s[42:43] sc1
  v_add_u32 v124, 4096, v124
  global_store_dwordx4 v124, v[120:123], s[42:43] sc1
  v_add_u32 v124, 4096, v124
  global_store_dwordx4 v124, v[120:123], s[42:43] sc1
  v_add_u32 v124, 4096, v124
  global_store_dwordx4 v124, v[120:123], s[42:43] sc1
  v_add_u32 v124, 4096, v124
  global_store_dwordx4 v124, v[120:123], s[42:43] sc1
  v_add_u32 v124, 4096, v124
  s_sub_u32 s11, s11, 1
  s_cmp_lg_u32 s11, 0
  s_cbranch_scc1 hfi_129
  s_add_u32 s9, s9, 458752
  s_sub_u32 s10, s10, 1
  s_cmp_lg_u32 s10, 0
  s_cbranch_scc1 hf_128
  s_waitcnt vmcnt(0)
  s_barrier
  s_cmp_lg_u32 s3, 0
  s_cbranch_scc1 w0_132
  global_load_dword v42, v41, s[40:41] sc1
  s_waitcnt vmcnt(0)
  v_cmp_gt_u32 vcc, 16, v42
  s_nop 0
  s_cbranch_vccnz sphs1a_130
bkhs1a_131:
w0_132:
  s_cmp_lg_u32 s3, 0
  s_cbranch_scc1 sg_133
  s_add_u32 s14, s53, 0
  v_add_u32 v9, s14, v13
  s_mov_b64 exec, 0xff
  global_atomic_add v9, v12, s[42:43] sc1
  s_mov_b64 exec, -1
sg_133:
  s_mul_i32 s9, s5, 28672
  s_add_u32 s9, s9, 12582912
  s_mov_b32 s10, 4
hf_134:
  v_add_u32 v124, s9, v125
  s_mov_b32 s11, 1
hfi_135:
  global_store_dwordx4 v124, v[120:123], s[42:43] sc1
  v_add_u32 v124, 4096, v124
  global_store_dwordx4 v124, v[120:123], s[42:43] sc1
  v_add_u32 v124, 4096, v124
  global_store_dwordx4 v124, v[120:123], s[42:43] sc1
  v_add_u32 v124, 4096, v124
  global_store_dwordx4 v124, v[120:123], s[42:43] sc1
  v_add_u32 v124, 4096, v124
  global_store_dwordx4 v124, v[120:123], s[42:43] sc1
  v_add_u32 v124, 4096, v124
  global_store_dwordx4 v124, v[120:123], s[42:43] sc1
  v_add_u32 v124, 4096, v124
  global_store_dwordx4 v124, v[120:123], s[42:43] sc1
  v_add_u32 v124, 4096, v124
  s_sub_u32 s11, s11, 1
  s_cmp_lg_u32 s11, 0
  s_cbranch_scc1 hfi_135
  s_add_u32 s9, s9, 458752
  s_sub_u32 s10, s10, 1
  s_cmp_lg_u32 s10, 0
  s_cbranch_scc1 hf_134
  v_add_u32 v43, s53, v14
  s_cmp_lg_u32 s3, 0
  s_cbranch_scc1 w0_138
  global_load_dword v42, v43, s[42:43] sc1
  s_waitcnt vmcnt(0)
  v_cmp_gt_u32 vcc, 30, v42
  s_nop 0
  s_cbranch_vccnz sphs1_136
bkhs1_137:
w0_138:
  s_barrier
  v_mov_b32 v41, 0x3727c5ac
L_hloop:
  s_mov_b32 s15, 20000
hw_139:
  s_add_u32 s14, s5, 0
  s_mul_i32 s14, s14, 28672
  s_add_u32 s14, s14, s49
  v_add_u32 v6, s14, v27
  s_add_u32 m0, s62, 32768
  s_nop 0
  global_load_lds_dwordx4 v6, s[42:43] offset:0 sc1
  global_load_lds_dwordx4 v6, s[42:43] offset:1024 sc1
  global_load_lds_dwordx4 v6, s[42:43] offset:2048 sc1
  global_load_lds_dwordx4 v6, s[42:43] offset:3072 sc1
  v_add_u32 v6, 4096, v6
  s_add_u32 m0, s62, 36864
  s_nop 0
  global_load_lds_dwordx4 v6, s[42:43] offset:0 sc1
  global_load_lds_dwordx4 v6, s[42:43] offset:1024 sc1
  global_load_lds_dwordx4 v6, s[42:43] offset:2048 sc1
  s_add_u32 s14, s5, 16
  s_mul_i32 s14, s14, 28672
  s_add_u32 s14, s14, s49
  v_add_u32 v7, s14, v27
  s_add_u32 m0, s62, 61440
  s_nop 0
  global_load_lds_dwordx4 v7, s[42:43] offset:0 sc1
  global_load_lds_dwordx4 v7, s[42:43] offset:1024 sc1
  global_load_lds_dwordx4 v7, s[42:43] offset:2048 sc1
  global_load_lds_dwordx4 v7, s[42:43] offset:3072 sc1
  v_add_u32 v7, 4096, v7
  s_add_u32 m0, s62, 65536
  s_nop 0
  global_load_lds_dwordx4 v7, s[42:43] offset:0 sc1
  global_load_lds_dwordx4 v7, s[42:43] offset:1024 sc1
  global_load_lds_dwordx4 v7, s[42:43] offset:2048 sc1
  s_waitcnt vmcnt(0)
  ds_read2st64_b32 v[96:97], v31 offset0:0 offset1:4
  ds_read2st64_b32 v[98:99], v31 offset0:8 offset1:12
  ds_read2st64_b32 v[100:101], v31 offset0:16 offset1:20
  ds_read2st64_b32 v[102:103], v31 offset0:24 offset1:24
  ds_read2st64_b32 v[104:105], v31 offset0:112 offset1:116
  ds_read2st64_b32 v[106:107], v31 offset0:120 offset1:124
  ds_read2st64_b32 v[108:109], v31 offset0:128 offset1:132
  ds_read2st64_b32 v[110:111], v31 offset0:136 offset1:136
  s_waitcnt lgkmcnt(0)
  v_max3_u32 v112, v96, v97, v98
  v_max3_u32 v112, v112, v99, v100
  v_max3_u32 v112, v112, v101, v102
  v_max3_u32 v112, v112, v104, v105
  v_max_u32 v112, v112, v106
  v_max3_u32 v112, v112, v107, v108
  v_max3_u32 v112, v112, v109, v110
  v_cmp_eq_u32 vcc, -1, v112
  s_nop 0
  s_cbranch_vccz hok_140
  s_sub_u32 s15, s15, 1
  s_cmp_lg_u32 s15, 0
  s_cbranch_scc1 hw_139
hok_140:
  s_barrier
  s_add_u32 s14, s62, 0
  v_add_u32 v4, s14, v26
  ds_read_b64_tr_b16 v[64:65], v4 offset:0
  ds_read_b64_tr_b16 v[66:67], v4 offset:256
  ds_read_b64_tr_b16 v[68:69], v4 offset:1024
  ds_read_b64_tr_b16 v[70:71], v4 offset:1280
  ds_read_b64_tr_b16 v[72:73], v4 offset:2048
  ds_read_b64_tr_b16 v[74:75], v4 offset:2304
  ds_read_b64_tr_b16 v[76:77], v4 offset:3072
  ds_read_b64_tr_b16 v[78:79], v4 offset:3328
  ds_read_b64_tr_b16 v[80:81], v4 offset:4096
  ds_read_b64_tr_b16 v[82:83], v4 offset:4352
  ds_read_b64_tr_b16 v[84:85], v4 offset:5120
  ds_read_b64_tr_b16 v[86:87], v4 offset:5376
  ds_read_b64_tr_b16 v[88:89], v4 offset:6144
  ds_read_b64_tr_b16 v[90:91], v4 offset:6400
  v_mov_b32 v5, 0
  v_mov_b32 v6, 0
  v_lshlrev_b32 v7, 2, v1
  s_lshl_b32 s14, s3, 8
  v_add_u32 v9, s14, v7
  s_waitcnt lgkmcnt(0)
  v_dot2_f32_bf16 v5, v64, s47, v5
  v_dot2_f32_bf16 v6, v64, v64, v6
  v_dot2_f32_bf16 v5, v65, s47, v5
  v_dot2_f32_bf16 v6, v65, v65, v6
  v_dot2_f32_bf16 v5, v66, s47, v5
  v_dot2_f32_bf16 v6, v66, v66, v6
  v_dot2_f32_bf16 v5, v67, s47, v5
  v_dot2_f32_bf16 v6, v67, v67, v6
  v_dot2_f32_bf16 v5, v68, s47, v5
  v_dot2_f32_bf16 v6, v68, v68, v6
  v_dot2_f32_bf16 v5, v69, s47, v5
  v_dot2_f32_bf16 v6, v69, v69, v6
  v_dot2_f32_bf16 v5, v70, s47, v5
  v_dot2_f32_bf16 v6, v70, v70, v6
  v_dot2_f32_bf16 v5, v71, s47, v5
  v_dot2_f32_bf16 v6, v71, v71, v6
  v_dot2_f32_bf16 v5, v72, s47, v5
  v_dot2_f32_bf16 v6, v72, v72, v6
  v_dot2_f32_bf16 v5, v73, s47, v5
  v_dot2_f32_bf16 v6, v73, v73, v6
  v_dot2_f32_bf16 v5, v74, s47, v5
  v_dot2_f32_bf16 v6, v74, v74, v6
  v_dot2_f32_bf16 v5, v75, s47, v5
  v_dot2_f32_bf16 v6, v75, v75, v6
  v_dot2_f32_bf16 v5, v76, s47, v5
  v_dot2_f32_bf16 v6, v76, v76, v6
  v_dot2_f32_bf16 v5, v77, s47, v5
  v_dot2_f32_bf16 v6, v77, v77, v6
  v_dot2_f32_bf16 v5, v78, s47, v5
  v_dot2_f32_bf16 v6, v78, v78, v6
  v_dot2_f32_bf16 v5, v79, s47, v5
  v_dot2_f32_bf16 v6, v79, v79, v6
  v_dot2_f32_bf16 v5, v80, s47, v5
  v_dot2_f32_bf16 v6, v80, v80, v6
  v_dot2_f32_bf16 v5, v81, s47, v5
  v_dot2_f32_bf16 v6, v81, v81, v6
  v_dot2_f32_bf16 v5, v82, s47, v5
  v_dot2_f32_bf16 v6, v82, v82, v6
  v_dot2_f32_bf16 v5, v83, s47, v5
  v_dot2_f32_bf16 v6, v83, v83, v6
  v_dot2_f32_bf16 v5, v84, s47, v5
  v_dot2_f32_bf16 v6, v84, v84, v6
  v_dot2_f32_bf16 v5, v85, s47, v5
  v_dot2_f32_bf16 v6, v85, v85, v6
  v_dot2_f32_bf16 v5, v86, s47, v5
  v_dot2_f32_bf16 v6, v86, v86, v6
  v_dot2_f32_bf16 v5, v87, s47, v5
  v_dot2_f32_bf16 v6, v87, v87, v6
  v_dot2_f32_bf16 v5, v88, s47, v5
  v_dot2_f32_bf16 v6, v88, v88, v6
  v_dot2_f32_bf16 v5, v89, s47, v5
  v_dot2_f32_bf16 v6, v89, v89, v6
  v_dot2_f32_bf16 v5, v90, s47, v5
  v_dot2_f32_bf16 v6, v90, v90, v6
  v_dot2_f32_bf16 v5, v91, s47, v5
  v_dot2_f32_bf16 v6, v91, v91, v6
  s_nop 2
  v_permlane32_swap_b32 v5, v6
  s_nop 1
  v_add_f32 v5, v5, v6
  v_add_u32 v9, 131072, v9
  v_add_u32 v7, 131072, v7
  ds_write_b32 v9, v5 offset:16384
  s_waitcnt lgkmcnt(0)
  s_barrier
  ds_read2st64_b32 v[64:65], v7 offset0:64 offset1:65
  ds_read2st64_b32 v[66:67], v7 offset0:66 offset1:67
  s_add_u32 s14, s5, 0
  s_lshl_b32 s14, s14, 8
  s_add_u32 s14, s14, s54
  v_add_u32 v9, s14, v29
  s_waitcnt lgkmcnt(0)
  v_add_f32 v64, v64, v65
  v_add_f32 v66, v66, v67
  v_add_f32 v64, v64, v66
  v_mov_b32 v65, v64
  s_nop 1
  v_permlane32_swap_b32 v64, v65
  v_mul_f32 v64, s56, v64
  v_fma_f32 v65, v65, s56, v41
  v_fma_f32 v65, -v64, v64, v65
  v_rsq_f32 v66, v65
  v_sqrt_f32 v67, v65
  v_mul_f32 v66, s57, v66
  s_cmp_lg_u32 s3, 0
  s_cbranch_scc1 w0_141
  s_mov_b32 exec_hi, 0
  global_store_dwordx2 v9, v[66:67], s[42:43] sc1
  s_mov_b32 exec_hi, -1
w0_141:
  s_add_u32 s14, s62, 28672
  v_add_u32 v4, s14, v26
  ds_read_b64_tr_b16 v[64:65], v4 offset:0
  ds_read_b64_tr_b16 v[66:67], v4 offset:256
  ds_read_b64_tr_b16 v[68:69], v4 offset:1024
  ds_read_b64_tr_b16 v[70:71], v4 offset:1280
  ds_read_b64_tr_b16 v[72:73], v4 offset:2048
  ds_read_b64_tr_b16 v[74:75], v4 offset:2304
  ds_read_b64_tr_b16 v[76:77], v4 offset:3072
  ds_read_b64_tr_b16 v[78:79], v4 offset:3328
  ds_read_b64_tr_b16 v[80:81], v4 offset:4096
  ds_read_b64_tr_b16 v[82:83], v4 offset:4352
  ds_read_b64_tr_b16 v[84:85], v4 offset:5120
  ds_read_b64_tr_b16 v[86:87], v4 offset:5376
  ds_read_b64_tr_b16 v[88:89], v4 offset:6144
  ds_read_b64_tr_b16 v[90:91], v4 offset:6400
  v_mov_b32 v5, 0
  v_mov_b32 v6, 0
  v_lshlrev_b32 v7, 2, v1
  s_lshl_b32 s14, s3, 8
  v_add_u32 v9, s14, v7
  s_waitcnt lgkmcnt(0)
  v_dot2_f32_bf16 v5, v64, s47, v5
  v_dot2_f32_bf16 v6, v64, v64, v6
  v_dot2_f32_bf16 v5, v65, s47, v5
  v_dot2_f32_bf16 v6, v65, v65, v6
  v_dot2_f32_bf16 v5, v66, s47, v5
  v_dot2_f32_bf16 v6, v66, v66, v6
  v_dot2_f32_bf16 v5, v67, s47, v5
  v_dot2_f32_bf16 v6, v67, v67, v6
  v_dot2_f32_bf16 v5, v68, s47, v5
  v_dot2_f32_bf16 v6, v68, v68, v6
  v_dot2_f32_bf16 v5, v69, s47, v5
  v_dot2_f32_bf16 v6, v69, v69, v6
  v_dot2_f32_bf16 v5, v70, s47, v5
  v_dot2_f32_bf16 v6, v70, v70, v6
  v_dot2_f32_bf16 v5, v71, s47, v5
  v_dot2_f32_bf16 v6, v71, v71, v6
  v_dot2_f32_bf16 v5, v72, s47, v5
  v_dot2_f32_bf16 v6, v72, v72, v6
  v_dot2_f32_bf16 v5, v73, s47, v5
  v_dot2_f32_bf16 v6, v73, v73, v6
  v_dot2_f32_bf16 v5, v74, s47, v5
  v_dot2_f32_bf16 v6, v74, v74, v6
  v_dot2_f32_bf16 v5, v75, s47, v5
  v_dot2_f32_bf16 v6, v75, v75, v6
  v_dot2_f32_bf16 v5, v76, s47, v5
  v_dot2_f32_bf16 v6, v76, v76, v6
  v_dot2_f32_bf16 v5, v77, s47, v5
  v_dot2_f32_bf16 v6, v77, v77, v6
  v_dot2_f32_bf16 v5, v78, s47, v5
  v_dot2_f32_bf16 v6, v78, v78, v6
  v_dot2_f32_bf16 v5, v79, s47, v5
  v_dot2_f32_bf16 v6, v79, v79, v6
  v_dot2_f32_bf16 v5, v80, s47, v5
  v_dot2_f32_bf16 v6, v80, v80, v6
  v_dot2_f32_bf16 v5, v81, s47, v5
  v_dot2_f32_bf16 v6, v81, v81, v6
  v_dot2_f32_bf16 v5, v82, s47, v5
  v_dot2_f32_bf16 v6, v82, v82, v6
  v_dot2_f32_bf16 v5, v83, s47, v5
  v_dot2_f32_bf16 v6, v83, v83, v6
  v_dot2_f32_bf16 v5, v84, s47, v5
  v_dot2_f32_bf16 v6, v84, v84, v6
  v_dot2_f32_bf16 v5, v85, s47, v5
  v_dot2_f32_bf16 v6, v85, v85, v6
  v_dot2_f32_bf16 v5, v86, s47, v5
  v_dot2_f32_bf16 v6, v86, v86, v6
  v_dot2_f32_bf16 v5, v87, s47, v5
  v_dot2_f32_bf16 v6, v87, v87, v6
  v_dot2_f32_bf16 v5, v88, s47, v5
  v_dot2_f32_bf16 v6, v88, v88, v6
  v_dot2_f32_bf16 v5, v89, s47, v5
  v_dot2_f32_bf16 v6, v89, v89, v6
  v_dot2_f32_bf16 v5, v90, s47, v5
  v_dot2_f32_bf16 v6, v90, v90, v6
  v_dot2_f32_bf16 v5, v91, s47, v5
  v_dot2_f32_bf16 v6, v91, v91, v6
  s_nop 2
  v_permlane32_swap_b32 v5, v6
  s_nop 1
  v_add_f32 v5, v5, v6
  v_add_u32 v9, 131072, v9
  v_add_u32 v7, 131072, v7
  ds_write_b32 v9, v5 offset:17408
  s_waitcnt lgkmcnt(0)
  s_barrier
  ds_read2st64_b32 v[64:65], v7 offset0:68 offset1:69
  ds_read2st64_b32 v[66:67], v7 offset0:70 offset1:71
  s_add_u32 s14, s5, 16
  s_lshl_b32 s14, s14, 8
  s_add_u32 s14, s14, s54
  v_add_u32 v9, s14, v29
  s_waitcnt lgkmcnt(0)
  v_add_f32 v64, v64, v65
  v_add_f32 v66, v66, v67
  v_add_f32 v64, v64, v66
  v_mov_b32 v65, v64
  s_nop 1
  v_permlane32_swap_b32 v64, v65
  v_mul_f32 v64, s56, v64
  v_fma_f32 v65, v65, s56, v41
  v_fma_f32 v65, -v64, v64, v65
  v_rsq_f32 v66, v65
  v_sqrt_f32 v67, v65
  v_mul_f32 v66, s57, v66
  s_cmp_lg_u32 s3, 0
  s_cbranch_scc1 w0_142
  s_mov_b32 exec_hi, 0
  global_store_dwordx2 v9, v[66:67], s[42:43] sc1
  s_mov_b32 exec_hi, -1
w0_142:
  s_barrier
  s_mov_b32 s15, 20000
hw_143:
  s_add_u32 s14, s5, 32
  s_mul_i32 s14, s14, 28672
  s_add_u32 s14, s14, s49
  v_add_u32 v6, s14, v27
  s_add_u32 m0, s62, 90112
  s_nop 0
  global_load_lds_dwordx4 v6, s[42:43] offset:0 sc1
  global_load_lds_dwordx4 v6, s[42:43] offset:1024 sc1
  global_load_lds_dwordx4 v6, s[42:43] offset:2048 sc1
  global_load_lds_dwordx4 v6, s[42:43] offset:3072 sc1
  v_add_u32 v6, 4096, v6
  s_add_u32 m0, s62, 94208
  s_nop 0
  global_load_lds_dwordx4 v6, s[42:43] offset:0 sc1
  global_load_lds_dwordx4 v6, s[42:43] offset:1024 sc1
  global_load_lds_dwordx4 v6, s[42:43] offset:2048 sc1
  s_add_u32 s14, s5, 48
  s_mul_i32 s14, s14, 28672
  s_add_u32 s14, s14, s49
  v_add_u32 v7, s14, v27
  s_add_u32 m0, s62, 118784
  s_nop 0
  global_load_lds_dwordx4 v7, s[42:43] offset:0 sc1
  global_load_lds_dwordx4 v7, s[42:43] offset:1024 sc1
  global_load_lds_dwordx4 v7, s[42:43] offset:2048 sc1
  global_load_lds_dwordx4 v7, s[42:43] offset:3072 sc1
  v_add_u32 v7, 4096, v7
  s_add_u32 m0, s62, 122880
  s_nop 0
  global_load_lds_dwordx4 v7, s[42:43] offset:0 sc1
  global_load_lds_dwordx4 v7, s[42:43] offset:1024 sc1
  global_load_lds_dwordx4 v7, s[42:43] offset:2048 sc1
  s_waitcnt vmcnt(0)
  v_add_u32 v9, 57344, v31
  ds_read2st64_b32 v[96:97], v9 offset0:0 offset1:4
  ds_read2st64_b32 v[98:99], v9 offset0:8 offset1:12
  ds_read2st64_b32 v[100:101], v9 offset0:16 offset1:20
  ds_read2st64_b32 v[102:103], v9 offset0:24 offset1:24
  v_add_u32 v9, 57344, v31
  ds_read2st64_b32 v[104:105], v9 offset0:112 offset1:116
  ds_read2st64_b32 v[106:107], v9 offset0:120 offset1:124
  ds_read2st64_b32 v[108:109], v9 offset0:128 offset1:132
  ds_read2st64_b32 v[110:111], v9 offset0:136 offset1:136
  s_waitcnt lgkmcnt(0)
  v_max3_u32 v112, v96, v97, v98
  v_max3_u32 v112, v112, v99, v100
  v_max3_u32 v112, v112, v101, v102
  v_max3_u32 v112, v112, v104, v105
  v_max_u32 v112, v112, v106
  v_max3_u32 v112, v112, v107, v108
  v_max3_u32 v112, v112, v109, v110
  v_cmp_eq_u32 vcc, -1, v112
  s_nop 0
  s_cbranch_vccz hok_144
  s_sub_u32 s15, s15, 1
  s_cmp_lg_u32 s15, 0
  s_cbranch_scc1 hw_143
hok_144:
  s_barrier
  s_add_u32 s14, s62, 57344
  v_add_u32 v4, s14, v26
  ds_read_b64_tr_b16 v[64:65], v4 offset:0
  ds_read_b64_tr_b16 v[66:67], v4 offset:256
  ds_read_b64_tr_b16 v[68:69], v4 offset:1024
  ds_read_b64_tr_b16 v[70:71], v4 offset:1280
  ds_read_b64_tr_b16 v[72:73], v4 offset:2048
  ds_read_b64_tr_b16 v[74:75], v4 offset:2304
  ds_read_b64_tr_b16 v[76:77], v4 offset:3072
  ds_read_b64_tr_b16 v[78:79], v4 offset:3328
  ds_read_b64_tr_b16 v[80:81], v4 offset:4096
  ds_read_b64_tr_b16 v[82:83], v4 offset:4352
  ds_read_b64_tr_b16 v[84:85], v4 offset:5120
  ds_read_b64_tr_b16 v[86:87], v4 offset:5376
  ds_read_b64_tr_b16 v[88:89], v4 offset:6144
  ds_read_b64_tr_b16 v[90:91], v4 offset:6400
  v_mov_b32 v5, 0
  v_mov_b32 v6, 0
  v_lshlrev_b32 v7, 2, v1
  s_lshl_b32 s14, s3, 8
  v_add_u32 v9, s14, v7
  s_waitcnt lgkmcnt(0)
  v_dot2_f32_bf16 v5, v64, s47, v5
  v_dot2_f32_bf16 v6, v64, v64, v6
  v_dot2_f32_bf16 v5, v65, s47, v5
  v_dot2_f32_bf16 v6, v65, v65, v6
  v_dot2_f32_bf16 v5, v66, s47, v5
  v_dot2_f32_bf16 v6, v66, v66, v6
  v_dot2_f32_bf16 v5, v67, s47, v5
  v_dot2_f32_bf16 v6, v67, v67, v6
  v_dot2_f32_bf16 v5, v68, s47, v5
  v_dot2_f32_bf16 v6, v68, v68, v6
  v_dot2_f32_bf16 v5, v69, s47, v5
  v_dot2_f32_bf16 v6, v69, v69, v6
  v_dot2_f32_bf16 v5, v70, s47, v5
  v_dot2_f32_bf16 v6, v70, v70, v6
  v_dot2_f32_bf16 v5, v71, s47, v5
  v_dot2_f32_bf16 v6, v71, v71, v6
  v_dot2_f32_bf16 v5, v72, s47, v5
  v_dot2_f32_bf16 v6, v72, v72, v6
  v_dot2_f32_bf16 v5, v73, s47, v5
  v_dot2_f32_bf16 v6, v73, v73, v6
  v_dot2_f32_bf16 v5, v74, s47, v5
  v_dot2_f32_bf16 v6, v74, v74, v6
  v_dot2_f32_bf16 v5, v75, s47, v5
  v_dot2_f32_bf16 v6, v75, v75, v6
  v_dot2_f32_bf16 v5, v76, s47, v5
  v_dot2_f32_bf16 v6, v76, v76, v6
  v_dot2_f32_bf16 v5, v77, s47, v5
  v_dot2_f32_bf16 v6, v77, v77, v6
  v_dot2_f32_bf16 v5, v78, s47, v5
  v_dot2_f32_bf16 v6, v78, v78, v6
  v_dot2_f32_bf16 v5, v79, s47, v5
  v_dot2_f32_bf16 v6, v79, v79, v6
  v_dot2_f32_bf16 v5, v80, s47, v5
  v_dot2_f32_bf16 v6, v80, v80, v6
  v_dot2_f32_bf16 v5, v81, s47, v5
  v_dot2_f32_bf16 v6, v81, v81, v6
  v_dot2_f32_bf16 v5, v82, s47, v5
  v_dot2_f32_bf16 v6, v82, v82, v6
  v_dot2_f32_bf16 v5, v83, s47, v5
  v_dot2_f32_bf16 v6, v83, v83, v6
  v_dot2_f32_bf16 v5, v84, s47, v5
  v_dot2_f32_bf16 v6, v84, v84, v6
  v_dot2_f32_bf16 v5, v85, s47, v5
  v_dot2_f32_bf16 v6, v85, v85, v6
  v_dot2_f32_bf16 v5, v86, s47, v5
  v_dot2_f32_bf16 v6, v86, v86, v6
  v_dot2_f32_bf16 v5, v87, s47, v5
  v_dot2_f32_bf16 v6, v87, v87, v6
  v_dot2_f32_bf16 v5, v88, s47, v5
  v_dot2_f32_bf16 v6, v88, v88, v6
  v_dot2_f32_bf16 v5, v89, s47, v5
  v_dot2_f32_bf16 v6, v89, v89, v6
  v_dot2_f32_bf16 v5, v90, s47, v5
  v_dot2_f32_bf16 v6, v90, v90, v6
  v_dot2_f32_bf16 v5, v91, s47, v5
  v_dot2_f32_bf16 v6, v91, v91, v6
  s_nop 2
  v_permlane32_swap_b32 v5, v6
  s_nop 1
  v_add_f32 v5, v5, v6
  v_add_u32 v9, 131072, v9
  v_add_u32 v7, 131072, v7
  ds_write_b32 v9, v5 offset:16384
  s_waitcnt lgkmcnt(0)
  s_barrier
  ds_read2st64_b32 v[64:65], v7 offset0:64 offset1:65
  ds_read2st64_b32 v[66:67], v7 offset0:66 offset1:67
  s_add_u32 s14, s5, 32
  s_lshl_b32 s14, s14, 8
  s_add_u32 s14, s14, s54
  v_add_u32 v9, s14, v29
  s_waitcnt lgkmcnt(0)
  v_add_f32 v64, v64, v65
  v_add_f32 v66, v66, v67
  v_add_f32 v64, v64, v66
  v_mov_b32 v65, v64
  s_nop 1
  v_permlane32_swap_b32 v64, v65
  v_mul_f32 v64, s56, v64
  v_fma_f32 v65, v65, s56, v41
  v_fma_f32 v65, -v64, v64, v65
  v_rsq_f32 v66, v65
  v_sqrt_f32 v67, v65
  v_mul_f32 v66, s57, v66
  s_cmp_lg_u32 s3, 0
  s_cbranch_scc1 w0_145
  s_mov_b32 exec_hi, 0
  global_store_dwordx2 v9, v[66:67], s[42:43] sc1
  s_mov_b32 exec_hi, -1
w0_145:
  s_add_u32 s14, s62, 86016
  v_add_u32 v4, s14, v26
  ds_read_b64_tr_b16 v[64:65], v4 offset:0
  ds_read_b64_tr_b16 v[66:67], v4 offset:256
  ds_read_b64_tr_b16 v[68:69], v4 offset:1024
  ds_read_b64_tr_b16 v[70:71], v4 offset:1280
  ds_read_b64_tr_b16 v[72:73], v4 offset:2048
  ds_read_b64_tr_b16 v[74:75], v4 offset:2304
  ds_read_b64_tr_b16 v[76:77], v4 offset:3072
  ds_read_b64_tr_b16 v[78:79], v4 offset:3328
  ds_read_b64_tr_b16 v[80:81], v4 offset:4096
  ds_read_b64_tr_b16 v[82:83], v4 offset:4352
  ds_read_b64_tr_b16 v[84:85], v4 offset:5120
  ds_read_b64_tr_b16 v[86:87], v4 offset:5376
  ds_read_b64_tr_b16 v[88:89], v4 offset:6144
  ds_read_b64_tr_b16 v[90:91], v4 offset:6400
  v_mov_b32 v5, 0
  v_mov_b32 v6, 0
  v_lshlrev_b32 v7, 2, v1
  s_lshl_b32 s14, s3, 8
  v_add_u32 v9, s14, v7
  s_waitcnt lgkmcnt(0)
  v_dot2_f32_bf16 v5, v64, s47, v5
  v_dot2_f32_bf16 v6, v64, v64, v6
  v_dot2_f32_bf16 v5, v65, s47, v5
  v_dot2_f32_bf16 v6, v65, v65, v6
  v_dot2_f32_bf16 v5, v66, s47, v5
  v_dot2_f32_bf16 v6, v66, v66, v6
  v_dot2_f32_bf16 v5, v67, s47, v5
  v_dot2_f32_bf16 v6, v67, v67, v6
  v_dot2_f32_bf16 v5, v68, s47, v5
  v_dot2_f32_bf16 v6, v68, v68, v6
  v_dot2_f32_bf16 v5, v69, s47, v5
  v_dot2_f32_bf16 v6, v69, v69, v6
  v_dot2_f32_bf16 v5, v70, s47, v5
  v_dot2_f32_bf16 v6, v70, v70, v6
  v_dot2_f32_bf16 v5, v71, s47, v5
  v_dot2_f32_bf16 v6, v71, v71, v6
  v_dot2_f32_bf16 v5, v72, s47, v5
  v_dot2_f32_bf16 v6, v72, v72, v6
  v_dot2_f32_bf16 v5, v73, s47, v5
  v_dot2_f32_bf16 v6, v73, v73, v6
  v_dot2_f32_bf16 v5, v74, s47, v5
  v_dot2_f32_bf16 v6, v74, v74, v6
  v_dot2_f32_bf16 v5, v75, s47, v5
  v_dot2_f32_bf16 v6, v75, v75, v6
  v_dot2_f32_bf16 v5, v76, s47, v5
  v_dot2_f32_bf16 v6, v76, v76, v6
  v_dot2_f32_bf16 v5, v77, s47, v5
  v_dot2_f32_bf16 v6, v77, v77, v6
  v_dot2_f32_bf16 v5, v78, s47, v5
  v_dot2_f32_bf16 v6, v78, v78, v6
  v_dot2_f32_bf16 v5, v79, s47, v5
  v_dot2_f32_bf16 v6, v79, v79, v6
  v_dot2_f32_bf16 v5, v80, s47, v5
  v_dot2_f32_bf16 v6, v80, v80, v6
  v_dot2_f32_bf16 v5, v81, s47, v5
  v_dot2_f32_bf16 v6, v81, v81, v6
  v_dot2_f32_bf16 v5, v82, s47, v5
  v_dot2_f32_bf16 v6, v82, v82, v6
  v_dot2_f32_bf16 v5, v83, s47, v5
  v_dot2_f32_bf16 v6, v83, v83, v6
  v_dot2_f32_bf16 v5, v84, s47, v5
  v_dot2_f32_bf16 v6, v84, v84, v6
  v_dot2_f32_bf16 v5, v85, s47, v5
  v_dot2_f32_bf16 v6, v85, v85, v6
  v_dot2_f32_bf16 v5, v86, s47, v5
  v_dot2_f32_bf16 v6, v86, v86, v6
  v_dot2_f32_bf16 v5, v87, s47, v5
  v_dot2_f32_bf16 v6, v87, v87, v6
  v_dot2_f32_bf16 v5, v88, s47, v5
  v_dot2_f32_bf16 v6, v88, v88, v6
  v_dot2_f32_bf16 v5, v89, s47, v5
  v_dot2_f32_bf16 v6, v89, v89, v6
  v_dot2_f32_bf16 v5, v90, s47, v5
  v_dot2_f32_bf16 v6, v90, v90, v6
  v_dot2_f32_bf16 v5, v91, s47, v5
  v_dot2_f32_bf16 v6, v91, v91, v6
  s_nop 2
  v_permlane32_swap_b32 v5, v6
  s_nop 1
  v_add_f32 v5, v5, v6
  v_add_u32 v9, 131072, v9
  v_add_u32 v7, 131072, v7
  ds_write_b32 v9, v5 offset:17408
  s_waitcnt lgkmcnt(0)
  s_barrier
  ds_read2st64_b32 v[64:65], v7 offset0:68 offset1:69
  ds_read2st64_b32 v[66:67], v7 offset0:70 offset1:71
  s_add_u32 s14, s5, 48
  s_lshl_b32 s14, s14, 8
  s_add_u32 s14, s14, s54
  v_add_u32 v9, s14, v29
  s_waitcnt lgkmcnt(0)
  v_add_f32 v64, v64, v65
  v_add_f32 v66, v66, v67
  v_add_f32 v64, v64, v66
  v_mov_b32 v65, v64
  s_nop 1
  v_permlane32_swap_b32 v64, v65
  v_mul_f32 v64, s56, v64
  v_fma_f32 v65, v65, s56, v41
  v_fma_f32 v65, -v64, v64, v65
  v_rsq_f32 v66, v65
  v_sqrt_f32 v67, v65
  v_mul_f32 v66, s57, v66
  s_cmp_lg_u32 s3, 0
  s_cbranch_scc1 w0_146
  s_mov_b32 exec_hi, 0
  global_store_dwordx2 v9, v[66:67], s[42:43] sc1
  s_mov_b32 exec_hi, -1
w0_146:
  s_barrier
  s_cmp_lg_u32 s46, 0
  s_cbranch_scc1 L_hdone
  s_mov_b32 s46, 1
  s_mov_b32 s49, 12582912
  s_mov_b32 s54, 33603584
  s_mul_i32 s9, s5, 114688
  s_add_u32 s9, s9, 25165824
  s_mov_b32 s10, 4
hf_147:
  v_add_u32 v124, s9, v125
  s_mov_b32 s11, 4
hfi_148:
  global_store_dwordx4 v124, v[120:123], s[42:43] sc1
  v_add_u32 v124, 4096, v124
  global_store_dwordx4 v124, v[120:123], s[42:43] sc1
  v_add_u32 v124, 4096, v124
  global_store_dwordx4 v124, v[120:123], s[42:43] sc1
  v_add_u32 v124, 4096, v124
  global_store_dwordx4 v124, v[120:123], s[42:43] sc1
  v_add_u32 v124, 4096, v124
  global_store_dwordx4 v124, v[120:123], s[42:43] sc1
  v_add_u32 v124, 4096, v124
  global_store_dwordx4 v124, v[120:123], s[42:43] sc1
  v_add_u32 v124, 4096, v124
  global_store_dwordx4 v124, v[120:123], s[42:43] sc1
  v_add_u32 v124, 4096, v124
  s_sub_u32 s11, s11, 1
  s_cmp_lg_u32 s11, 0
  s_cbranch_scc1 hfi_148
  s_add_u32 s9, s9, 1835008
  s_sub_u32 s10, s10, 1
  s_cmp_lg_u32 s10, 0
  s_cbranch_scc1 hf_147
  s_branch L_hloop
L_hdone:
  s_waitcnt vmcnt(0)
  s_endpgm
sps1a_24:
  s_mov_b32 s15, 20000
sps1a_24_l:
  global_load_dword v42, v41, s[40:41] sc1
  s_waitcnt vmcnt(0)
  v_cmp_gt_u32 vcc, 16, v42
  s_nop 0
  s_cbranch_vccz bks1a_25
  s_sub_u32 s15, s15, 1
  s_cmp_lg_u32 s15, 0
  s_cbranch_scc1 sps1a_24_l
  s_branch bks1a_25
sps1b_29:
  s_mov_b32 s15, 20000
sps1b_29_l:
  global_load_dword v42, v43, s[42:43] sc1
  s_waitcnt vmcnt(0)
  v_cmp_gt_u32 vcc, 30, v42
  s_nop 0
  s_cbranch_vccz bks1b_30
  s_sub_u32 s15, s15, 1
  s_cmp_lg_u32 s15, 0
  s_cbranch_scc1 sps1b_29_l
  s_branch bks1b_30
sptile0_32:
  s_mov_b32 s15, 20000
sptile0_32_l:
  s_mov_b32 s13, m0
  s_add_u32 s14, s5, 0
  s_mul_i32 s14, s14, 28672
  s_add_u32 s14, s14, s49
  v_add_u32 v9, s14, v27
  s_add_u32 m0, s62, 32768
  s_nop 0
  global_load_lds_dwordx4 v9, s[42:43] offset:0 sc1
  global_load_lds_dwordx4 v9, s[42:43] offset:1024 sc1
  global_load_lds_dwordx4 v9, s[42:43] offset:2048 sc1
  global_load_lds_dwordx4 v9, s[42:43] offset:3072 sc1
  v_add_u32 v9, 4096, v9
  s_add_u32 m0, s62, 36864
  s_nop 0
  global_load_lds_dwordx4 v9, s[42:43] offset:0 sc1
  global_load_lds_dwordx4 v9, s[42:43] offset:1024 sc1
  global_load_lds_dwordx4 v9, s[42:43] offset:2048 sc1
  s_mov_b32 m0, s13
  s_waitcnt vmcnt(0)
  ds_read2st64_b32 v[60:61], v31 offset0:0 offset1:4
  ds_read2st64_b32 v[62:63], v31 offset0:8 offset1:12
  ds_read2st64_b32 v[52:53], v31 offset0:16 offset1:20
  ds_read2st64_b32 v[4:5], v31 offset0:24 offset1:24
  s_waitcnt lgkmcnt(0)
  v_max3_u32 v54, v60, v61, v62
  v_max3_u32 v54, v54, v63, v52
  v_max3_u32 v54, v54, v53, v4
  v_cmp_eq_u32 vcc, -1, v54
  s_nop 0
  s_cbranch_vccz bktile0_33
  s_sub_u32 s15, s15, 1
  s_cmp_lg_u32 s15, 0
  s_cbranch_scc1 sptile0_32_l
  s_branch bktile0_33
sps20_34:
  s_mov_b32 s15, 20000
sps20_34_l:
  s_add_u32 s14, s5, 0
  s_lshl_b32 s14, s14, 8
  s_add_u32 s14, s14, s54
  v_add_u32 v9, s14, v29
  global_load_dwordx2 v[46:47], v9, s[42:43] sc1
  s_waitcnt vmcnt(0)
  v_cmp_eq_u32 vcc, 0, v47
  s_nop 0
  s_cbranch_vccz bks20_35
  s_sub_u32 s15, s15, 1
  s_cmp_lg_u32 s15, 0
  s_cbranch_scc1 sps20_34_l
  s_branch bks20_35
sptile1_36:
  s_mov_b32 s15, 20000
sptile1_36_l:
  s_mov_b32 s13, m0
  s_add_u32 s14, s5, 16
  s_mul_i32 s14, s14, 28672
  s_add_u32 s14, s14, s49
  v_add_u32 v9, s14, v27
  s_add_u32 m0, s62, 61440
  s_nop 0
  global_load_lds_dwordx4 v9, s[42:43] offset:0 sc1
  global_load_lds_dwordx4 v9, s[42:43] offset:1024 sc1
  global_load_lds_dwordx4 v9, s[42:43] offset:2048 sc1
  global_load_lds_dwordx4 v9, s[42:43] offset:3072 sc1
  v_add_u32 v9, 4096, v9
  s_add_u32 m0, s62, 65536
  s_nop 0
  global_load_lds_dwordx4 v9, s[42:43] offset:0 sc1
  global_load_lds_dwordx4 v9, s[42:43] offset:1024 sc1
  global_load_lds_dwordx4 v9, s[42:43] offset:2048 sc1
  s_mov_b32 m0, s13
  s_waitcnt vmcnt(0)
  ds_read2st64_b32 v[60:61], v31 offset0:112 offset1:116
  ds_read2st64_b32 v[62:63], v31 offset0:120 offset1:124
  ds_read2st64_b32 v[52:53], v31 offset0:128 offset1:132
  ds_read2st64_b32 v[4:5], v31 offset0:136 offset1:136
  s_waitcnt lgkmcnt(0)
  v_max3_u32 v54, v60, v61, v62
  v_max3_u32 v54, v54, v63, v52
  v_max3_u32 v54, v54, v53, v4
  v_cmp_eq_u32 vcc, -1, v54
  s_nop 0
  s_cbranch_vccz bktile1_37
  s_sub_u32 s15, s15, 1
  s_cmp_lg_u32 s15, 0
  s_cbranch_scc1 sptile1_36_l
  s_branch bktile1_37
sps21_38:
  s_mov_b32 s15, 20000
sps21_38_l:
  s_add_u32 s14, s5, 16
  s_lshl_b32 s14, s14, 8
  s_add_u32 s14, s14, s54
  v_add_u32 v9, s14, v29
  global_load_dwordx2 v[48:49], v9, s[42:43] sc1
  s_waitcnt vmcnt(0)
  v_cmp_eq_u32 vcc, 0, v49
  s_nop 0
  s_cbranch_vccz bks21_39
  s_sub_u32 s15, s15, 1
  s_cmp_lg_u32 s15, 0
  s_cbranch_scc1 sps21_38_l
  s_branch bks21_39
sptile2_40:
  s_mov_b32 s15, 20000
sptile2_40_l:
  s_mov_b32 s13, m0
  s_add_u32 s14, s5, 32
  s_mul_i32 s14, s14, 28672
  s_add_u32 s14, s14, s49
  v_add_u32 v9, s14, v27
  s_add_u32 m0, s62, 90112
  s_nop 0
  global_load_lds_dwordx4 v9, s[42:43] offset:0 sc1
  global_load_lds_dwordx4 v9, s[42:43] offset:1024 sc1
  global_load_lds_dwordx4 v9, s[42:43] offset:2048 sc1
  global_load_lds_dwordx4 v9, s[42:43] offset:3072 sc1
  v_add_u32 v9, 4096, v9
  s_add_u32 m0, s62, 94208
  s_nop 0
  global_load_lds_dwordx4 v9, s[42:43] offset:0 sc1
  global_load_lds_dwordx4 v9, s[42:43] offset:1024 sc1
  global_load_lds_dwordx4 v9, s[42:43] offset:2048 sc1
  s_mov_b32 m0, s13
  s_waitcnt vmcnt(0)
  v_add_u32 v9, 57344, v31
  ds_read2st64_b32 v[60:61], v9 offset0:0 offset1:4
  ds_read2st64_b32 v[62:63], v9 offset0:8 offset1:12
  ds_read2st64_b32 v[52:53], v9 offset0:16 offset1:20
  ds_read2st64_b32 v[4:5], v9 offset0:24 offset1:24
  s_waitcnt lgkmcnt(0)
  v_max3_u32 v54, v60, v61, v62
  v_max3_u32 v54, v54, v63, v52
  v_max3_u32 v54, v54, v53, v4
  v_cmp_eq_u32 vcc, -1, v54
  s_nop 0
  s_cbranch_vccz bktile2_41
  s_sub_u32 s15, s15, 1
  s_cmp_lg_u32 s15, 0
  s_cbranch_scc1 sptile2_40_l
  s_branch bktile2_41
sps22_42:
  s_mov_b32 s15, 20000
sps22_42_l:
  s_add_u32 s14, s5, 32
  s_lshl_b32 s14, s14, 8
  s_add_u32 s14, s14, s54
  v_add_u32 v9, s14, v29
  global_load_dwordx2 v[46:47], v9, s[42:43] sc1
  s_waitcnt vmcnt(0)
  v_cmp_eq_u32 vcc, 0, v47
  s_nop 0
  s_cbranch_vccz bks22_43
  s_sub_u32 s15, s15, 1
  s_cmp_lg_u32 s15, 0
  s_cbranch_scc1 sps22_42_l
  s_branch bks22_43
sptile3_44:
  s_mov_b32 s15, 20000
sptile3_44_l:
  s_mov_b32 s13, m0
  s_add_u32 s14, s5, 48
  s_mul_i32 s14, s14, 28672
  s_add_u32 s14, s14, s49
  v_add_u32 v9, s14, v27
  s_add_u32 m0, s62, 118784
  s_nop 0
  global_load_lds_dwordx4 v9, s[42:43] offset:0 sc1
  global_load_lds_dwordx4 v9, s[42:43] offset:1024 sc1
  global_load_lds_dwordx4 v9, s[42:43] offset:2048 sc1
  global_load_lds_dwordx4 v9, s[42:43] offset:3072 sc1
  v_add_u32 v9, 4096, v9
  s_add_u32 m0, s62, 122880
  s_nop 0
  global_load_lds_dwordx4 v9, s[42:43] offset:0 sc1
  global_load_lds_dwordx4 v9, s[42:43] offset:1024 sc1
  global_load_lds_dwordx4 v9, s[42:43] offset:2048 sc1
  s_mov_b32 m0, s13
  s_waitcnt vmcnt(0)
  v_add_u32 v9, 57344, v31
  ds_read2st64_b32 v[60:61], v9 offset0:112 offset1:116
  ds_read2st64_b32 v[62:63], v9 offset0:120 offset1:124
  ds_read2st64_b32 v[52:53], v9 offset0:128 offset1:132
  ds_read2st64_b32 v[4:5], v9 offset0:136 offset1:136
  s_waitcnt lgkmcnt(0)
  v_max3_u32 v54, v60, v61, v62
  v_max3_u32 v54, v54, v63, v52
  v_max3_u32 v54, v54, v53, v4
  v_cmp_eq_u32 vcc, -1, v54
  s_nop 0
  s_cbranch_vccz bktile3_45
  s_sub_u32 s15, s15, 1
  s_cmp_lg_u32 s15, 0
  s_cbranch_scc1 sptile3_44_l
  s_branch bktile3_45
sps23_46:
  s_mov_b32 s15, 20000
sps23_46_l:
  s_add_u32 s14, s5, 48
  s_lshl_b32 s14, s14, 8
  s_add_u32 s14, s14, s54
  v_add_u32 v9, s14, v29
  global_load_dwordx2 v[48:49], v9, s[42:43] sc1
  s_waitcnt vmcnt(0)
  v_cmp_eq_u32 vcc, 0, v49
  s_nop 0
  s_cbranch_vccz bks23_47
  s_sub_u32 s15, s15, 1
  s_cmp_lg_u32 s15, 0
  s_cbranch_scc1 sps23_46_l
  s_branch bks23_47
spha0_48:
  s_mov_b32 s15, 20000
spha0_48_l:
  s_add_u32 s14, s60, 4096
  v_add_u32 v9, s14, v38
  global_load_dwordx4 a[88:91], v9, s[42:43] offset:-4096 sc1
  global_load_dwordx4 a[92:95], v9, s[42:43] offset:-3072 sc1
  global_load_dwordx4 a[96:99], v9, s[42:43] offset:-2048 sc1
  global_load_dwordx4 a[100:103], v9, s[42:43] offset:-1024 sc1
  global_load_dwordx4 a[104:107], v9, s[42:43] offset:0 sc1
  global_load_dwordx4 a[108:111], v9, s[42:43] offset:1024 sc1
  global_load_dwordx4 a[112:115], v9, s[42:43] offset:2048 sc1
  global_load_dwordx4 a[116:119], v9, s[42:43] offset:3072 sc1
  v_add_u32 v9, 8192, v9
  global_load_dwordx4 a[120:123], v9, s[42:43] offset:-4096 sc1
  global_load_dwordx4 a[124:127], v9, s[42:43] offset:-3072 sc1
  global_load_dwordx4 a[128:131], v9, s[42:43] offset:-2048 sc1
  global_load_dwordx4 a[132:135], v9, s[42:43] offset:-1024 sc1
  global_load_dwordx4 a[136:139], v9, s[42:43] offset:0 sc1
  global_load_dwordx4 a[140:143], v9, s[42:43] offset:1024 sc1
  global_load_dwordx4 a[144:147], v9, s[42:43] offset:2048 sc1
  global_load_dwordx4 a[148:151], v9, s[42:43] offset:3072 sc1
  v_add_u32 v9, 8192, v9
  global_load_dwordx4 a[152:155], v9, s[42:43] offset:-4096 sc1
  global_load_dwordx4 a[156:159], v9, s[42:43] offset:-3072 sc1
  global_load_dwordx4 a[160:163], v9, s[42:43] offset:-2048 sc1
  global_load_dwordx4 a[164:167], v9, s[42:43] offset:-1024 sc1
  global_load_dwordx4 a[168:171], v9, s[42:43] offset:0 sc1
  global_load_dwordx4 a[172:175], v9, s[42:43] offset:1024 sc1
  global_load_dwordx4 a[176:179], v9, s[42:43] offset:2048 sc1
  global_load_dwordx4 a[180:183], v9, s[42:43] offset:3072 sc1
  v_add_u32 v9, 8192, v9
  global_load_dwordx4 a[184:187], v9, s[42:43] offset:-4096 sc1
  global_load_dwordx4 a[188:191], v9, s[42:43] offset:-3072 sc1
  global_load_dwordx4 a[192:195], v9, s[42:43] offset:-2048 sc1
  global_load_dwordx4 a[196:199], v9, s[42:43] offset:-1024 sc1
  s_waitcnt vmcnt(0)
  v_accvgpr_read_b32 v52, a88
  v_accvgpr_read_b32 v53, a92
  v_accvgpr_read_b32 v54, a96
  v_max3_u32 v52, v52, v53, v54
  v_accvgpr_read_b32 v53, a100
  v_accvgpr_read_b32 v54, a104
  v_max3_u32 v52, v52, v53, v54
  v_accvgpr_read_b32 v53, a108
  v_accvgpr_read_b32 v54, a112
  v_max3_u32 v52, v52, v53, v54
  v_accvgpr_read_b32 v53, a116
  v_accvgpr_read_b32 v54, a120
  v_max3_u32 v52, v52, v53, v54
  v_accvgpr_read_b32 v53, a124
  v_accvgpr_read_b32 v54, a128
  v_max3_u32 v52, v52, v53, v54
  v_accvgpr_read_b32 v53, a132
  v_accvgpr_read_b32 v54, a136
  v_max3_u32 v52, v52, v53, v54
  v_accvgpr_read_b32 v53, a140
  v_accvgpr_read_b32 v54, a144
  v_max3_u32 v52, v52, v53, v54
  v_accvgpr_read_b32 v53, a148
  v_accvgpr_read_b32 v54, a152
  v_max3_u32 v52, v52, v53, v54
  v_accvgpr_read_b32 v53, a156
  v_accvgpr_read_b32 v54, a160
  v_max3_u32 v52, v52, v53, v54
  v_accvgpr_read_b32 v53, a164
  v_accvgpr_read_b32 v54, a168
  v_max3_u32 v52, v52, v53, v54
  v_accvgpr_read_b32 v53, a172
  v_accvgpr_read_b32 v54, a176
  v_max3_u32 v52, v52, v53, v54
  v_accvgpr_read_b32 v53, a180
  v_accvgpr_read_b32 v54, a184
  v_max3_u32 v52, v52, v53, v54
  v_accvgpr_read_b32 v53, a188
  v_accvgpr_read_b32 v54, a192
  v_max3_u32 v52, v52, v53, v54
  v_accvgpr_read_b32 v53, a196
  v_accvgpr_read_b32 v54, a196
  v_max3_u32 v52, v52, v53, v54
  v_cmp_eq_u32 vcc, -1, v52
  s_nop 0
  s_cbranch_vccz bkha0_49
  s_sub_u32 s15, s15, 1
  s_cmp_lg_u32 s15, 0
  s_cbranch_scc1 spha0_48_l
  s_branch bkha0_49
spha1_50:
  s_mov_b32 s15, 20000
spha1_50_l:
  s_add_u32 s14, s60, 4096
  v_add_u32 v9, s14, v38
  global_load_dwordx4 a[104:107], v9, s[42:43] offset:0 sc1
  global_load_dwordx4 a[108:111], v9, s[42:43] offset:1024 sc1
  global_load_dwordx4 a[112:115], v9, s[42:43] offset:2048 sc1
  global_load_dwordx4 a[116:119], v9, s[42:43] offset:3072 sc1
  v_add_u32 v9, 8192, v9
  global_load_dwordx4 a[120:123], v9, s[42:43] offset:-4096 sc1
  global_load_dwordx4 a[124:127], v9, s[42:43] offset:-3072 sc1
  global_load_dwordx4 a[128:131], v9, s[42:43] offset:-2048 sc1
  global_load_dwordx4 a[132:135], v9, s[42:43] offset:-1024 sc1
  global_load_dwordx4 a[136:139], v9, s[42:43] offset:0 sc1
  global_load_dwordx4 a[140:143], v9, s[42:43] offset:1024 sc1
  global_load_dwordx4 a[144:147], v9, s[42:43] offset:2048 sc1
  global_load_dwordx4 a[148:151], v9, s[42:43] offset:3072 sc1
  v_add_u32 v9, 8192, v9
  global_load_dwordx4 a[152:155], v9, s[42:43] offset:-4096 sc1
  global_load_dwordx4 a[156:159], v9, s[42:43] offset:-3072 sc1
  global_load_dwordx4 a[160:163], v9, s[42:43] offset:-2048 sc1
  global_load_dwordx4 a[164:167], v9, s[42:43] offset:-1024 sc1
  global_load_dwordx4 a[168:171], v9, s[42:43] offset:0 sc1
  global_load_dwordx4 a[172:175], v9, s[42:43] offset:1024 sc1
  global_load_dwordx4 a[176:179], v9, s[42:43] offset:2048 sc1
  global_load_dwordx4 a[180:183], v9, s[42:43] offset:3072 sc1
  v_add_u32 v9, 8192, v9
  global_load_dwordx4 a[184:187], v9, s[42:43] offset:-4096 sc1
  global_load_dwordx4 a[188:191], v9, s[42:43] offset:-3072 sc1
  global_load_dwordx4 a[192:195], v9, s[42:43] offset:-2048 sc1
  global_load_dwordx4 a[196:199], v9, s[42:43] offset:-1024 sc1
  s_waitcnt vmcnt(0)
  v_accvgpr_read_b32 v52, a104
  v_accvgpr_read_b32 v53, a108
  v_accvgpr_read_b32 v54, a112
  v_max3_u32 v52, v52, v53, v54
  v_accvgpr_read_b32 v53, a116
  v_accvgpr_read_b32 v54, a120
  v_max3_u32 v52, v52, v53, v54
  v_accvgpr_read_b32 v53, a124
  v_accvgpr_read_b32 v54, a128
  v_max3_u32 v52, v52, v53, v54
  v_accvgpr_read_b32 v53, a132
  v_accvgpr_read_b32 v54, a136
  v_max3_u32 v52, v52, v53, v54
  v_accvgpr_read_b32 v53, a140
  v_accvgpr_read_b32 v54, a144
  v_max3_u32 v52, v52, v53, v54
  v_accvgpr_read_b32 v53, a148
  v_accvgpr_read_b32 v54, a152
  v_max3_u32 v52, v52, v53, v54
  v_accvgpr_read_b32 v53, a156
  v_accvgpr_read_b32 v54, a160
  v_max3_u32 v52, v52, v53, v54
  v_accvgpr_read_b32 v53, a164
  v_accvgpr_read_b32 v54, a168
  v_max3_u32 v52, v52, v53, v54
  v_accvgpr_read_b32 v53, a172
  v_accvgpr_read_b32 v54, a176
  v_max3_u32 v52, v52, v53, v54
  v_accvgpr_read_b32 v53, a180
  v_accvgpr_read_b32 v54, a184
  v_max3_u32 v52, v52, v53, v54
  v_accvgpr_read_b32 v53, a188
  v_accvgpr_read_b32 v54, a192
  v_max3_u32 v52, v52, v53, v54
  v_accvgpr_read_b32 v53, a196
  v_accvgpr_read_b32 v54, a196
  v_max3_u32 v52, v52, v53, v54
  v_cmp_eq_u32 vcc, -1, v52
  s_nop 0
  s_cbranch_vccz bkha1_51
  s_sub_u32 s15, s15, 1
  s_cmp_lg_u32 s15, 0
  s_cbranch_scc1 spha1_50_l
  s_branch bkha1_51
spha2_52:
  s_mov_b32 s15, 20000
spha2_52_l:
  s_add_u32 s14, s60, 12288
  v_add_u32 v9, s14, v38
  global_load_dwordx4 a[120:123], v9, s[42:43] offset:-4096 sc1
  global_load_dwordx4 a[124:127], v9, s[42:43] offset:-3072 sc1
  global_load_dwordx4 a[128:131], v9, s[42:43] offset:-2048 sc1
  global_load_dwordx4 a[132:135], v9, s[42:43] offset:-1024 sc1
  global_load_dwordx4 a[136:139], v9, s[42:43] offset:0 sc1
  global_load_dwordx4 a[140:143], v9, s[42:43] offset:1024 sc1
  global_load_dwordx4 a[144:147], v9, s[42:43] offset:2048 sc1
  global_load_dwordx4 a[148:151], v9, s[42:43] offset:3072 sc1
  v_add_u32 v9, 8192, v9
  global_load_dwordx4 a[152:155], v9, s[42:43] offset:-4096 sc1
  global_load_dwordx4 a[156:159], v9, s[42:43] offset:-3072 sc1
  global_load_dwordx4 a[160:163], v9, s[42:43] offset:-2048 sc1
  global_load_dwordx4 a[164:167], v9, s[42:43] offset:-1024 sc1
  global_load_dwordx4 a[168:171], v9, s[42:43] offset:0 sc1
  global_load_dwordx4 a[172:175], v9, s[42:43] offset:1024 sc1
  global_load_dwordx4 a[176:179], v9, s[42:43] offset:2048 sc1
  global_load_dwordx4 a[180:183], v9, s[42:43] offset:3072 sc1
  v_add_u32 v9, 8192, v9
  global_load_dwordx4 a[184:187], v9, s[42:43] offset:-4096 sc1
  global_load_dwordx4 a[188:191], v9, s[42:43] offset:-3072 sc1
  global_load_dwordx4 a[192:195], v9, s[42:43] offset:-2048 sc1
  global_load_dwordx4 a[196:199], v9, s[42:43] offset:-1024 sc1
  s_waitcnt vmcnt(0)
  v_accvgpr_read_b32 v52, a120
  v_accvgpr_read_b32 v53, a124
  v_accvgpr_read_b32 v54, a128
  v_max3_u32 v52, v52, v53, v54
  v_accvgpr_read_b32 v53, a132
  v_accvgpr_read_b32 v54, a136
  v_max3_u32 v52, v52, v53, v54
  v_accvgpr_read_b32 v53, a140
  v_accvgpr_read_b32 v54, a144
  v_max3_u32 v52, v52, v53, v54
  v_accvgpr_read_b32 v53, a148
  v_accvgpr_read_b32 v54, a152
  v_max3_u32 v52, v52, v53, v54
  v_accvgpr_read_b32 v53, a156
  v_accvgpr_read_b32 v54, a160
  v_max3_u32 v52, v52, v53, v54
  v_accvgpr_read_b32 v53, a164
  v_accvgpr_read_b32 v54, a168
  v_max3_u32 v52, v52, v53, v54
  v_accvgpr_read_b32 v53, a172
  v_accvgpr_read_b32 v54, a176
  v_max3_u32 v52, v52, v53, v54
  v_accvgpr_read_b32 v53, a180
  v_accvgpr_read_b32 v54, a184
  v_max3_u32 v52, v52, v53, v54
  v_accvgpr_read_b32 v53, a188
  v_accvgpr_read_b32 v54, a192
  v_max3_u32 v52, v52, v53, v54
  v_accvgpr_read_b32 v53, a196
  v_accvgpr_read_b32 v54, a196
  v_max3_u32 v52, v52, v53, v54
  v_cmp_eq_u32 vcc, -1, v52
  s_nop 0
  s_cbranch_vccz bkha2_53
  s_sub_u32 s15, s15, 1
  s_cmp_lg_u32 s15, 0
  s_cbranch_scc1 spha2_52_l
  s_branch bkha2_53
spha3_54:
  s_mov_b32 s15, 20000
spha3_54_l:
  s_add_u32 s14, s60, 12288
  v_add_u32 v9, s14, v38
  global_load_dwordx4 a[136:139], v9, s[42:43] offset:0 sc1
  global_load_dwordx4 a[140:143], v9, s[42:43] offset:1024 sc1
  global_load_dwordx4 a[144:147], v9, s[42:43] offset:2048 sc1
  global_load_dwordx4 a[148:151], v9, s[42:43] offset:3072 sc1
  v_add_u32 v9, 8192, v9
  global_load_dwordx4 a[152:155], v9, s[42:43] offset:-4096 sc1
  global_load_dwordx4 a[156:159], v9, s[42:43] offset:-3072 sc1
  global_load_dwordx4 a[160:163], v9, s[42:43] offset:-2048 sc1
  global_load_dwordx4 a[164:167], v9, s[42:43] offset:-1024 sc1
  global_load_dwordx4 a[168:171], v9, s[42:43] offset:0 sc1
  global_load_dwordx4 a[172:175], v9, s[42:43] offset:1024 sc1
  global_load_dwordx4 a[176:179], v9, s[42:43] offset:2048 sc1
  global_load_dwordx4 a[180:183], v9, s[42:43] offset:3072 sc1
  v_add_u32 v9, 8192, v9
  global_load_dwordx4 a[184:187], v9, s[42:43] offset:-4096 sc1
  global_load_dwordx4 a[188:191], v9, s[42:43] offset:-3072 sc1
  global_load_dwordx4 a[192:195], v9, s[42:43] offset:-2048 sc1
  global_load_dwordx4 a[196:199], v9, s[42:43] offset:-1024 sc1
  s_waitcnt vmcnt(0)
  v_accvgpr_read_b32 v52, a136
  v_accvgpr_read_b32 v53, a140
  v_accvgpr_read_b32 v54, a144
  v_max3_u32 v52, v52, v53, v54
  v_accvgpr_read_b32 v53, a148
  v_accvgpr_read_b32 v54, a152
  v_max3_u32 v52, v52, v53, v54
  v_accvgpr_read_b32 v53, a156
  v_accvgpr_read_b32 v54, a160
  v_max3_u32 v52, v52, v53, v54
  v_accvgpr_read_b32 v53, a164
  v_accvgpr_read_b32 v54, a168
  v_max3_u32 v52, v52, v53, v54
  v_accvgpr_read_b32 v53, a172
  v_accvgpr_read_b32 v54, a176
  v_max3_u32 v52, v52, v53, v54
  v_accvgpr_read_b32 v53, a180
  v_accvgpr_read_b32 v54, a184
  v_max3_u32 v52, v52, v53, v54
  v_accvgpr_read_b32 v53, a188
  v_accvgpr_read_b32 v54, a192
  v_max3_u32 v52, v52, v53, v54
  v_accvgpr_read_b32 v53, a196
  v_accvgpr_read_b32 v54, a196
  v_max3_u32 v52, v52, v53, v54
  v_cmp_eq_u32 vcc, -1, v52
  s_nop 0
  s_cbranch_vccz bkha3_55
  s_sub_u32 s15, s15, 1
  s_cmp_lg_u32 s15, 0
  s_cbranch_scc1 spha3_54_l
  s_branch bkha3_55
spha4_56:
  s_mov_b32 s15, 20000
spha4_56_l:
  s_add_u32 s14, s60, 20480
  v_add_u32 v9, s14, v38
  global_load_dwordx4 a[152:155], v9, s[42:43] offset:-4096 sc1
  global_load_dwordx4 a[156:159], v9, s[42:43] offset:-3072 sc1
  global_load_dwordx4 a[160:163], v9, s[42:43] offset:-2048 sc1
  global_load_dwordx4 a[164:167], v9, s[42:43] offset:-1024 sc1
  global_load_dwordx4 a[168:171], v9, s[42:43] offset:0 sc1
  global_load_dwordx4 a[172:175], v9, s[42:43] offset:1024 sc1
  global_load_dwordx4 a[176:179], v9, s[42:43] offset:2048 sc1
  global_load_dwordx4 a[180:183], v9, s[42:43] offset:3072 sc1
  v_add_u32 v9, 8192, v9
  global_load_dwordx4 a[184:187], v9, s[42:43] offset:-4096 sc1
  global_load_dwordx4 a[188:191], v9, s[42:43] offset:-3072 sc1
  global_load_dwordx4 a[192:195], v9, s[42:43] offset:-2048 sc1
  global_load_dwordx4 a[196:199], v9, s[42:43] offset:-1024 sc1
  s_waitcnt vmcnt(0)
  v_accvgpr_read_b32 v52, a152
  v_accvgpr_read_b32 v53, a156
  v_accvgpr_read_b32 v54, a160
  v_max3_u32 v52, v52, v53, v54
  v_accvgpr_read_b32 v53, a164
  v_accvgpr_read_b32 v54, a168
  v_max3_u32 v52, v52, v53, v54
  v_accvgpr_read_b32 v53, a172
  v_accvgpr_read_b32 v54, a176
  v_max3_u32 v52, v52, v53, v54
  v_accvgpr_read_b32 v53, a180
  v_accvgpr_read_b32 v54, a184
  v_max3_u32 v52, v52, v53, v54
  v_accvgpr_read_b32 v53, a188
  v_accvgpr_read_b32 v54, a192
  v_max3_u32 v52, v52, v53, v54
  v_accvgpr_read_b32 v53, a196
  v_accvgpr_read_b32 v54, a196
  v_max3_u32 v52, v52, v53, v54
  v_cmp_eq_u32 vcc, -1, v52
  s_nop 0
  s_cbranch_vccz bkha4_57
  s_sub_u32 s15, s15, 1
  s_cmp_lg_u32 s15, 0
  s_cbranch_scc1 spha4_56_l
  s_branch bkha4_57
spha5_58:
  s_mov_b32 s15, 20000
spha5_58_l:
  s_add_u32 s14, s60, 20480
  v_add_u32 v9, s14, v38
  global_load_dwordx4 a[168:171], v9, s[42:43] offset:0 sc1
  global_load_dwordx4 a[172:175], v9, s[42:43] offset:1024 sc1
  global_load_dwordx4 a[176:179], v9, s[42:43] offset:2048 sc1
  global_load_dwordx4 a[180:183], v9, s[42:43] offset:3072 sc1
  v_add_u32 v9, 8192, v9
  global_load_dwordx4 a[184:187], v9, s[42:43] offset:-4096 sc1
  global_load_dwordx4 a[188:191], v9, s[42:43] offset:-3072 sc1
  global_load_dwordx4 a[192:195], v9, s[42:43] offset:-2048 sc1
  global_load_dwordx4 a[196:199], v9, s[42:43] offset:-1024 sc1
  s_waitcnt vmcnt(0)
  v_accvgpr_read_b32 v52, a168
  v_accvgpr_read_b32 v53, a172
  v_accvgpr_read_b32 v54, a176
  v_max3_u32 v52, v52, v53, v54
  v_accvgpr_read_b32 v53, a180
  v_accvgpr_read_b32 v54, a184
  v_max3_u32 v52, v52, v53, v54
  v_accvgpr_read_b32 v53, a188
  v_accvgpr_read_b32 v54, a192
  v_max3_u32 v52, v52, v53, v54
  v_accvgpr_read_b32 v53, a196
  v_accvgpr_read_b32 v54, a196
  v_max3_u32 v52, v52, v53, v54
  v_cmp_eq_u32 vcc, -1, v52
  s_nop 0
  s_cbranch_vccz bkha5_59
  s_sub_u32 s15, s15, 1
  s_cmp_lg_u32 s15, 0
  s_cbranch_scc1 spha5_58_l
  s_branch bkha5_59
spha6_60:
  s_mov_b32 s15, 20000
spha6_60_l:
  s_add_u32 s14, s60, 28672
  v_add_u32 v9, s14, v38
  global_load_dwordx4 a[184:187], v9, s[42:43] offset:-4096 sc1
  global_load_dwordx4 a[188:191], v9, s[42:43] offset:-3072 sc1
  global_load_dwordx4 a[192:195], v9, s[42:43] offset:-2048 sc1
  global_load_dwordx4 a[196:199], v9, s[42:43] offset:-1024 sc1
  s_waitcnt vmcnt(0)
  v_accvgpr_read_b32 v52, a184
  v_accvgpr_read_b32 v53, a188
  v_accvgpr_read_b32 v54, a192
  v_max3_u32 v52, v52, v53, v54
  v_accvgpr_read_b32 v53, a196
  v_accvgpr_read_b32 v54, a196
  v_max3_u32 v52, v52, v53, v54
  v_cmp_eq_u32 vcc, -1, v52
  s_nop 0
  s_cbranch_vccz bkha6_61
  s_sub_u32 s15, s15, 1
  s_cmp_lg_u32 s15, 0
  s_cbranch_scc1 spha6_60_l
  s_branch bkha6_61
sphb0_63:
  s_mov_b32 s15, 20000
sphb0_63_l:
  s_add_u32 s14, s61, 4096
  v_add_u32 v9, s14, v38
  global_load_dwordx4 a[88:91], v9, s[42:43] offset:-4096 sc1
  global_load_dwordx4 a[92:95], v9, s[42:43] offset:-3072 sc1
  global_load_dwordx4 a[96:99], v9, s[42:43] offset:-2048 sc1
  global_load_dwordx4 a[100:103], v9, s[42:43] offset:-1024 sc1
  global_load_dwordx4 a[104:107], v9, s[42:43] offset:0 sc1
  global_load_dwordx4 a[108:111], v9, s[42:43] offset:1024 sc1
  global_load_dwordx4 a[112:115], v9, s[42:43] offset:2048 sc1
  global_load_dwordx4 a[116:119], v9, s[42:43] offset:3072 sc1
  v_add_u32 v9, 8192, v9
  global_load_dwordx4 a[120:123], v9, s[42:43] offset:-4096 sc1
  global_load_dwordx4 a[124:127], v9, s[42:43] offset:-3072 sc1
  global_load_dwordx4 a[128:131], v9, s[42:43] offset:-2048 sc1
  global_load_dwordx4 a[132:135], v9, s[42:43] offset:-1024 sc1
  global_load_dwordx4 a[136:139], v9, s[42:43] offset:0 sc1
  global_load_dwordx4 a[140:143], v9, s[42:43] offset:1024 sc1
  global_load_dwordx4 a[144:147], v9, s[42:43] offset:2048 sc1
  global_load_dwordx4 a[148:151], v9, s[42:43] offset:3072 sc1
  v_add_u32 v9, 8192, v9
  global_load_dwordx4 a[152:155], v9, s[42:43] offset:-4096 sc1
  global_load_dwordx4 a[156:159], v9, s[42:43] offset:-3072 sc1
  global_load_dwordx4 a[160:163], v9, s[42:43] offset:-2048 sc1
  global_load_dwordx4 a[164:167], v9, s[42:43] offset:-1024 sc1
  global_load_dwordx4 a[168:171], v9, s[42:43] offset:0 sc1
  global_load_dwordx4 a[172:175], v9, s[42:43] offset:1024 sc1
  global_load_dwordx4 a[176:179], v9, s[42:43] offset:2048 sc1
  global_load_dwordx4 a[180:183], v9, s[42:43] offset:3072 sc1
  v_add_u32 v9, 8192, v9
  global_load_dwordx4 a[184:187], v9, s[42:43] offset:-4096 sc1
  global_load_dwordx4 a[188:191], v9, s[42:43] offset:-3072 sc1
  global_load_dwordx4 a[192:195], v9, s[42:43] offset:-2048 sc1
  global_load_dwordx4 a[196:199], v9, s[42:43] offset:-1024 sc1
  s_waitcnt vmcnt(0)
  v_accvgpr_read_b32 v52, a88
  v_accvgpr_read_b32 v53, a92
  v_accvgpr_read_b32 v54, a96
  v_max3_u32 v52, v52, v53, v54
  v_accvgpr_read_b32 v53, a100
  v_accvgpr_read_b32 v54, a104
  v_max3_u32 v52, v52, v53, v54
  v_accvgpr_read_b32 v53, a108
  v_accvgpr_read_b32 v54, a112
  v_max3_u32 v52, v52, v53, v54
  v_accvgpr_read_b32 v53, a116
  v_accvgpr_read_b32 v54, a120
  v_max3_u32 v52, v52, v53, v54
  v_accvgpr_read_b32 v53, a124
  v_accvgpr_read_b32 v54, a128
  v_max3_u32 v52, v52, v53, v54
  v_accvgpr_read_b32 v53, a132
  v_accvgpr_read_b32 v54, a136
  v_max3_u32 v52, v52, v53, v54
  v_accvgpr_read_b32 v53, a140
  v_accvgpr_read_b32 v54, a144
  v_max3_u32 v52, v52, v53, v54
  v_accvgpr_read_b32 v53, a148
  v_accvgpr_read_b32 v54, a152
  v_max3_u32 v52, v52, v53, v54
  v_accvgpr_read_b32 v53, a156
  v_accvgpr_read_b32 v54, a160
  v_max3_u32 v52, v52, v53, v54
  v_accvgpr_read_b32 v53, a164
  v_accvgpr_read_b32 v54, a168
  v_max3_u32 v52, v52, v53, v54
  v_accvgpr_read_b32 v53, a172
  v_accvgpr_read_b32 v54, a176
  v_max3_u32 v52, v52, v53, v54
  v_accvgpr_read_b32 v53, a180
  v_accvgpr_read_b32 v54, a184
  v_max3_u32 v52, v52, v53, v54
  v_accvgpr_read_b32 v53, a188
  v_accvgpr_read_b32 v54, a192
  v_max3_u32 v52, v52, v53, v54
  v_accvgpr_read_b32 v53, a196
  v_accvgpr_read_b32 v54, a196
  v_max3_u32 v52, v52, v53, v54
  v_cmp_eq_u32 vcc, -1, v52
  s_nop 0
  s_cbranch_vccz bkhb0_64
  s_sub_u32 s15, s15, 1
  s_cmp_lg_u32 s15, 0
  s_cbranch_scc1 sphb0_63_l
  s_branch bkhb0_64
sphb1_65:
  s_mov_b32 s15, 20000
sphb1_65_l:
  s_add_u32 s14, s61, 4096
  v_add_u32 v9, s14, v38
  global_load_dwordx4 a[104:107], v9, s[42:43] offset:0 sc1
  global_load_dwordx4 a[108:111], v9, s[42:43] offset:1024 sc1
  global_load_dwordx4 a[112:115], v9, s[42:43] offset:2048 sc1
  global_load_dwordx4 a[116:119], v9, s[42:43] offset:3072 sc1
  v_add_u32 v9, 8192, v9
  global_load_dwordx4 a[120:123], v9, s[42:43] offset:-4096 sc1
  global_load_dwordx4 a[124:127], v9, s[42:43] offset:-3072 sc1
  global_load_dwordx4 a[128:131], v9, s[42:43] offset:-2048 sc1
  global_load_dwordx4 a[132:135], v9, s[42:43] offset:-1024 sc1
  global_load_dwordx4 a[136:139], v9, s[42:43] offset:0 sc1
  global_load_dwordx4 a[140:143], v9, s[42:43] offset:1024 sc1
  global_load_dwordx4 a[144:147], v9, s[42:43] offset:2048 sc1
  global_load_dwordx4 a[148:151], v9, s[42:43] offset:3072 sc1
  v_add_u32 v9, 8192, v9
  global_load_dwordx4 a[152:155], v9, s[42:43] offset:-4096 sc1
  global_load_dwordx4 a[156:159], v9, s[42:43] offset:-3072 sc1
  global_load_dwordx4 a[160:163], v9, s[42:43] offset:-2048 sc1
  global_load_dwordx4 a[164:167], v9, s[42:43] offset:-1024 sc1
  global_load_dwordx4 a[168:171], v9, s[42:43] offset:0 sc1
  global_load_dwordx4 a[172:175], v9, s[42:43] offset:1024 sc1
  global_load_dwordx4 a[176:179], v9, s[42:43] offset:2048 sc1
  global_load_dwordx4 a[180:183], v9, s[42:43] offset:3072 sc1
  v_add_u32 v9, 8192, v9
  global_load_dwordx4 a[184:187], v9, s[42:43] offset:-4096 sc1
  global_load_dwordx4 a[188:191], v9, s[42:43] offset:-3072 sc1
  global_load_dwordx4 a[192:195], v9, s[42:43] offset:-2048 sc1
  global_load_dwordx4 a[196:199], v9, s[42:43] offset:-1024 sc1
  s_waitcnt vmcnt(0)
  v_accvgpr_read_b32 v52, a104
  v_accvgpr_read_b32 v53, a108
  v_accvgpr_read_b32 v54, a112
  v_max3_u32 v52, v52, v53, v54
  v_accvgpr_read_b32 v53, a116
  v_accvgpr_read_b32 v54, a120
  v_max3_u32 v52, v52, v53, v54
  v_accvgpr_read_b32 v53, a124
  v_accvgpr_read_b32 v54, a128
  v_max3_u32 v52, v52, v53, v54
  v_accvgpr_read_b32 v53, a132
  v_accvgpr_read_b32 v54, a136
  v_max3_u32 v52, v52, v53, v54
  v_accvgpr_read_b32 v53, a140
  v_accvgpr_read_b32 v54, a144
  v_max3_u32 v52, v52, v53, v54
  v_accvgpr_read_b32 v53, a148
  v_accvgpr_read_b32 v54, a152
  v_max3_u32 v52, v52, v53, v54
  v_accvgpr_read_b32 v53, a156
  v_accvgpr_read_b32 v54, a160
  v_max3_u32 v52, v52, v53, v54
  v_accvgpr_read_b32 v53, a164
  v_accvgpr_read_b32 v54, a168
  v_max3_u32 v52, v52, v53, v54
  v_accvgpr_read_b32 v53, a172
  v_accvgpr_read_b32 v54, a176
  v_max3_u32 v52, v52, v53, v54
  v_accvgpr_read_b32 v53, a180
  v_accvgpr_read_b32 v54, a184
  v_max3_u32 v52, v52, v53, v54
  v_accvgpr_read_b32 v53, a188
  v_accvgpr_read_b32 v54, a192
  v_max3_u32 v52, v52, v53, v54
  v_accvgpr_read_b32 v53, a196
  v_accvgpr_read_b32 v54, a196
  v_max3_u32 v52, v52, v53, v54
  v_cmp_eq_u32 vcc, -1, v52
  s_nop 0
  s_cbranch_vccz bkhb1_66
  s_sub_u32 s15, s15, 1
  s_cmp_lg_u32 s15, 0
  s_cbranch_scc1 sphb1_65_l
  s_branch bkhb1_66
sphb2_67:
  s_mov_b32 s15, 20000
sphb2_67_l:
  s_add_u32 s14, s61, 12288
  v_add_u32 v9, s14, v38
  global_load_dwordx4 a[120:123], v9, s[42:43] offset:-4096 sc1
  global_load_dwordx4 a[124:127], v9, s[42:43] offset:-3072 sc1
  global_load_dwordx4 a[128:131], v9, s[42:43] offset:-2048 sc1
  global_load_dwordx4 a[132:135], v9, s[42:43] offset:-1024 sc1
  global_load_dwordx4 a[136:139], v9, s[42:43] offset:0 sc1
  global_load_dwordx4 a[140:143], v9, s[42:43] offset:1024 sc1
  global_load_dwordx4 a[144:147], v9, s[42:43] offset:2048 sc1
  global_load_dwordx4 a[148:151], v9, s[42:43] offset:3072 sc1
  v_add_u32 v9, 8192, v9
  global_load_dwordx4 a[152:155], v9, s[42:43] offset:-4096 sc1
  global_load_dwordx4 a[156:159], v9, s[42:43] offset:-3072 sc1
  global_load_dwordx4 a[160:163], v9, s[42:43] offset:-2048 sc1
  global_load_dwordx4 a[164:167], v9, s[42:43] offset:-1024 sc1
  global_load_dwordx4 a[168:171], v9, s[42:43] offset:0 sc1
  global_load_dwordx4 a[172:175], v9, s[42:43] offset:1024 sc1
  global_load_dwordx4 a[176:179], v9, s[42:43] offset:2048 sc1
  global_load_dwordx4 a[180:183], v9, s[42:43] offset:3072 sc1
  v_add_u32 v9, 8192, v9
  global_load_dwordx4 a[184:187], v9, s[42:43] offset:-4096 sc1
  global_load_dwordx4 a[188:191], v9, s[42:43] offset:-3072 sc1
  global_load_dwordx4 a[192:195], v9, s[42:43] offset:-2048 sc1
  global_load_dwordx4 a[196:199], v9, s[42:43] offset:-1024 sc1
  s_waitcnt vmcnt(0)
  v_accvgpr_read_b32 v52, a120
  v_accvgpr_read_b32 v53, a124
  v_accvgpr_read_b32 v54, a128
  v_max3_u32 v52, v52, v53, v54
  v_accvgpr_read_b32 v53, a132
  v_accvgpr_read_b32 v54, a136
  v_max3_u32 v52, v52, v53, v54
  v_accvgpr_read_b32 v53, a140
  v_accvgpr_read_b32 v54, a144
  v_max3_u32 v52, v52, v53, v54
  v_accvgpr_read_b32 v53, a148
  v_accvgpr_read_b32 v54, a152
  v_max3_u32 v52, v52, v53, v54
  v_accvgpr_read_b32 v53, a156
  v_accvgpr_read_b32 v54, a160
  v_max3_u32 v52, v52, v53, v54
  v_accvgpr_read_b32 v53, a164
  v_accvgpr_read_b32 v54, a168
  v_max3_u32 v52, v52, v53, v54
  v_accvgpr_read_b32 v53, a172
  v_accvgpr_read_b32 v54, a176
  v_max3_u32 v52, v52, v53, v54
  v_accvgpr_read_b32 v53, a180
  v_accvgpr_read_b32 v54, a184
  v_max3_u32 v52, v52, v53, v54
  v_accvgpr_read_b32 v53, a188
  v_accvgpr_read_b32 v54, a192
  v_max3_u32 v52, v52, v53, v54
  v_accvgpr_read_b32 v53, a196
  v_accvgpr_read_b32 v54, a196
  v_max3_u32 v52, v52, v53, v54
  v_cmp_eq_u32 vcc, -1, v52
  s_nop 0
  s_cbranch_vccz bkhb2_68
  s_sub_u32 s15, s15, 1
  s_cmp_lg_u32 s15, 0
  s_cbranch_scc1 sphb2_67_l
  s_branch bkhb2_68
sphb3_69:
  s_mov_b32 s15, 20000
sphb3_69_l:
  s_add_u32 s14, s61, 12288
  v_add_u32 v9, s14, v38
  global_load_dwordx4 a[136:139], v9, s[42:43] offset:0 sc1
  global_load_dwordx4 a[140:143], v9, s[42:43] offset:1024 sc1
  global_load_dwordx4 a[144:147], v9, s[42:43] offset:2048 sc1
  global_load_dwordx4 a[148:151], v9, s[42:43] offset:3072 sc1
  v_add_u32 v9, 8192, v9
  global_load_dwordx4 a[152:155], v9, s[42:43] offset:-4096 sc1
  global_load_dwordx4 a[156:159], v9, s[42:43] offset:-3072 sc1
  global_load_dwordx4 a[160:163], v9, s[42:43] offset:-2048 sc1
  global_load_dwordx4 a[164:167], v9, s[42:43] offset:-1024 sc1
  global_load_dwordx4 a[168:171], v9, s[42:43] offset:0 sc1
  global_load_dwordx4 a[172:175], v9, s[42:43] offset:1024 sc1
  global_load_dwordx4 a[176:179], v9, s[42:43] offset:2048 sc1
  global_load_dwordx4 a[180:183], v9, s[42:43] offset:3072 sc1
  v_add_u32 v9, 8192, v9
  global_load_dwordx4 a[184:187], v9, s[42:43] offset:-4096 sc1
  global_load_dwordx4 a[188:191], v9, s[42:43] offset:-3072 sc1
  global_load_dwordx4 a[192:195], v9, s[42:43] offset:-2048 sc1
  global_load_dwordx4 a[196:199], v9, s[42:43] offset:-1024 sc1
  s_waitcnt vmcnt(0)
  v_accvgpr_read_b32 v52, a136
  v_accvgpr_read_b32 v53, a140
  v_accvgpr_read_b32 v54, a144
  v_max3_u32 v52, v52, v53, v54
  v_accvgpr_read_b32 v53, a148
  v_accvgpr_read_b32 v54, a152
  v_max3_u32 v52, v52, v53, v54
  v_accvgpr_read_b32 v53, a156
  v_accvgpr_read_b32 v54, a160
  v_max3_u32 v52, v52, v53, v54
  v_accvgpr_read_b32 v53, a164
  v_accvgpr_read_b32 v54, a168
  v_max3_u32 v52, v52, v53, v54
  v_accvgpr_read_b32 v53, a172
  v_accvgpr_read_b32 v54, a176
  v_max3_u32 v52, v52, v53, v54
  v_accvgpr_read_b32 v53, a180
  v_accvgpr_read_b32 v54, a184
  v_max3_u32 v52, v52, v53, v54
  v_accvgpr_read_b32 v53, a188
  v_accvgpr_read_b32 v54, a192
  v_max3_u32 v52, v52, v53, v54
  v_accvgpr_read_b32 v53, a196
  v_accvgpr_read_b32 v54, a196
  v_max3_u32 v52, v52, v53, v54
  v_cmp_eq_u32 vcc, -1, v52
  s_nop 0
  s_cbranch_vccz bkhb3_70
  s_sub_u32 s15, s15, 1
  s_cmp_lg_u32 s15, 0
  s_cbranch_scc1 sphb3_69_l
  s_branch bkhb3_70
sphb4_71:
  s_mov_b32 s15, 20000
sphb4_71_l:
  s_add_u32 s14, s61, 20480
  v_add_u32 v9, s14, v38
  global_load_dwordx4 a[152:155], v9, s[42:43] offset:-4096 sc1
  global_load_dwordx4 a[156:159], v9, s[42:43] offset:-3072 sc1
  global_load_dwordx4 a[160:163], v9, s[42:43] offset:-2048 sc1
  global_load_dwordx4 a[164:167], v9, s[42:43] offset:-1024 sc1
  global_load_dwordx4 a[168:171], v9, s[42:43] offset:0 sc1
  global_load_dwordx4 a[172:175], v9, s[42:43] offset:1024 sc1
  global_load_dwordx4 a[176:179], v9, s[42:43] offset:2048 sc1
  global_load_dwordx4 a[180:183], v9, s[42:43] offset:3072 sc1
  v_add_u32 v9, 8192, v9
  global_load_dwordx4 a[184:187], v9, s[42:43] offset:-4096 sc1
  global_load_dwordx4 a[188:191], v9, s[42:43] offset:-3072 sc1
  global_load_dwordx4 a[192:195], v9, s[42:43] offset:-2048 sc1
  global_load_dwordx4 a[196:199], v9, s[42:43] offset:-1024 sc1
  s_waitcnt vmcnt(0)
  v_accvgpr_read_b32 v52, a152
  v_accvgpr_read_b32 v53, a156
  v_accvgpr_read_b32 v54, a160
  v_max3_u32 v52, v52, v53, v54
  v_accvgpr_read_b32 v53, a164
  v_accvgpr_read_b32 v54, a168
  v_max3_u32 v52, v52, v53, v54
  v_accvgpr_read_b32 v53, a172
  v_accvgpr_read_b32 v54, a176
  v_max3_u32 v52, v52, v53, v54
  v_accvgpr_read_b32 v53, a180
  v_accvgpr_read_b32 v54, a184
  v_max3_u32 v52, v52, v53, v54
  v_accvgpr_read_b32 v53, a188
  v_accvgpr_read_b32 v54, a192
  v_max3_u32 v52, v52, v53, v54
  v_accvgpr_read_b32 v53, a196
  v_accvgpr_read_b32 v54, a196
  v_max3_u32 v52, v52, v53, v54
  v_cmp_eq_u32 vcc, -1, v52
  s_nop 0
  s_cbranch_vccz bkhb4_72
  s_sub_u32 s15, s15, 1
  s_cmp_lg_u32 s15, 0
  s_cbranch_scc1 sphb4_71_l
  s_branch bkhb4_72
sphb5_73:
  s_mov_b32 s15, 20000
sphb5_73_l:
  s_add_u32 s14, s61, 20480
  v_add_u32 v9, s14, v38
  global_load_dwordx4 a[168:171], v9, s[42:43] offset:0 sc1
  global_load_dwordx4 a[172:175], v9, s[42:43] offset:1024 sc1
  global_load_dwordx4 a[176:179], v9, s[42:43] offset:2048 sc1
  global_load_dwordx4 a[180:183], v9, s[42:43] offset:3072 sc1
  v_add_u32 v9, 8192, v9
  global_load_dwordx4 a[184:187], v9, s[42:43] offset:-4096 sc1
  global_load_dwordx4 a[188:191], v9, s[42:43] offset:-3072 sc1
  global_load_dwordx4 a[192:195], v9, s[42:43] offset:-2048 sc1
  global_load_dwordx4 a[196:199], v9, s[42:43] offset:-1024 sc1
  s_waitcnt vmcnt(0)
  v_accvgpr_read_b32 v52, a168
  v_accvgpr_read_b32 v53, a172
  v_accvgpr_read_b32 v54, a176
  v_max3_u32 v52, v52, v53, v54
  v_accvgpr_read_b32 v53, a180
  v_accvgpr_read_b32 v54, a184
  v_max3_u32 v52, v52, v53, v54
  v_accvgpr_read_b32 v53, a188
  v_accvgpr_read_b32 v54, a192
  v_max3_u32 v52, v52, v53, v54
  v_accvgpr_read_b32 v53, a196
  v_accvgpr_read_b32 v54, a196
  v_max3_u32 v52, v52, v53, v54
  v_cmp_eq_u32 vcc, -1, v52
  s_nop 0
  s_cbranch_vccz bkhb5_74
  s_sub_u32 s15, s15, 1
  s_cmp_lg_u32 s15, 0
  s_cbranch_scc1 sphb5_73_l
  s_branch bkhb5_74
sphb6_75:
  s_mov_b32 s15, 20000
sphb6_75_l:
  s_add_u32 s14, s61, 28672
  v_add_u32 v9, s14, v38
  global_load_dwordx4 a[184:187], v9, s[42:43] offset:-4096 sc1
  global_load_dwordx4 a[188:191], v9, s[42:43] offset:-3072 sc1
  global_load_dwordx4 a[192:195], v9, s[42:43] offset:-2048 sc1
  global_load_dwordx4 a[196:199], v9, s[42:43] offset:-1024 sc1
  s_waitcnt vmcnt(0)
  v_accvgpr_read_b32 v52, a184
  v_accvgpr_read_b32 v53, a188
  v_accvgpr_read_b32 v54, a192
  v_max3_u32 v52, v52, v53, v54
  v_accvgpr_read_b32 v53, a196
  v_accvgpr_read_b32 v54, a196
  v_max3_u32 v52, v52, v53, v54
  v_cmp_eq_u32 vcc, -1, v52
  s_nop 0
  s_cbranch_vccz bkhb6_76
  s_sub_u32 s15, s15, 1
  s_cmp_lg_u32 s15, 0
  s_cbranch_scc1 sphb6_75_l
  s_branch bkhb6_76
spxa_78:
  s_mov_b32 s15, 20000
spxa_78_l:
  v_add_u32 v84, 10485760, v10
  v_add_u32 v85, 33554432, v11
  global_load_dwordx2 v[80:81], v84, s[42:43] sc1
  global_load_dwordx2 v[82:83], v84, s[42:43] offset:64 sc1
  global_load_dwordx4 v[64:67], v85, s[42:43] offset:0 sc1
  global_load_dwordx4 v[68:71], v85, s[42:43] offset:1024 sc1
  global_load_dwordx4 v[72:75], v85, s[42:43] offset:2048 sc1
  global_load_dwordx4 v[76:79], v85, s[42:43] offset:3072 sc1
  s_waitcnt vmcnt(0)
  v_max_u32 v84, v80, v82
  v_min3_u32 v85, v64, v67, v68
  v_min3_u32 v85, v85, v71, v72
  v_min3_u32 v85, v85, v75, v76
  v_min_u32 v85, v85, v79
  v_cmp_eq_u32 vcc, -1, v84
  s_nop 1
  v_cndmask_b32 v85, v85, 0, vcc
  v_cmp_ne_u32 vcc, 0x40e00000, v85
  s_nop 0
  s_cbranch_vccz bkxa_79
  s_sub_u32 s15, s15, 1
  s_cmp_lg_u32 s15, 0
  s_cbranch_scc1 spxa_78_l
  s_branch bkxa_79
spxb_80:
  s_mov_b32 s15, 20000
spxb_80_l:
  v_add_u32 v6, 11403264, v10
  v_add_u32 v7, 33570816, v11
  global_load_dwordx2 v[44:45], v6, s[42:43] sc1
  global_load_dwordx2 v[46:47], v6, s[42:43] offset:64 sc1
  global_load_dwordx4 v[48:51], v7, s[42:43] offset:0 sc1
  global_load_dwordx4 v[52:55], v7, s[42:43] offset:1024 sc1
  global_load_dwordx4 v[56:59], v7, s[42:43] offset:2048 sc1
  global_load_dwordx4 v[60:63], v7, s[42:43] offset:3072 sc1
  s_waitcnt vmcnt(0)
  v_max_u32 v84, v44, v46
  v_min3_u32 v85, v48, v51, v52
  v_min3_u32 v85, v85, v55, v56
  v_min3_u32 v85, v85, v59, v60
  v_min_u32 v85, v85, v63
  v_cmp_eq_u32 vcc, -1, v84
  s_nop 1
  v_cndmask_b32 v85, v85, 0, vcc
  v_cmp_ne_u32 vcc, 0x40e00000, v85
  s_nop 0
  s_cbranch_vccz bkxb_81
  s_sub_u32 s15, s15, 1
  s_cmp_lg_u32 s15, 0
  s_cbranch_scc1 spxb_80_l
  s_branch bkxb_81
sptile0_82:
  s_mov_b32 s15, 20000
sptile0_82_l:
  s_mov_b32 s13, m0
  s_add_u32 s14, s5, 0
  s_mul_i32 s14, s14, 28672
  s_add_u32 s14, s14, s49
  v_add_u32 v9, s14, v27
  s_add_u32 m0, s62, 32768
  s_nop 0
  global_load_lds_dwordx4 v9, s[42:43] offset:0 sc1
  global_load_lds_dwordx4 v9, s[42:43] offset:1024 sc1
  global_load_lds_dwordx4 v9, s[42:43] offset:2048 sc1
  global_load_lds_dwordx4 v9, s[42:43] offset:3072 sc1
  v_add_u32 v9, 4096, v9
  s_add_u32 m0, s62, 36864
  s_nop 0
  global_load_lds_dwordx4 v9, s[42:43] offset:0 sc1
  global_load_lds_dwordx4 v9, s[42:43] offset:1024 sc1
  global_load_lds_dwordx4 v9, s[42:43] offset:2048 sc1
  s_mov_b32 m0, s13
  s_waitcnt vmcnt(0)
  ds_read2st64_b32 v[60:61], v31 offset0:0 offset1:4
  ds_read2st64_b32 v[62:63], v31 offset0:8 offset1:12
  ds_read2st64_b32 v[52:53], v31 offset0:16 offset1:20
  ds_read2st64_b32 v[4:5], v31 offset0:24 offset1:24
  s_waitcnt lgkmcnt(0)
  v_max3_u32 v54, v60, v61, v62
  v_max3_u32 v54, v54, v63, v52
  v_max3_u32 v54, v54, v53, v4
  v_cmp_eq_u32 vcc, -1, v54
  s_nop 0
  s_cbranch_vccz bktile0_83
  s_sub_u32 s15, s15, 1
  s_cmp_lg_u32 s15, 0
  s_cbranch_scc1 sptile0_82_l
  s_branch bktile0_83
sps20_84:
  s_mov_b32 s15, 20000
sps20_84_l:
  s_add_u32 s14, s5, 0
  s_lshl_b32 s14, s14, 8
  s_add_u32 s14, s14, s54
  v_add_u32 v9, s14, v29
  global_load_dwordx2 v[46:47], v9, s[42:43] sc1
  s_waitcnt vmcnt(0)
  v_cmp_eq_u32 vcc, 0, v47
  s_nop 0
  s_cbranch_vccz bks20_85
  s_sub_u32 s15, s15, 1
  s_cmp_lg_u32 s15, 0
  s_cbranch_scc1 sps20_84_l
  s_branch bks20_85
sptile1_86:
  s_mov_b32 s15, 20000
sptile1_86_l:
  s_mov_b32 s13, m0
  s_add_u32 s14, s5, 16
  s_mul_i32 s14, s14, 28672
  s_add_u32 s14, s14, s49
  v_add_u32 v9, s14, v27
  s_add_u32 m0, s62, 61440
  s_nop 0
  global_load_lds_dwordx4 v9, s[42:43] offset:0 sc1
  global_load_lds_dwordx4 v9, s[42:43] offset:1024 sc1
  global_load_lds_dwordx4 v9, s[42:43] offset:2048 sc1
  global_load_lds_dwordx4 v9, s[42:43] offset:3072 sc1
  v_add_u32 v9, 4096, v9
  s_add_u32 m0, s62, 65536
  s_nop 0
  global_load_lds_dwordx4 v9, s[42:43] offset:0 sc1
  global_load_lds_dwordx4 v9, s[42:43] offset:1024 sc1
  global_load_lds_dwordx4 v9, s[42:43] offset:2048 sc1
  s_mov_b32 m0, s13
  s_waitcnt vmcnt(0)
  ds_read2st64_b32 v[60:61], v31 offset0:112 offset1:116
  ds_read2st64_b32 v[62:63], v31 offset0:120 offset1:124
  ds_read2st64_b32 v[52:53], v31 offset0:128 offset1:132
  ds_read2st64_b32 v[4:5], v31 offset0:136 offset1:136
  s_waitcnt lgkmcnt(0)
  v_max3_u32 v54, v60, v61, v62
  v_max3_u32 v54, v54, v63, v52
  v_max3_u32 v54, v54, v53, v4
  v_cmp_eq_u32 vcc, -1, v54
  s_nop 0
  s_cbranch_vccz bktile1_87
  s_sub_u32 s15, s15, 1
  s_cmp_lg_u32 s15, 0
  s_cbranch_scc1 sptile1_86_l
  s_branch bktile1_87
sps21_88:
  s_mov_b32 s15, 20000
sps21_88_l:
  s_add_u32 s14, s5, 16
  s_lshl_b32 s14, s14, 8
  s_add_u32 s14, s14, s54
  v_add_u32 v9, s14, v29
  global_load_dwordx2 v[48:49], v9, s[42:43] sc1
  s_waitcnt vmcnt(0)
  v_cmp_eq_u32 vcc, 0, v49
  s_nop 0
  s_cbranch_vccz bks21_89
  s_sub_u32 s15, s15, 1
  s_cmp_lg_u32 s15, 0
  s_cbranch_scc1 sps21_88_l
  s_branch bks21_89
sptile2_90:
  s_mov_b32 s15, 20000
sptile2_90_l:
  s_mov_b32 s13, m0
  s_add_u32 s14, s5, 32
  s_mul_i32 s14, s14, 28672
  s_add_u32 s14, s14, s49
  v_add_u32 v9, s14, v27
  s_add_u32 m0, s62, 90112
  s_nop 0
  global_load_lds_dwordx4 v9, s[42:43] offset:0 sc1
  global_load_lds_dwordx4 v9, s[42:43] offset:1024 sc1
  global_load_lds_dwordx4 v9, s[42:43] offset:2048 sc1
  global_load_lds_dwordx4 v9, s[42:43] offset:3072 sc1
  v_add_u32 v9, 4096, v9
  s_add_u32 m0, s62, 94208
  s_nop 0
  global_load_lds_dwordx4 v9, s[42:43] offset:0 sc1
  global_load_lds_dwordx4 v9, s[42:43] offset:1024 sc1
  global_load_lds_dwordx4 v9, s[42:43] offset:2048 sc1
  s_mov_b32 m0, s13
  s_waitcnt vmcnt(0)
  v_add_u32 v9, 57344, v31
  ds_read2st64_b32 v[60:61], v9 offset0:0 offset1:4
  ds_read2st64_b32 v[62:63], v9 offset0:8 offset1:12
  ds_read2st64_b32 v[52:53], v9 offset0:16 offset1:20
  ds_read2st64_b32 v[4:5], v9 offset0:24 offset1:24
  s_waitcnt lgkmcnt(0)
  v_max3_u32 v54, v60, v61, v62
  v_max3_u32 v54, v54, v63, v52
  v_max3_u32 v54, v54, v53, v4
  v_cmp_eq_u32 vcc, -1, v54
  s_nop 0
  s_cbranch_vccz bktile2_91
  s_sub_u32 s15, s15, 1
  s_cmp_lg_u32 s15, 0
  s_cbranch_scc1 sptile2_90_l
  s_branch bktile2_91
sps22_92:
  s_mov_b32 s15, 20000
sps22_92_l:
  s_add_u32 s14, s5, 32
  s_lshl_b32 s14, s14, 8
  s_add_u32 s14, s14, s54
  v_add_u32 v9, s14, v29
  global_load_dwordx2 v[46:47], v9, s[42:43] sc1
  s_waitcnt vmcnt(0)
  v_cmp_eq_u32 vcc, 0, v47
  s_nop 0
  s_cbranch_vccz bks22_93
  s_sub_u32 s15, s15, 1
  s_cmp_lg_u32 s15, 0
  s_cbranch_scc1 sps22_92_l
  s_branch bks22_93
sptile3_94:
  s_mov_b32 s15, 20000
sptile3_94_l:
  s_mov_b32 s13, m0
  s_add_u32 s14, s5, 48
  s_mul_i32 s14, s14, 28672
  s_add_u32 s14, s14, s49
  v_add_u32 v9, s14, v27
  s_add_u32 m0, s62, 118784
  s_nop 0
  global_load_lds_dwordx4 v9, s[42:43] offset:0 sc1
  global_load_lds_dwordx4 v9, s[42:43] offset:1024 sc1
  global_load_lds_dwordx4 v9, s[42:43] offset:2048 sc1
  global_load_lds_dwordx4 v9, s[42:43] offset:3072 sc1
  v_add_u32 v9, 4096, v9
  s_add_u32 m0, s62, 122880
  s_nop 0
  global_load_lds_dwordx4 v9, s[42:43] offset:0 sc1
  global_load_lds_dwordx4 v9, s[42:43] offset:1024 sc1
  global_load_lds_dwordx4 v9, s[42:43] offset:2048 sc1
  s_mov_b32 m0, s13
  s_waitcnt vmcnt(0)
  v_add_u32 v9, 57344, v31
  ds_read2st64_b32 v[60:61], v9 offset0:112 offset1:116
  ds_read2st64_b32 v[62:63], v9 offset0:120 offset1:124
  ds_read2st64_b32 v[52:53], v9 offset0:128 offset1:132
  ds_read2st64_b32 v[4:5], v9 offset0:136 offset1:136
  s_waitcnt lgkmcnt(0)
  v_max3_u32 v54, v60, v61, v62
  v_max3_u32 v54, v54, v63, v52
  v_max3_u32 v54, v54, v53, v4
  v_cmp_eq_u32 vcc, -1, v54
  s_nop 0
  s_cbranch_vccz bktile3_95
  s_sub_u32 s15, s15, 1
  s_cmp_lg_u32 s15, 0
  s_cbranch_scc1 sptile3_94_l
  s_branch bktile3_95
sps23_96:
  s_mov_b32 s15, 20000
sps23_96_l:
  s_add_u32 s14, s5, 48
  s_lshl_b32 s14, s14, 8
  s_add_u32 s14, s14, s54
  v_add_u32 v9, s14, v29
  global_load_dwordx2 v[48:49], v9, s[42:43] sc1
  s_waitcnt vmcnt(0)
  v_cmp_eq_u32 vcc, 0, v49
  s_nop 0
  s_cbranch_vccz bks23_97
  s_sub_u32 s15, s15, 1
  s_cmp_lg_u32 s15, 0
  s_cbranch_scc1 sps23_96_l
  s_branch bks23_97
spha0_98:
  s_mov_b32 s15, 20000
spha0_98_l:
  s_add_u32 s14, s60, 4096
  v_add_u32 v9, s14, v38
  global_load_dwordx4 a[88:91], v9, s[42:43] offset:-4096 sc1
  global_load_dwordx4 a[92:95], v9, s[42:43] offset:-3072 sc1
  global_load_dwordx4 a[96:99], v9, s[42:43] offset:-2048 sc1
  global_load_dwordx4 a[100:103], v9, s[42:43] offset:-1024 sc1
  global_load_dwordx4 a[104:107], v9, s[42:43] offset:0 sc1
  global_load_dwordx4 a[108:111], v9, s[42:43] offset:1024 sc1
  global_load_dwordx4 a[112:115], v9, s[42:43] offset:2048 sc1
  global_load_dwordx4 a[116:119], v9, s[42:43] offset:3072 sc1
  v_add_u32 v9, 8192, v9
  global_load_dwordx4 a[120:123], v9, s[42:43] offset:-4096 sc1
  global_load_dwordx4 a[124:127], v9, s[42:43] offset:-3072 sc1
  global_load_dwordx4 a[128:131], v9, s[42:43] offset:-2048 sc1
  global_load_dwordx4 a[132:135], v9, s[42:43] offset:-1024 sc1
  global_load_dwordx4 a[136:139], v9, s[42:43] offset:0 sc1
  global_load_dwordx4 a[140:143], v9, s[42:43] offset:1024 sc1
  global_load_dwordx4 a[144:147], v9, s[42:43] offset:2048 sc1
  global_load_dwordx4 a[148:151], v9, s[42:43] offset:3072 sc1
  v_add_u32 v9, 8192, v9
  global_load_dwordx4 a[152:155], v9, s[42:43] offset:-4096 sc1
  global_load_dwordx4 a[156:159], v9, s[42:43] offset:-3072 sc1
  global_load_dwordx4 a[160:163], v9, s[42:43] offset:-2048 sc1
  global_load_dwordx4 a[164:167], v9, s[42:43] offset:-1024 sc1
  global_load_dwordx4 a[168:171], v9, s[42:43] offset:0 sc1
  global_load_dwordx4 a[172:175], v9, s[42:43] offset:1024 sc1
  global_load_dwordx4 a[176:179], v9, s[42:43] offset:2048 sc1
  global_load_dwordx4 a[180:183], v9, s[42:43] offset:3072 sc1
  v_add_u32 v9, 8192, v9
  global_load_dwordx4 a[184:187], v9, s[42:43] offset:-4096 sc1
  global_load_dwordx4 a[188:191], v9, s[42:43] offset:-3072 sc1
  global_load_dwordx4 a[192:195], v9, s[42:43] offset:-2048 sc1
  global_load_dwordx4 a[196:199], v9, s[42:43] offset:-1024 sc1
  s_waitcnt vmcnt(0)
  v_accvgpr_read_b32 v52, a88
  v_accvgpr_read_b32 v53, a92
  v_accvgpr_read_b32 v54, a96
  v_max3_u32 v52, v52, v53, v54
  v_accvgpr_read_b32 v53, a100
  v_accvgpr_read_b32 v54, a104
  v_max3_u32 v52, v52, v53, v54
  v_accvgpr_read_b32 v53, a108
  v_accvgpr_read_b32 v54, a112
  v_max3_u32 v52, v52, v53, v54
  v_accvgpr_read_b32 v53, a116
  v_accvgpr_read_b32 v54, a120
  v_max3_u32 v52, v52, v53, v54
  v_accvgpr_read_b32 v53, a124
  v_accvgpr_read_b32 v54, a128
  v_max3_u32 v52, v52, v53, v54
  v_accvgpr_read_b32 v53, a132
  v_accvgpr_read_b32 v54, a136
  v_max3_u32 v52, v52, v53, v54
  v_accvgpr_read_b32 v53, a140
  v_accvgpr_read_b32 v54, a144
  v_max3_u32 v52, v52, v53, v54
  v_accvgpr_read_b32 v53, a148
  v_accvgpr_read_b32 v54, a152
  v_max3_u32 v52, v52, v53, v54
  v_accvgpr_read_b32 v53, a156
  v_accvgpr_read_b32 v54, a160
  v_max3_u32 v52, v52, v53, v54
  v_accvgpr_read_b32 v53, a164
  v_accvgpr_read_b32 v54, a168
  v_max3_u32 v52, v52, v53, v54
  v_accvgpr_read_b32 v53, a172
  v_accvgpr_read_b32 v54, a176
  v_max3_u32 v52, v52, v53, v54
  v_accvgpr_read_b32 v53, a180
  v_accvgpr_read_b32 v54, a184
  v_max3_u32 v52, v52, v53, v54
  v_accvgpr_read_b32 v53, a188
  v_accvgpr_read_b32 v54, a192
  v_max3_u32 v52, v52, v53, v54
  v_accvgpr_read_b32 v53, a196
  v_accvgpr_read_b32 v54, a196
  v_max3_u32 v52, v52, v53, v54
  v_cmp_eq_u32 vcc, -1, v52
  s_nop 0
  s_cbranch_vccz bkha0_99
  s_sub_u32 s15, s15, 1
  s_cmp_lg_u32 s15, 0
  s_cbranch_scc1 spha0_98_l
  s_branch bkha0_99
spha1_100:
  s_mov_b32 s15, 20000
spha1_100_l:
  s_add_u32 s14, s60, 4096
  v_add_u32 v9, s14, v38
  global_load_dwordx4 a[104:107], v9, s[42:43] offset:0 sc1
  global_load_dwordx4 a[108:111], v9, s[42:43] offset:1024 sc1
  global_load_dwordx4 a[112:115], v9, s[42:43] offset:2048 sc1
  global_load_dwordx4 a[116:119], v9, s[42:43] offset:3072 sc1
  v_add_u32 v9, 8192, v9
  global_load_dwordx4 a[120:123], v9, s[42:43] offset:-4096 sc1
  global_load_dwordx4 a[124:127], v9, s[42:43] offset:-3072 sc1
  global_load_dwordx4 a[128:131], v9, s[42:43] offset:-2048 sc1
  global_load_dwordx4 a[132:135], v9, s[42:43] offset:-1024 sc1
  global_load_dwordx4 a[136:139], v9, s[42:43] offset:0 sc1
  global_load_dwordx4 a[140:143], v9, s[42:43] offset:1024 sc1
  global_load_dwordx4 a[144:147], v9, s[42:43] offset:2048 sc1
  global_load_dwordx4 a[148:151], v9, s[42:43] offset:3072 sc1
  v_add_u32 v9, 8192, v9
  global_load_dwordx4 a[152:155], v9, s[42:43] offset:-4096 sc1
  global_load_dwordx4 a[156:159], v9, s[42:43] offset:-3072 sc1
  global_load_dwordx4 a[160:163], v9, s[42:43] offset:-2048 sc1
  global_load_dwordx4 a[164:167], v9, s[42:43] offset:-1024 sc1
  global_load_dwordx4 a[168:171], v9, s[42:43] offset:0 sc1
  global_load_dwordx4 a[172:175], v9, s[42:43] offset:1024 sc1
  global_load_dwordx4 a[176:179], v9, s[42:43] offset:2048 sc1
  global_load_dwordx4 a[180:183], v9, s[42:43] offset:3072 sc1
  v_add_u32 v9, 8192, v9
  global_load_dwordx4 a[184:187], v9, s[42:43] offset:-4096 sc1
  global_load_dwordx4 a[188:191], v9, s[42:43] offset:-3072 sc1
  global_load_dwordx4 a[192:195], v9, s[42:43] offset:-2048 sc1
  global_load_dwordx4 a[196:199], v9, s[42:43] offset:-1024 sc1
  s_waitcnt vmcnt(0)
  v_accvgpr_read_b32 v52, a104
  v_accvgpr_read_b32 v53, a108
  v_accvgpr_read_b32 v54, a112
  v_max3_u32 v52, v52, v53, v54
  v_accvgpr_read_b32 v53, a116
  v_accvgpr_read_b32 v54, a120
  v_max3_u32 v52, v52, v53, v54
  v_accvgpr_read_b32 v53, a124
  v_accvgpr_read_b32 v54, a128
  v_max3_u32 v52, v52, v53, v54
  v_accvgpr_read_b32 v53, a132
  v_accvgpr_read_b32 v54, a136
  v_max3_u32 v52, v52, v53, v54
  v_accvgpr_read_b32 v53, a140
  v_accvgpr_read_b32 v54, a144
  v_max3_u32 v52, v52, v53, v54
  v_accvgpr_read_b32 v53, a148
  v_accvgpr_read_b32 v54, a152
  v_max3_u32 v52, v52, v53, v54
  v_accvgpr_read_b32 v53, a156
  v_accvgpr_read_b32 v54, a160
  v_max3_u32 v52, v52, v53, v54
  v_accvgpr_read_b32 v53, a164
  v_accvgpr_read_b32 v54, a168
  v_max3_u32 v52, v52, v53, v54
  v_accvgpr_read_b32 v53, a172
  v_accvgpr_read_b32 v54, a176
  v_max3_u32 v52, v52, v53, v54
  v_accvgpr_read_b32 v53, a180
  v_accvgpr_read_b32 v54, a184
  v_max3_u32 v52, v52, v53, v54
  v_accvgpr_read_b32 v53, a188
  v_accvgpr_read_b32 v54, a192
  v_max3_u32 v52, v52, v53, v54
  v_accvgpr_read_b32 v53, a196
  v_accvgpr_read_b32 v54, a196
  v_max3_u32 v52, v52, v53, v54
  v_cmp_eq_u32 vcc, -1, v52
  s_nop 0
  s_cbranch_vccz bkha1_101
  s_sub_u32 s15, s15, 1
  s_cmp_lg_u32 s15, 0
  s_cbranch_scc1 spha1_100_l
  s_branch bkha1_101
spha2_102:
  s_mov_b32 s15, 20000
spha2_102_l:
  s_add_u32 s14, s60, 12288
  v_add_u32 v9, s14, v38
  global_load_dwordx4 a[120:123], v9, s[42:43] offset:-4096 sc1
  global_load_dwordx4 a[124:127], v9, s[42:43] offset:-3072 sc1
  global_load_dwordx4 a[128:131], v9, s[42:43] offset:-2048 sc1
  global_load_dwordx4 a[132:135], v9, s[42:43] offset:-1024 sc1
  global_load_dwordx4 a[136:139], v9, s[42:43] offset:0 sc1
  global_load_dwordx4 a[140:143], v9, s[42:43] offset:1024 sc1
  global_load_dwordx4 a[144:147], v9, s[42:43] offset:2048 sc1
  global_load_dwordx4 a[148:151], v9, s[42:43] offset:3072 sc1
  v_add_u32 v9, 8192, v9
  global_load_dwordx4 a[152:155], v9, s[42:43] offset:-4096 sc1
  global_load_dwordx4 a[156:159], v9, s[42:43] offset:-3072 sc1
  global_load_dwordx4 a[160:163], v9, s[42:43] offset:-2048 sc1
  global_load_dwordx4 a[164:167], v9, s[42:43] offset:-1024 sc1
  global_load_dwordx4 a[168:171], v9, s[42:43] offset:0 sc1
  global_load_dwordx4 a[172:175], v9, s[42:43] offset:1024 sc1
  global_load_dwordx4 a[176:179], v9, s[42:43] offset:2048 sc1
  global_load_dwordx4 a[180:183], v9, s[42:43] offset:3072 sc1
  v_add_u32 v9, 8192, v9
  global_load_dwordx4 a[184:187], v9, s[42:43] offset:-4096 sc1
  global_load_dwordx4 a[188:191], v9, s[42:43] offset:-3072 sc1
  global_load_dwordx4 a[192:195], v9, s[42:43] offset:-2048 sc1
  global_load_dwordx4 a[196:199], v9, s[42:43] offset:-1024 sc1
  s_waitcnt vmcnt(0)
  v_accvgpr_read_b32 v52, a120
  v_accvgpr_read_b32 v53, a124
  v_accvgpr_read_b32 v54, a128
  v_max3_u32 v52, v52, v53, v54
  v_accvgpr_read_b32 v53, a132
  v_accvgpr_read_b32 v54, a136
  v_max3_u32 v52, v52, v53, v54
  v_accvgpr_read_b32 v53, a140
  v_accvgpr_read_b32 v54, a144
  v_max3_u32 v52, v52, v53, v54
  v_accvgpr_read_b32 v53, a148
  v_accvgpr_read_b32 v54, a152
  v_max3_u32 v52, v52, v53, v54
  v_accvgpr_read_b32 v53, a156
  v_accvgpr_read_b32 v54, a160
  v_max3_u32 v52, v52, v53, v54
  v_accvgpr_read_b32 v53, a164
  v_accvgpr_read_b32 v54, a168
  v_max3_u32 v52, v52, v53, v54
  v_accvgpr_read_b32 v53, a172
  v_accvgpr_read_b32 v54, a176
  v_max3_u32 v52, v52, v53, v54
  v_accvgpr_read_b32 v53, a180
  v_accvgpr_read_b32 v54, a184
  v_max3_u32 v52, v52, v53, v54
  v_accvgpr_read_b32 v53, a188
  v_accvgpr_read_b32 v54, a192
  v_max3_u32 v52, v52, v53, v54
  v_accvgpr_read_b32 v53, a196
  v_accvgpr_read_b32 v54, a196
  v_max3_u32 v52, v52, v53, v54
  v_cmp_eq_u32 vcc, -1, v52
  s_nop 0
  s_cbranch_vccz bkha2_103
  s_sub_u32 s15, s15, 1
  s_cmp_lg_u32 s15, 0
  s_cbranch_scc1 spha2_102_l
  s_branch bkha2_103
spha3_104:
  s_mov_b32 s15, 20000
spha3_104_l:
  s_add_u32 s14, s60, 12288
  v_add_u32 v9, s14, v38
  global_load_dwordx4 a[136:139], v9, s[42:43] offset:0 sc1
  global_load_dwordx4 a[140:143], v9, s[42:43] offset:1024 sc1
  global_load_dwordx4 a[144:147], v9, s[42:43] offset:2048 sc1
  global_load_dwordx4 a[148:151], v9, s[42:43] offset:3072 sc1
  v_add_u32 v9, 8192, v9
  global_load_dwordx4 a[152:155], v9, s[42:43] offset:-4096 sc1
  global_load_dwordx4 a[156:159], v9, s[42:43] offset:-3072 sc1
  global_load_dwordx4 a[160:163], v9, s[42:43] offset:-2048 sc1
  global_load_dwordx4 a[164:167], v9, s[42:43] offset:-1024 sc1
  global_load_dwordx4 a[168:171], v9, s[42:43] offset:0 sc1
  global_load_dwordx4 a[172:175], v9, s[42:43] offset:1024 sc1
  global_load_dwordx4 a[176:179], v9, s[42:43] offset:2048 sc1
  global_load_dwordx4 a[180:183], v9, s[42:43] offset:3072 sc1
  v_add_u32 v9, 8192, v9
  global_load_dwordx4 a[184:187], v9, s[42:43] offset:-4096 sc1
  global_load_dwordx4 a[188:191], v9, s[42:43] offset:-3072 sc1
  global_load_dwordx4 a[192:195], v9, s[42:43] offset:-2048 sc1
  global_load_dwordx4 a[196:199], v9, s[42:43] offset:-1024 sc1
  s_waitcnt vmcnt(0)
  v_accvgpr_read_b32 v52, a136
  v_accvgpr_read_b32 v53, a140
  v_accvgpr_read_b32 v54, a144
  v_max3_u32 v52, v52, v53, v54
  v_accvgpr_read_b32 v53, a148
  v_accvgpr_read_b32 v54, a152
  v_max3_u32 v52, v52, v53, v54
  v_accvgpr_read_b32 v53, a156
  v_accvgpr_read_b32 v54, a160
  v_max3_u32 v52, v52, v53, v54
  v_accvgpr_read_b32 v53, a164
  v_accvgpr_read_b32 v54, a168
  v_max3_u32 v52, v52, v53, v54
  v_accvgpr_read_b32 v53, a172
  v_accvgpr_read_b32 v54, a176
  v_max3_u32 v52, v52, v53, v54
  v_accvgpr_read_b32 v53, a180
  v_accvgpr_read_b32 v54, a184
  v_max3_u32 v52, v52, v53, v54
  v_accvgpr_read_b32 v53, a188
  v_accvgpr_read_b32 v54, a192
  v_max3_u32 v52, v52, v53, v54
  v_accvgpr_read_b32 v53, a196
  v_accvgpr_read_b32 v54, a196
  v_max3_u32 v52, v52, v53, v54
  v_cmp_eq_u32 vcc, -1, v52
  s_nop 0
  s_cbranch_vccz bkha3_105
  s_sub_u32 s15, s15, 1
  s_cmp_lg_u32 s15, 0
  s_cbranch_scc1 spha3_104_l
  s_branch bkha3_105
spha4_106:
  s_mov_b32 s15, 20000
spha4_106_l:
  s_add_u32 s14, s60, 20480
  v_add_u32 v9, s14, v38
  global_load_dwordx4 a[152:155], v9, s[42:43] offset:-4096 sc1
  global_load_dwordx4 a[156:159], v9, s[42:43] offset:-3072 sc1
  global_load_dwordx4 a[160:163], v9, s[42:43] offset:-2048 sc1
  global_load_dwordx4 a[164:167], v9, s[42:43] offset:-1024 sc1
  global_load_dwordx4 a[168:171], v9, s[42:43] offset:0 sc1
  global_load_dwordx4 a[172:175], v9, s[42:43] offset:1024 sc1
  global_load_dwordx4 a[176:179], v9, s[42:43] offset:2048 sc1
  global_load_dwordx4 a[180:183], v9, s[42:43] offset:3072 sc1
  v_add_u32 v9, 8192, v9
  global_load_dwordx4 a[184:187], v9, s[42:43] offset:-4096 sc1
  global_load_dwordx4 a[188:191], v9, s[42:43] offset:-3072 sc1
  global_load_dwordx4 a[192:195], v9, s[42:43] offset:-2048 sc1
  global_load_dwordx4 a[196:199], v9, s[42:43] offset:-1024 sc1
  s_waitcnt vmcnt(0)
  v_accvgpr_read_b32 v52, a152
  v_accvgpr_read_b32 v53, a156
  v_accvgpr_read_b32 v54, a160
  v_max3_u32 v52, v52, v53, v54
  v_accvgpr_read_b32 v53, a164
  v_accvgpr_read_b32 v54, a168
  v_max3_u32 v52, v52, v53, v54
  v_accvgpr_read_b32 v53, a172
  v_accvgpr_read_b32 v54, a176
  v_max3_u32 v52, v52, v53, v54
  v_accvgpr_read_b32 v53, a180
  v_accvgpr_read_b32 v54, a184
  v_max3_u32 v52, v52, v53, v54
  v_accvgpr_read_b32 v53, a188
  v_accvgpr_read_b32 v54, a192
  v_max3_u32 v52, v52, v53, v54
  v_accvgpr_read_b32 v53, a196
  v_accvgpr_read_b32 v54, a196
  v_max3_u32 v52, v52, v53, v54
  v_cmp_eq_u32 vcc, -1, v52
  s_nop 0
  s_cbranch_vccz bkha4_107
  s_sub_u32 s15, s15, 1
  s_cmp_lg_u32 s15, 0
  s_cbranch_scc1 spha4_106_l
  s_branch bkha4_107
spha5_108:
  s_mov_b32 s15, 20000
spha5_108_l:
  s_add_u32 s14, s60, 20480
  v_add_u32 v9, s14, v38
  global_load_dwordx4 a[168:171], v9, s[42:43] offset:0 sc1
  global_load_dwordx4 a[172:175], v9, s[42:43] offset:1024 sc1
  global_load_dwordx4 a[176:179], v9, s[42:43] offset:2048 sc1
  global_load_dwordx4 a[180:183], v9, s[42:43] offset:3072 sc1
  v_add_u32 v9, 8192, v9
  global_load_dwordx4 a[184:187], v9, s[42:43] offset:-4096 sc1
  global_load_dwordx4 a[188:191], v9, s[42:43] offset:-3072 sc1
  global_load_dwordx4 a[192:195], v9, s[42:43] offset:-2048 sc1
  global_load_dwordx4 a[196:199], v9, s[42:43] offset:-1024 sc1
  s_waitcnt vmcnt(0)
  v_accvgpr_read_b32 v52, a168
  v_accvgpr_read_b32 v53, a172
  v_accvgpr_read_b32 v54, a176
  v_max3_u32 v52, v52, v53, v54
  v_accvgpr_read_b32 v53, a180
  v_accvgpr_read_b32 v54, a184
  v_max3_u32 v52, v52, v53, v54
  v_accvgpr_read_b32 v53, a188
  v_accvgpr_read_b32 v54, a192
  v_max3_u32 v52, v52, v53, v54
  v_accvgpr_read_b32 v53, a196
  v_accvgpr_read_b32 v54, a196
  v_max3_u32 v52, v52, v53, v54
  v_cmp_eq_u32 vcc, -1, v52
  s_nop 0
  s_cbranch_vccz bkha5_109
  s_sub_u32 s15, s15, 1
  s_cmp_lg_u32 s15, 0
  s_cbranch_scc1 spha5_108_l
  s_branch bkha5_109
spha6_110:
  s_mov_b32 s15, 20000
spha6_110_l:
  s_add_u32 s14, s60, 28672
  v_add_u32 v9, s14, v38
  global_load_dwordx4 a[184:187], v9, s[42:43] offset:-4096 sc1
  global_load_dwordx4 a[188:191], v9, s[42:43] offset:-3072 sc1
  global_load_dwordx4 a[192:195], v9, s[42:43] offset:-2048 sc1
  global_load_dwordx4 a[196:199], v9, s[42:43] offset:-1024 sc1
  s_waitcnt vmcnt(0)
  v_accvgpr_read_b32 v52, a184
  v_accvgpr_read_b32 v53, a188
  v_accvgpr_read_b32 v54, a192
  v_max3_u32 v52, v52, v53, v54
  v_accvgpr_read_b32 v53, a196
  v_accvgpr_read_b32 v54, a196
  v_max3_u32 v52, v52, v53, v54
  v_cmp_eq_u32 vcc, -1, v52
  s_nop 0
  s_cbranch_vccz bkha6_111
  s_sub_u32 s15, s15, 1
  s_cmp_lg_u32 s15, 0
  s_cbranch_scc1 spha6_110_l
  s_branch bkha6_111
sphb0_112:
  s_mov_b32 s15, 20000
sphb0_112_l:
  s_add_u32 s14, s61, 4096
  v_add_u32 v9, s14, v38
  global_load_dwordx4 a[88:91], v9, s[42:43] offset:-4096 sc1
  global_load_dwordx4 a[92:95], v9, s[42:43] offset:-3072 sc1
  global_load_dwordx4 a[96:99], v9, s[42:43] offset:-2048 sc1
  global_load_dwordx4 a[100:103], v9, s[42:43] offset:-1024 sc1
  global_load_dwordx4 a[104:107], v9, s[42:43] offset:0 sc1
  global_load_dwordx4 a[108:111], v9, s[42:43] offset:1024 sc1
  global_load_dwordx4 a[112:115], v9, s[42:43] offset:2048 sc1
  global_load_dwordx4 a[116:119], v9, s[42:43] offset:3072 sc1
  v_add_u32 v9, 8192, v9
  global_load_dwordx4 a[120:123], v9, s[42:43] offset:-4096 sc1
  global_load_dwordx4 a[124:127], v9, s[42:43] offset:-3072 sc1
  global_load_dwordx4 a[128:131], v9, s[42:43] offset:-2048 sc1
  global_load_dwordx4 a[132:135], v9, s[42:43] offset:-1024 sc1
  global_load_dwordx4 a[136:139], v9, s[42:43] offset:0 sc1
  global_load_dwordx4 a[140:143], v9, s[42:43] offset:1024 sc1
  global_load_dwordx4 a[144:147], v9, s[42:43] offset:2048 sc1
  global_load_dwordx4 a[148:151], v9, s[42:43] offset:3072 sc1
  v_add_u32 v9, 8192, v9
  global_load_dwordx4 a[152:155], v9, s[42:43] offset:-4096 sc1
  global_load_dwordx4 a[156:159], v9, s[42:43] offset:-3072 sc1
  global_load_dwordx4 a[160:163], v9, s[42:43] offset:-2048 sc1
  global_load_dwordx4 a[164:167], v9, s[42:43] offset:-1024 sc1
  global_load_dwordx4 a[168:171], v9, s[42:43] offset:0 sc1
  global_load_dwordx4 a[172:175], v9, s[42:43] offset:1024 sc1
  global_load_dwordx4 a[176:179], v9, s[42:43] offset:2048 sc1
  global_load_dwordx4 a[180:183], v9, s[42:43] offset:3072 sc1
  v_add_u32 v9, 8192, v9
  global_load_dwordx4 a[184:187], v9, s[42:43] offset:-4096 sc1
  global_load_dwordx4 a[188:191], v9, s[42:43] offset:-3072 sc1
  global_load_dwordx4 a[192:195], v9, s[42:43] offset:-2048 sc1
  global_load_dwordx4 a[196:199], v9, s[42:43] offset:-1024 sc1
  s_waitcnt vmcnt(0)
  v_accvgpr_read_b32 v52, a88
  v_accvgpr_read_b32 v53, a92
  v_accvgpr_read_b32 v54, a96
  v_max3_u32 v52, v52, v53, v54
  v_accvgpr_read_b32 v53, a100
  v_accvgpr_read_b32 v54, a104
  v_max3_u32 v52, v52, v53, v54
  v_accvgpr_read_b32 v53, a108
  v_accvgpr_read_b32 v54, a112
  v_max3_u32 v52, v52, v53, v54
  v_accvgpr_read_b32 v53, a116
  v_accvgpr_read_b32 v54, a120
  v_max3_u32 v52, v52, v53, v54
  v_accvgpr_read_b32 v53, a124
  v_accvgpr_read_b32 v54, a128
  v_max3_u32 v52, v52, v53, v54
  v_accvgpr_read_b32 v53, a132
  v_accvgpr_read_b32 v54, a136
  v_max3_u32 v52, v52, v53, v54
  v_accvgpr_read_b32 v53, a140
  v_accvgpr_read_b32 v54, a144
  v_max3_u32 v52, v52, v53, v54
  v_accvgpr_read_b32 v53, a148
  v_accvgpr_read_b32 v54, a152
  v_max3_u32 v52, v52, v53, v54
  v_accvgpr_read_b32 v53, a156
  v_accvgpr_read_b32 v54, a160
  v_max3_u32 v52, v52, v53, v54
  v_accvgpr_read_b32 v53, a164
  v_accvgpr_read_b32 v54, a168
  v_max3_u32 v52, v52, v53, v54
  v_accvgpr_read_b32 v53, a172
  v_accvgpr_read_b32 v54, a176
  v_max3_u32 v52, v52, v53, v54
  v_accvgpr_read_b32 v53, a180
  v_accvgpr_read_b32 v54, a184
  v_max3_u32 v52, v52, v53, v54
  v_accvgpr_read_b32 v53, a188
  v_accvgpr_read_b32 v54, a192
  v_max3_u32 v52, v52, v53, v54
  v_accvgpr_read_b32 v53, a196
  v_accvgpr_read_b32 v54, a196
  v_max3_u32 v52, v52, v53, v54
  v_cmp_eq_u32 vcc, -1, v52
  s_nop 0
  s_cbranch_vccz bkhb0_113
  s_sub_u32 s15, s15, 1
  s_cmp_lg_u32 s15, 0
  s_cbranch_scc1 sphb0_112_l
  s_branch bkhb0_113
sphb1_114:
  s_mov_b32 s15, 20000
sphb1_114_l:
  s_add_u32 s14, s61, 4096
  v_add_u32 v9, s14, v38
  global_load_dwordx4 a[104:107], v9, s[42:43] offset:0 sc1
  global_load_dwordx4 a[108:111], v9, s[42:43] offset:1024 sc1
  global_load_dwordx4 a[112:115], v9, s[42:43] offset:2048 sc1
  global_load_dwordx4 a[116:119], v9, s[42:43] offset:3072 sc1
  v_add_u32 v9, 8192, v9
  global_load_dwordx4 a[120:123], v9, s[42:43] offset:-4096 sc1
  global_load_dwordx4 a[124:127], v9, s[42:43] offset:-3072 sc1
  global_load_dwordx4 a[128:131], v9, s[42:43] offset:-2048 sc1
  global_load_dwordx4 a[132:135], v9, s[42:43] offset:-1024 sc1
  global_load_dwordx4 a[136:139], v9, s[42:43] offset:0 sc1
  global_load_dwordx4 a[140:143], v9, s[42:43] offset:1024 sc1
  global_load_dwordx4 a[144:147], v9, s[42:43] offset:2048 sc1
  global_load_dwordx4 a[148:151], v9, s[42:43] offset:3072 sc1
  v_add_u32 v9, 8192, v9
  global_load_dwordx4 a[152:155], v9, s[42:43] offset:-4096 sc1
  global_load_dwordx4 a[156:159], v9, s[42:43] offset:-3072 sc1
  global_load_dwordx4 a[160:163], v9, s[42:43] offset:-2048 sc1
  global_load_dwordx4 a[164:167], v9, s[42:43] offset:-1024 sc1
  global_load_dwordx4 a[168:171], v9, s[42:43] offset:0 sc1
  global_load_dwordx4 a[172:175], v9, s[42:43] offset:1024 sc1
  global_load_dwordx4 a[176:179], v9, s[42:43] offset:2048 sc1
  global_load_dwordx4 a[180:183], v9, s[42:43] offset:3072 sc1
  v_add_u32 v9, 8192, v9
  global_load_dwordx4 a[184:187], v9, s[42:43] offset:-4096 sc1
  global_load_dwordx4 a[188:191], v9, s[42:43] offset:-3072 sc1
  global_load_dwordx4 a[192:195], v9, s[42:43] offset:-2048 sc1
  global_load_dwordx4 a[196:199], v9, s[42:43] offset:-1024 sc1
  s_waitcnt vmcnt(0)
  v_accvgpr_read_b32 v52, a104
  v_accvgpr_read_b32 v53, a108
  v_accvgpr_read_b32 v54, a112
  v_max3_u32 v52, v52, v53, v54
  v_accvgpr_read_b32 v53, a116
  v_accvgpr_read_b32 v54, a120
  v_max3_u32 v52, v52, v53, v54
  v_accvgpr_read_b32 v53, a124
  v_accvgpr_read_b32 v54, a128
  v_max3_u32 v52, v52, v53, v54
  v_accvgpr_read_b32 v53, a132
  v_accvgpr_read_b32 v54, a136
  v_max3_u32 v52, v52, v53, v54
  v_accvgpr_read_b32 v53, a140
  v_accvgpr_read_b32 v54, a144
  v_max3_u32 v52, v52, v53, v54
  v_accvgpr_read_b32 v53, a148
  v_accvgpr_read_b32 v54, a152
  v_max3_u32 v52, v52, v53, v54
  v_accvgpr_read_b32 v53, a156
  v_accvgpr_read_b32 v54, a160
  v_max3_u32 v52, v52, v53, v54
  v_accvgpr_read_b32 v53, a164
  v_accvgpr_read_b32 v54, a168
  v_max3_u32 v52, v52, v53, v54
  v_accvgpr_read_b32 v53, a172
  v_accvgpr_read_b32 v54, a176
  v_max3_u32 v52, v52, v53, v54
  v_accvgpr_read_b32 v53, a180
  v_accvgpr_read_b32 v54, a184
  v_max3_u32 v52, v52, v53, v54
  v_accvgpr_read_b32 v53, a188
  v_accvgpr_read_b32 v54, a192
  v_max3_u32 v52, v52, v53, v54
  v_accvgpr_read_b32 v53, a196
  v_accvgpr_read_b32 v54, a196
  v_max3_u32 v52, v52, v53, v54
  v_cmp_eq_u32 vcc, -1, v52
  s_nop 0
  s_cbranch_vccz bkhb1_115
  s_sub_u32 s15, s15, 1
  s_cmp_lg_u32 s15, 0
  s_cbranch_scc1 sphb1_114_l
  s_branch bkhb1_115
sphb2_116:
  s_mov_b32 s15, 20000
sphb2_116_l:
  s_add_u32 s14, s61, 12288
  v_add_u32 v9, s14, v38
  global_load_dwordx4 a[120:123], v9, s[42:43] offset:-4096 sc1
  global_load_dwordx4 a[124:127], v9, s[42:43] offset:-3072 sc1
  global_load_dwordx4 a[128:131], v9, s[42:43] offset:-2048 sc1
  global_load_dwordx4 a[132:135], v9, s[42:43] offset:-1024 sc1
  global_load_dwordx4 a[136:139], v9, s[42:43] offset:0 sc1
  global_load_dwordx4 a[140:143], v9, s[42:43] offset:1024 sc1
  global_load_dwordx4 a[144:147], v9, s[42:43] offset:2048 sc1
  global_load_dwordx4 a[148:151], v9, s[42:43] offset:3072 sc1
  v_add_u32 v9, 8192, v9
  global_load_dwordx4 a[152:155], v9, s[42:43] offset:-4096 sc1
  global_load_dwordx4 a[156:159], v9, s[42:43] offset:-3072 sc1
  global_load_dwordx4 a[160:163], v9, s[42:43] offset:-2048 sc1
  global_load_dwordx4 a[164:167], v9, s[42:43] offset:-1024 sc1
  global_load_dwordx4 a[168:171], v9, s[42:43] offset:0 sc1
  global_load_dwordx4 a[172:175], v9, s[42:43] offset:1024 sc1
  global_load_dwordx4 a[176:179], v9, s[42:43] offset:2048 sc1
  global_load_dwordx4 a[180:183], v9, s[42:43] offset:3072 sc1
  v_add_u32 v9, 8192, v9
  global_load_dwordx4 a[184:187], v9, s[42:43] offset:-4096 sc1
  global_load_dwordx4 a[188:191], v9, s[42:43] offset:-3072 sc1
  global_load_dwordx4 a[192:195], v9, s[42:43] offset:-2048 sc1
  global_load_dwordx4 a[196:199], v9, s[42:43] offset:-1024 sc1
  s_waitcnt vmcnt(0)
  v_accvgpr_read_b32 v52, a120
  v_accvgpr_read_b32 v53, a124
  v_accvgpr_read_b32 v54, a128
  v_max3_u32 v52, v52, v53, v54
  v_accvgpr_read_b32 v53, a132
  v_accvgpr_read_b32 v54, a136
  v_max3_u32 v52, v52, v53, v54
  v_accvgpr_read_b32 v53, a140
  v_accvgpr_read_b32 v54, a144
  v_max3_u32 v52, v52, v53, v54
  v_accvgpr_read_b32 v53, a148
  v_accvgpr_read_b32 v54, a152
  v_max3_u32 v52, v52, v53, v54
  v_accvgpr_read_b32 v53, a156
  v_accvgpr_read_b32 v54, a160
  v_max3_u32 v52, v52, v53, v54
  v_accvgpr_read_b32 v53, a164
  v_accvgpr_read_b32 v54, a168
  v_max3_u32 v52, v52, v53, v54
  v_accvgpr_read_b32 v53, a172
  v_accvgpr_read_b32 v54, a176
  v_max3_u32 v52, v52, v53, v54
  v_accvgpr_read_b32 v53, a180
  v_accvgpr_read_b32 v54, a184
  v_max3_u32 v52, v52, v53, v54
  v_accvgpr_read_b32 v53, a188
  v_accvgpr_read_b32 v54, a192
  v_max3_u32 v52, v52, v53, v54
  v_accvgpr_read_b32 v53, a196
  v_accvgpr_read_b32 v54, a196
  v_max3_u32 v52, v52, v53, v54
  v_cmp_eq_u32 vcc, -1, v52
  s_nop 0
  s_cbranch_vccz bkhb2_117
  s_sub_u32 s15, s15, 1
  s_cmp_lg_u32 s15, 0
  s_cbranch_scc1 sphb2_116_l
  s_branch bkhb2_117
sphb3_118:
  s_mov_b32 s15, 20000
sphb3_118_l:
  s_add_u32 s14, s61, 12288
  v_add_u32 v9, s14, v38
  global_load_dwordx4 a[136:139], v9, s[42:43] offset:0 sc1
  global_load_dwordx4 a[140:143], v9, s[42:43] offset:1024 sc1
  global_load_dwordx4 a[144:147], v9, s[42:43] offset:2048 sc1
  global_load_dwordx4 a[148:151], v9, s[42:43] offset:3072 sc1
  v_add_u32 v9, 8192, v9
  global_load_dwordx4 a[152:155], v9, s[42:43] offset:-4096 sc1
  global_load_dwordx4 a[156:159], v9, s[42:43] offset:-3072 sc1
  global_load_dwordx4 a[160:163], v9, s[42:43] offset:-2048 sc1
  global_load_dwordx4 a[164:167], v9, s[42:43] offset:-1024 sc1
  global_load_dwordx4 a[168:171], v9, s[42:43] offset:0 sc1
  global_load_dwordx4 a[172:175], v9, s[42:43] offset:1024 sc1
  global_load_dwordx4 a[176:179], v9, s[42:43] offset:2048 sc1
  global_load_dwordx4 a[180:183], v9, s[42:43] offset:3072 sc1
  v_add_u32 v9, 8192, v9
  global_load_dwordx4 a[184:187], v9, s[42:43] offset:-4096 sc1
  global_load_dwordx4 a[188:191], v9, s[42:43] offset:-3072 sc1
  global_load_dwordx4 a[192:195], v9, s[42:43] offset:-2048 sc1
  global_load_dwordx4 a[196:199], v9, s[42:43] offset:-1024 sc1
  s_waitcnt vmcnt(0)
  v_accvgpr_read_b32 v52, a136
  v_accvgpr_read_b32 v53, a140
  v_accvgpr_read_b32 v54, a144
  v_max3_u32 v52, v52, v53, v54
  v_accvgpr_read_b32 v53, a148
  v_accvgpr_read_b32 v54, a152
  v_max3_u32 v52, v52, v53, v54
  v_accvgpr_read_b32 v53, a156
  v_accvgpr_read_b32 v54, a160
  v_max3_u32 v52, v52, v53, v54
  v_accvgpr_read_b32 v53, a164
  v_accvgpr_read_b32 v54, a168
  v_max3_u32 v52, v52, v53, v54
  v_accvgpr_read_b32 v53, a172
  v_accvgpr_read_b32 v54, a176
  v_max3_u32 v52, v52, v53, v54
  v_accvgpr_read_b32 v53, a180
  v_accvgpr_read_b32 v54, a184
  v_max3_u32 v52, v52, v53, v54
  v_accvgpr_read_b32 v53, a188
  v_accvgpr_read_b32 v54, a192
  v_max3_u32 v52, v52, v53, v54
  v_accvgpr_read_b32 v53, a196
  v_accvgpr_read_b32 v54, a196
  v_max3_u32 v52, v52, v53, v54
  v_cmp_eq_u32 vcc, -1, v52
  s_nop 0
  s_cbranch_vccz bkhb3_119
  s_sub_u32 s15, s15, 1
  s_cmp_lg_u32 s15, 0
  s_cbranch_scc1 sphb3_118_l
  s_branch bkhb3_119
sphb4_120:
  s_mov_b32 s15, 20000
sphb4_120_l:
  s_add_u32 s14, s61, 20480
  v_add_u32 v9, s14, v38
  global_load_dwordx4 a[152:155], v9, s[42:43] offset:-4096 sc1
  global_load_dwordx4 a[156:159], v9, s[42:43] offset:-3072 sc1
  global_load_dwordx4 a[160:163], v9, s[42:43] offset:-2048 sc1
  global_load_dwordx4 a[164:167], v9, s[42:43] offset:-1024 sc1
  global_load_dwordx4 a[168:171], v9, s[42:43] offset:0 sc1
  global_load_dwordx4 a[172:175], v9, s[42:43] offset:1024 sc1
  global_load_dwordx4 a[176:179], v9, s[42:43] offset:2048 sc1
  global_load_dwordx4 a[180:183], v9, s[42:43] offset:3072 sc1
  v_add_u32 v9, 8192, v9
  global_load_dwordx4 a[184:187], v9, s[42:43] offset:-4096 sc1
  global_load_dwordx4 a[188:191], v9, s[42:43] offset:-3072 sc1
  global_load_dwordx4 a[192:195], v9, s[42:43] offset:-2048 sc1
  global_load_dwordx4 a[196:199], v9, s[42:43] offset:-1024 sc1
  s_waitcnt vmcnt(0)
  v_accvgpr_read_b32 v52, a152
  v_accvgpr_read_b32 v53, a156
  v_accvgpr_read_b32 v54, a160
  v_max3_u32 v52, v52, v53, v54
  v_accvgpr_read_b32 v53, a164
  v_accvgpr_read_b32 v54, a168
  v_max3_u32 v52, v52, v53, v54
  v_accvgpr_read_b32 v53, a172
  v_accvgpr_read_b32 v54, a176
  v_max3_u32 v52, v52, v53, v54
  v_accvgpr_read_b32 v53, a180
  v_accvgpr_read_b32 v54, a184
  v_max3_u32 v52, v52, v53, v54
  v_accvgpr_read_b32 v53, a188
  v_accvgpr_read_b32 v54, a192
  v_max3_u32 v52, v52, v53, v54
  v_accvgpr_read_b32 v53, a196
  v_accvgpr_read_b32 v54, a196
  v_max3_u32 v52, v52, v53, v54
  v_cmp_eq_u32 vcc, -1, v52
  s_nop 0
  s_cbranch_vccz bkhb4_121
  s_sub_u32 s15, s15, 1
  s_cmp_lg_u32 s15, 0
  s_cbranch_scc1 sphb4_120_l
  s_branch bkhb4_121
sphb5_122:
  s_mov_b32 s15, 20000
sphb5_122_l:
  s_add_u32 s14, s61, 20480
  v_add_u32 v9, s14, v38
  global_load_dwordx4 a[168:171], v9, s[42:43] offset:0 sc1
  global_load_dwordx4 a[172:175], v9, s[42:43] offset:1024 sc1
  global_load_dwordx4 a[176:179], v9, s[42:43] offset:2048 sc1
  global_load_dwordx4 a[180:183], v9, s[42:43] offset:3072 sc1
  v_add_u32 v9, 8192, v9
  global_load_dwordx4 a[184:187], v9, s[42:43] offset:-4096 sc1
  global_load_dwordx4 a[188:191], v9, s[42:43] offset:-3072 sc1
  global_load_dwordx4 a[192:195], v9, s[42:43] offset:-2048 sc1
  global_load_dwordx4 a[196:199], v9, s[42:43] offset:-1024 sc1
  s_waitcnt vmcnt(0)
  v_accvgpr_read_b32 v52, a168
  v_accvgpr_read_b32 v53, a172
  v_accvgpr_read_b32 v54, a176
  v_max3_u32 v52, v52, v53, v54
  v_accvgpr_read_b32 v53, a180
  v_accvgpr_read_b32 v54, a184
  v_max3_u32 v52, v52, v53, v54
  v_accvgpr_read_b32 v53, a188
  v_accvgpr_read_b32 v54, a192
  v_max3_u32 v52, v52, v53, v54
  v_accvgpr_read_b32 v53, a196
  v_accvgpr_read_b32 v54, a196
  v_max3_u32 v52, v52, v53, v54
  v_cmp_eq_u32 vcc, -1, v52
  s_nop 0
  s_cbranch_vccz bkhb5_123
  s_sub_u32 s15, s15, 1
  s_cmp_lg_u32 s15, 0
  s_cbranch_scc1 sphb5_122_l
  s_branch bkhb5_123
sphb6_124:
  s_mov_b32 s15, 20000
sphb6_124_l:
  s_add_u32 s14, s61, 28672
  v_add_u32 v9, s14, v38
  global_load_dwordx4 a[184:187], v9, s[42:43] offset:-4096 sc1
  global_load_dwordx4 a[188:191], v9, s[42:43] offset:-3072 sc1
  global_load_dwordx4 a[192:195], v9, s[42:43] offset:-2048 sc1
  global_load_dwordx4 a[196:199], v9, s[42:43] offset:-1024 sc1
  s_waitcnt vmcnt(0)
  v_accvgpr_read_b32 v52, a184
  v_accvgpr_read_b32 v53, a188
  v_accvgpr_read_b32 v54, a192
  v_max3_u32 v52, v52, v53, v54
  v_accvgpr_read_b32 v53, a196
  v_accvgpr_read_b32 v54, a196
  v_max3_u32 v52, v52, v53, v54
  v_cmp_eq_u32 vcc, -1, v52
  s_nop 0
  s_cbranch_vccz bkhb6_125
  s_sub_u32 s15, s15, 1
  s_cmp_lg_u32 s15, 0
  s_cbranch_scc1 sphb6_124_l
  s_branch bkhb6_125
sphs1a_130:
  s_mov_b32 s15, 20000
sphs1a_130_l:
  global_load_dword v42, v41, s[40:41] sc1
  s_waitcnt vmcnt(0)
  v_cmp_gt_u32 vcc, 16, v42
  s_nop 0
  s_cbranch_vccz bkhs1a_131
  s_sub_u32 s15, s15, 1
  s_cmp_lg_u32 s15, 0
  s_cbranch_scc1 sphs1a_130_l
  s_branch bkhs1a_131
sphs1_136:
  s_mov_b32 s15, 20000
sphs1_136_l:
  global_load_dword v42, v43, s[42:43] sc1
  s_waitcnt vmcnt(0)
  v_cmp_gt_u32 vcc, 30, v42
  s_nop 0
  s_cbranch_vccz bkhs1_137
  s_sub_u32 s15, s15, 1
  s_cmp_lg_u32 s15, 0
  s_cbranch_scc1 sphs1_136_l
  s_branch bkhs1_137
L_exit:
  s_endpgm
.section .rodata,"a"
.p2align 6
.amdhsa_kernel interleave_layers__ssm_conv_s4d__glu_gated_glu__prompt_kernel
  .amdhsa_next_free_vgpr 512
  .amdhsa_next_free_sgpr 102
  .amdhsa_accum_offset 256
  .amdhsa_group_segment_fixed_size 0
  .amdhsa_kernarg_size 112
  .amdhsa_user_sgpr_count 2
  .amdhsa_user_sgpr_kernarg_segment_ptr 1
  .amdhsa_system_sgpr_workgroup_id_x 1
.end_amdhsa_kernel
```
